```python
import torch

def _softmax(x, axis=-1):
    return torch.softmax(x, dim=axis)
def _gelu(x):
    return torch.nn.functional.gelu(x, approximate="tanh")
def _silu(x):
    return torch.nn.functional.silu(x)
def _sigmoid(x):
    return torch.sigmoid(x)
def _layernorm(x, axis=-1, eps=1e-5):
    m = x.mean(dim=axis, keepdim=True)
    v = x.var(dim=axis, keepdim=True, unbiased=False)
    return (x - m) / torch.sqrt(v + eps)
def _scatter_add(tgt, idx, src, axis=0):
    return tgt.clone().index_add_(axis, idx, src)
def _segment_sum(src, seg, n):
    out = torch.zeros((n,) + src.shape[1:], dtype=src.dtype)
    return out.index_add_(0, seg, src)
def _pad(x, pw):
    flat = tuple(v for pair in reversed(pw) for v in pair)
    return torch.nn.functional.pad(x, flat)

kernel_name = 'recurrent_scan__gqa_block_cached__dense_activation_silu__prompt'

def setup_inputs():

    _w = (lambda a: (lambda t: t.to(torch.bfloat16) if t.is_floating_point() else t)(torch.as_tensor(a)))
    def _A_setup():
        B, Sq, D = 1, 2048, 640
        Hq, Hkv, Sk, Dh = 32, 32, 2048, 128
        assert Hq % Hkv == 0, (Hq, Hkv)
        return {
            "x": _w((lambda *s: torch.randn(*s, dtype=torch.bfloat16) * 0.05)(B, Sq, D)),
            "k_cache": _w((lambda *s: torch.randn(*s, dtype=torch.bfloat16) * 3.2)(B, Hkv, Sk, Dh)),
            "v_cache": _w((lambda *s: torch.randn(*s, dtype=torch.bfloat16) * 3.2)(B, Hkv, Sk, Dh)),
            "wq": _w((lambda *s: torch.randn(*s, dtype=torch.bfloat16) * 3.2)(D, Hq * Dh) * (D ** -0.5)),
            "wo": _w((lambda *s: torch.randn(*s, dtype=torch.bfloat16) * 3.2)(Hq * Dh, D) * ((Hq * Dh) ** -0.5)),
        }
    _A_in = _A_setup()

    def _B_setup():
        B, S, D, F = 1, 2048, 640, 1728
        return {
            "x": _w((lambda *s: torch.randn(*s, dtype=torch.bfloat16) * 0.05)(B, S, D)),
            "w1": _w((lambda *s: torch.randn(*s, dtype=torch.bfloat16) * 3.2)(D, F) * (D ** -0.5)),
            "w2": _w((lambda *s: torch.randn(*s, dtype=torch.bfloat16) * 0.4)(F, D) * (F ** -0.5)),
        }
    _B_in = _B_setup()

    return {
        "A_x": _A_in["x"],
        "A_k_cache": _A_in["k_cache"],
        "A_v_cache": _A_in["v_cache"],
        "A_wq": _A_in["wq"],
        "A_wo": _A_in["wo"],
        "B_x": _B_in["x"],
        "B_w1": _B_in["w1"],
        "B_w2": _B_in["w2"],
    }

def reference(A_x, A_k_cache, A_v_cache, A_wq, A_wo, B_x, B_w1, B_w2):
    def _A_ref(x, k_cache, v_cache, wq, wo):
        B, Sq, D = x.shape
        Hq, Dh = 32, 128
        Hkv = k_cache.shape[1]
        rep = Hq // Hkv
        q = (lambda x, *d: x.permute(*d))((x @ wq).reshape(B, Sq, Hq, Dh), 0, 2, 1, 3)
        k = (lambda x, n, axis: torch.repeat_interleave(x, n, dim=axis))(k_cache, rep, axis=1)
        v = (lambda x, n, axis: torch.repeat_interleave(x, n, dim=axis))(v_cache, rep, axis=1)
        scores = torch.einsum("bhqd,bhkd->bhqk", q, k) * (Dh ** -0.5)
        p = _softmax(scores, axis=-1)
        o = torch.einsum("bhqk,bhkd->bhqd", p, v)
        return (lambda x, *d: x.permute(*d))(o, 0, 2, 1, 3).reshape(B, Sq, Hq * Dh) @ wo

    def _B_ref(x, w1, w2):
        h = torch.einsum("bsd,df->bsf", x, w1)
        h = _silu(h)
        out = torch.einsum("bsf,fd->bsd", h, w2)
        return out

    x = A_x
    xn = _layernorm(x, axis=-1)
    s = _A_ref(xn, A_k_cache, A_v_cache, A_wq, A_wo)
    g = _silu(_B_ref(xn, B_w1, B_w2))
    return x + s * g
```

```asm
; @launch grid=(256,1,1) block=(256,1,1) lds=163840
.amdgcn_target "amdgcn-amd-amdhsa--gfx950"
.text
.globl recurrent_scan__gqa_block_cached__dense_activation_silu__prompt_kernel
.p2align 8
.type recurrent_scan__gqa_block_cached__dense_activation_silu__prompt_kernel,@function
recurrent_scan__gqa_block_cached__dense_activation_silu__prompt_kernel:
    s_load_dwordx16 s[52:67], s[0:1], 0
    s_cmp_ge_u32 s2, 256
    s_cbranch_scc1 M_exit
    v_lshrrev_b32 v31, 6, v0
    v_mov_b32 v62, v0
    v_readfirstlane_b32 s76, v31
    v_and_b32 v0, 63, v0
    s_lshr_b32 s78, s2, 5
    v_lshrrev_b32 v29, 4, v0
    v_lshrrev_b32 v30, 3, v0
    v_and_b32 v31, 7, v0
    s_lshl_b32 s101, s76, 13
    s_lshl_b32 s5, s78, 2
    s_add_u32 s5, s5, s76
    s_mul_i32 s6, s5, 81920
    v_mul_u32_u24 v26, 1280, v30
    v_add_u32 v26, s6, v26
    v_xor_b32 v27, v31, v29
    v_lshl_add_u32 v20, v27, 4, v26
    v_add_u32 v22, 18432, v20
    v_xor_b32 v27, 64, v20
    v_add_u32 v21, 9216, v27
    v_add_u32 v23, 27648, v27
    s_mov_b32 s10, 2621440
    s_mov_b32 s11, 0x00020000
    s_add_u32 m0, s101, 65536
    s_mov_b32 s80, 0
    s_waitcnt lgkmcnt(0)
    s_mov_b64 s[8:9], s[52:53]
    buffer_load_dwordx4 v20, s[8:11], s80 offen offset:0 lds
    buffer_load_dwordx4 v21, s[8:11], s80 offen offset:1024 lds
    buffer_load_dwordx4 v22, s[8:11], s80 offen offset:2048 lds
    buffer_load_dwordx4 v23, s[8:11], s80 offen offset:3072 lds
    s_add_u32 m0, s101, 69632
    s_mov_b32 s80, 40960
    buffer_load_dwordx4 v20, s[8:11], s80 offen offset:0 lds
    buffer_load_dwordx4 v21, s[8:11], s80 offen offset:1024 lds
    buffer_load_dwordx4 v22, s[8:11], s80 offen offset:2048 lds
    buffer_load_dwordx4 v23, s[8:11], s80 offen offset:3072 lds
    s_getpc_b64 s[6:7]
M_pc:
    s_lshr_b32 s3, s2, 3
    s_lshl_b32 s3, s3, 11
    v_lshl_add_u32 v60, v62, 3, s3
    v_min_u32 v60, M_hot_end-M_pc-4, v60
    v_mov_b32 v61, 0
    v_lshl_add_u64 v[60:61], v[60:61], 0, s[6:7]
    global_load_dword v63, v[60:61], off
    s_load_dwordx2 s[48:49], s[0:1], 64
    s_load_dwordx2 s[36:37], s[0:1], 72
    s_load_dwordx2 s[40:41], s[0:1], 80
    s_and_b32 s3, s2, 7
    s_bfe_u32 s7, s2, 0x20003
    s_lshl_b32 s77, s3, 2
    s_add_u32 s77, s77, s7
    s_lshl_b32 s100, s76, 11
    s_lshl_b32 s79, s76, 12
    v_and_b32 v28, 15, v0
    s_lshl_b32 s6, s76, 17
    v_lshlrev_b32 v26, 13, v29
    v_add_u32 v26, s6, v26
    v_lshlrev_b32 v27, 2, v29
    v_xor_b32 v27, v27, v28
    v_lshl_add_u32 v52, v27, 4, v26
    v_add_u32 v53, 31744, v52
    v_add_u32 v54, 63488, v52
    v_add_u32 v55, 95232, v52
    s_lshl_b32 s6, s77, 8
    s_add_u32 s12, s58, s6
    s_addc_u32 s13, s59, 0
    s_mov_b32 s14, 5234944
    s_mov_b32 s15, 0x00020000
    s_add_u32 m0, s79, 114688
    s_mov_b32 s80, 0
    buffer_load_dwordx4 v52, s[12:15], s80 offen offset:0 lds
    buffer_load_dwordx4 v53, s[12:15], s80 offen offset:1024 lds
    buffer_load_dwordx4 v54, s[12:15], s80 offen offset:2048 lds
    buffer_load_dwordx4 v55, s[12:15], s80 offen offset:3072 lds
    s_min_u32 s4, s3, 5
    s_sub_u32 s81, s77, s4
    s_cmp_lt_u32 s3, 5
    s_cselect_b32 s4, s7, 0
    s_cmp_eq_u32 s4, 3
    s_cselect_b32 s81, 27, s81
    s_lshl_b32 s6, s81, 7
    s_add_u32 s16, s64, s6
    s_addc_u32 s17, s65, 0
    s_mov_b32 s18, 2208512
    s_mov_b32 s19, 0x00020000
    s_cmp_lt_u32 s81, 27
    s_cselect_b32 s18, s18, 0
    s_mul_i32 s6, s76, 55296
    v_mul_u32_u24 v26, 3456, v30
    v_add_u32 v26, s6, v26
    v_and_b32 v27, 2, v30
    v_xor_b32 v27, v27, v31
    v_lshl_add_u32 v56, v27, 4, v26
    v_xor_b32 v27, 64, v56
    v_add_u32 v57, 26624, v27
    s_add_u32 m0, s100, 131072
    s_mov_b32 s80, 0
    buffer_load_dwordx4 v56, s[16:19], s80 offen offset:0 lds
    buffer_load_dwordx4 v57, s[16:19], s80 offen offset:1024 lds
    v_lshlrev_b32 v1, 4, v0
    v_bfe_u32 v30, v0, 2, 3
    v_and_b32 v31, 3, v0
    v_bfe_u32 v12, v0, 2, 2
    v_lshl_add_u32 v26, v29, 3, v12
    v_lshlrev_b32 v27, 8, v26
    v_lshl_add_u32 v27, v31, 4, v27
    v_xor_b32 v12, s76, v12
    v_lshl_add_u32 v40, v12, 6, v27
    v_xor_b32 v41, 64, v40
    v_xor_b32 v42, 128, v40
    v_xor_b32 v43, 192, v40
    v_lshlrev_b32 v27, 7, v26
    v_lshl_add_u32 v27, v31, 3, v27
    v_add_u32 v27, 131072, v27
    v_lshrrev_b32 v12, 1, v30
    s_and_b32 s6, s76, 2
    v_xor_b32 v12, s6, v12
    v_lshl_add_u32 v48, v12, 5, v27
    v_xor_b32 v49, 32, v48
    v_xor_b32 v50, 64, v48
    v_xor_b32 v51, 96, v48
    v_lshrrev_b32 v12, 1, v28
    v_xor_b32 v12, v12, v29
    v_lshlrev_b32 v12, 4, v12
    v_lshl_add_u32 v12, v28, 7, v12
    s_add_u32 s6, s101, 65536
    v_add_u32 v24, s6, v12
    v_xor_b32 v25, 64, v24
    v_and_b32 v26, 1, v0
    v_cmp_eq_u32 vcc, 0, v26
    v_mov_b32 v27, 0x44444444
    v_mov_b32 v12, 0xeeeeeeee
    v_cndmask_b32 v35, v12, v27, vcc
    v_and_b32 v26, 2, v0
    v_cmp_eq_u32 vcc, 0, v26
    v_mov_b32 v27, 0x3f803f80
    v_mov_b32 v12, 0
    v_cndmask_b32 v36, v12, v27, vcc
    v_cndmask_b32 v37, v12, v27, vcc
    v_cndmask_b32 v38, v12, v27, vcc
    v_cndmask_b32 v39, v12, v27, vcc
    v_accvgpr_write_b32 a192, 0
    v_accvgpr_write_b32 a193, 0
    v_accvgpr_write_b32 a194, 0
    v_accvgpr_write_b32 a195, 0
    v_accvgpr_write_b32 a196, 0
    v_accvgpr_write_b32 a197, 0
    v_accvgpr_write_b32 a198, 0
    v_accvgpr_write_b32 a199, 0
    v_accvgpr_write_b32 a200, 0
    v_accvgpr_write_b32 a201, 0
    v_accvgpr_write_b32 a202, 0
    v_accvgpr_write_b32 a203, 0
    v_accvgpr_write_b32 a204, 0
    v_accvgpr_write_b32 a205, 0
    v_accvgpr_write_b32 a206, 0
    v_accvgpr_write_b32 a207, 0
    s_add_u32 m0, s101, 0
    s_mov_b32 s80, 128
    buffer_load_dwordx4 v20, s[8:11], s80 offen offset:0 lds
    buffer_load_dwordx4 v21, s[8:11], s80 offen offset:1024 lds
    buffer_load_dwordx4 v22, s[8:11], s80 offen offset:2048 lds
    buffer_load_dwordx4 v23, s[8:11], s80 offen offset:3072 lds
    s_add_u32 m0, s101, 4096
    s_mov_b32 s80, 41088
    buffer_load_dwordx4 v20, s[8:11], s80 offen offset:0 lds
    buffer_load_dwordx4 v21, s[8:11], s80 offen offset:1024 lds
    s_waitcnt lgkmcnt(0)
    s_waitcnt vmcnt(6)
    s_barrier
    ds_read_b128 a[64:67], v24 offset:0
    ds_read_b128 a[68:71], v25 offset:0
    ds_read_b128 a[72:75], v24 offset:2048
    ds_read_b128 a[76:79], v25 offset:2048
    ds_read_b128 a[80:83], v24 offset:4096
    ds_read_b128 a[84:87], v25 offset:4096
    ds_read_b128 a[88:91], v24 offset:6144
    ds_read_b128 a[92:95], v25 offset:6144
    v_xor_b32 v24, 0x10000, v24
    v_xor_b32 v25, 0x10000, v25
    v_xor_b32 v40, 0x10000, v40
    ds_read_b64_tr_b16 a[128:129], v40 offset:49152
    ds_read_b64_tr_b16 a[130:131], v40 offset:50176
    ds_read_b64_tr_b16 a[132:133], v40 offset:57344
    ds_read_b64_tr_b16 a[134:135], v40 offset:58368
    ds_read_b64_tr_b16 a[136:137], v40 offset:49160
    ds_read_b64_tr_b16 a[138:139], v40 offset:50184
    ds_read_b64_tr_b16 a[140:141], v40 offset:57352
    ds_read_b64_tr_b16 a[142:143], v40 offset:58376
    s_waitcnt lgkmcnt(4)
    v_mfma_f32_16x16x32_bf16 v[128:131], a[128:131], a[64:67], 0
    s_lshl_b32 s6, s78, 5
    v_xor_b32 v41, 0x10000, v41
    ds_read_b64_tr_b16 a[144:145], v41 offset:49152
    v_mfma_f32_16x16x32_bf16 v[128:131], a[132:135], a[68:71], v[128:131]
    s_add_u32 s6, s6, s77
    ds_read_b64_tr_b16 a[146:147], v41 offset:50176
    s_lshl_b32 s6, s6, 2
    v_mfma_f32_16x16x32_bf16 v[132:135], a[132:135], a[76:79], 0
    s_add_u32 s6, s6, s76
    ds_read_b64_tr_b16 a[148:149], v41 offset:57344
    s_lshl_b32 s6, s6, 1
    v_mfma_f32_16x16x32_bf16 v[132:135], a[128:131], a[72:75], v[132:135]
    ds_read_b64_tr_b16 a[150:151], v41 offset:58368
    v_mfma_f32_16x16x32_bf16 v[136:139], a[128:131], a[80:83], 0
    buffer_load_dwordx4 v22, s[8:11], s80 offen offset:2048 lds
    v_mfma_f32_16x16x32_bf16 v[136:139], a[132:135], a[84:87], v[136:139]
    buffer_load_dwordx4 v23, s[8:11], s80 offen offset:3072 lds
    v_mfma_f32_16x16x32_bf16 v[140:143], a[132:135], a[92:95], 0
    s_add_u32 m0, s79, 98304
    s_mov_b32 s80, 524288
    v_lshrrev_b32 v26, 5, v0
    v_mfma_f32_16x16x32_bf16 v[140:143], a[128:131], a[88:91], v[140:143]
    v_add_u32 v26, s6, v26
    v_mul_u32_u24 v27, 1280, v26
    v_smfmac_f32_16x16x64_bf16 a[192:195], v[36:39], a[128:135], v35
    s_waitcnt lgkmcnt(4)
    v_and_b32 v12, 31, v0
    v_lshl_add_u32 v13, v12, 4, v27
    v_mfma_f32_16x16x32_bf16 v[156:159], a[136:139], a[88:91], 0
    ds_read_b64_tr_b16 a[152:153], v41 offset:49160
    v_lshl_add_u32 v14, v12, 3, v27
    v_mfma_f32_16x16x32_bf16 v[156:159], a[140:143], a[92:95], v[156:159]
    ds_read_b64_tr_b16 a[154:155], v41 offset:50184
    v_lshlrev_b32 v26, 3, v26
    v_mfma_f32_16x16x32_bf16 v[152:155], a[140:143], a[84:87], 0
    ds_read_b64_tr_b16 a[156:157], v41 offset:57352
    v_lshl_add_u32 v19, v12, 24, v26
    v_mfma_f32_16x16x32_bf16 v[152:155], a[136:139], a[80:83], v[152:155]
    ds_read_b64_tr_b16 a[158:159], v41 offset:58376
    v_mfma_f32_16x16x32_bf16 v[148:151], a[136:139], a[72:75], 0
    buffer_load_dwordx4 v52, s[12:15], s80 offen offset:0 lds
    v_mfma_f32_16x16x32_bf16 v[148:151], a[140:143], a[76:79], v[148:151]
    buffer_load_dwordx4 v53, s[12:15], s80 offen offset:1024 lds
    v_mfma_f32_16x16x32_bf16 v[144:147], a[140:143], a[68:71], 0
    v_min_u32 v12, 1, v62
    v_lshlrev_b32 v33, 24, v12
    v_mfma_f32_16x16x32_bf16 v[144:147], a[136:139], a[64:67], v[144:147]
    v_mov_b32 v32, 1
    s_lshl_b32 s6, s77, 19
    v_smfmac_f32_16x16x64_bf16 a[196:199], v[36:39], a[136:143], v35
    s_waitcnt lgkmcnt(4)
    s_add_u32 s20, s54, s6
    s_addc_u32 s21, s55, 0
    v_mfma_f32_16x16x32_bf16 v[160:163], a[144:147], a[64:67], 0
    s_mov_b32 s22, 524288
    v_xor_b32 v42, 0x10000, v42
    ds_read_b64_tr_b16 a[128:129], v42 offset:49152
    v_mfma_f32_16x16x32_bf16 v[160:163], a[148:151], a[68:71], v[160:163]
    s_mov_b32 s23, 0x00020000
    ds_read_b64_tr_b16 a[130:131], v42 offset:50176
    s_add_u32 s24, s56, s6
    s_addc_u32 s25, s57, 0
    v_mfma_f32_16x16x32_bf16 v[164:167], a[148:151], a[76:79], 0
    s_mov_b32 s26, 524288
    ds_read_b64_tr_b16 a[132:133], v42 offset:57344
    s_mov_b32 s27, 0x00020000
    v_mfma_f32_16x16x32_bf16 v[164:167], a[144:147], a[72:75], v[164:167]
    s_sub_u32 s66, s66, 5242880
    s_subb_u32 s67, s67, 0
    ds_read_b64_tr_b16 a[134:135], v42 offset:58368
    v_mfma_f32_16x16x32_bf16 v[168:171], a[144:147], a[80:83], 0
    s_cmp_lt_u32 s2, 160
    s_cselect_b64 s[44:45], s[60:61], s[66:67]
    s_cselect_b32 s7, 64, 91
    v_mfma_f32_16x16x32_bf16 v[168:171], a[148:151], a[84:87], v[168:171]
    s_mul_i32 s46, s7, 81920
    buffer_load_dwordx4 v54, s[12:15], s80 offen offset:2048 lds
    v_mfma_f32_16x16x32_bf16 v[172:175], a[148:151], a[92:95], 0
    s_mov_b32 s47, 0x00020000
    buffer_load_dwordx4 v55, s[12:15], s80 offen offset:3072 lds
    v_mfma_f32_16x16x32_bf16 v[172:175], a[144:147], a[88:91], v[172:175]
    s_waitcnt lgkmcnt(4)
    s_add_u32 m0, s100, 139264
    s_mov_b32 s80, 221184
    v_mfma_f32_16x16x32_bf16 v[188:191], a[152:155], a[88:91], 0
    s_mul_i32 s6, s5, 745472
    ds_read_b64_tr_b16 a[136:137], v42 offset:49160
    s_add_u32 s6, s6, 4194304
    v_mfma_f32_16x16x32_bf16 v[188:191], a[156:159], a[92:95], v[188:191]
    s_lshl_b32 s7, s77, 14
    ds_read_b64_tr_b16 a[138:139], v42 offset:50184
    s_add_u32 s7, s7, s6
    v_mfma_f32_16x16x32_bf16 v[184:187], a[156:159], a[84:87], 0
    s_add_u32 s28, s40, s7
    s_addc_u32 s29, s41, 0
    ds_read_b64_tr_b16 a[140:141], v42 offset:57352
    v_mfma_f32_16x16x32_bf16 v[184:187], a[152:155], a[80:83], v[184:187]
    s_mov_b32 s30, 16384
    ds_read_b64_tr_b16 a[142:143], v42 offset:58376
    s_mov_b32 s31, 0x00020000
    v_mfma_f32_16x16x32_bf16 v[180:183], a[152:155], a[72:75], 0
    s_lshl_b32 s7, s81, 13
    buffer_load_dwordx4 v56, s[16:19], s80 offen offset:0 lds
    v_mfma_f32_16x16x32_bf16 v[180:183], a[156:159], a[76:79], v[180:183]
    s_add_u32 s7, s7, 524288
    buffer_load_dwordx4 v57, s[16:19], s80 offen offset:1024 lds
    v_mfma_f32_16x16x32_bf16 v[176:179], a[156:159], a[68:71], 0
    s_add_u32 m0, s101, 65536
    s_mov_b32 s80, 256
    s_add_u32 s7, s7, s6
    v_mfma_f32_16x16x32_bf16 v[176:179], a[152:155], a[64:67], v[176:179]
    s_waitcnt lgkmcnt(4)
    s_add_u32 s32, s40, s7
    s_addc_u32 s33, s41, 0
    v_mfma_f32_16x16x32_bf16 v[192:195], a[128:131], a[64:67], 0
    s_mov_b32 s34, 8192
    v_xor_b32 v43, 0x10000, v43
    ds_read_b64_tr_b16 a[144:145], v43 offset:49152
    v_mfma_f32_16x16x32_bf16 v[192:195], a[132:135], a[68:71], v[192:195]
    s_mov_b32 s35, 0x00020000
    ds_read_b64_tr_b16 a[146:147], v43 offset:50176
    s_cmp_lt_u32 s81, 27
    s_cselect_b32 s34, s34, 0
    v_mfma_f32_16x16x32_bf16 v[196:199], a[132:135], a[76:79], 0
    s_mov_b32 s38, 256
    ds_read_b64_tr_b16 a[148:149], v43 offset:57344
    s_mov_b32 s39, 0x00020000
    v_mfma_f32_16x16x32_bf16 v[196:199], a[128:131], a[72:75], v[196:199]
    s_mov_b32 s64, s48
    ds_read_b64_tr_b16 a[150:151], v43 offset:58368
    s_mov_b32 s65, s49
    v_mfma_f32_16x16x32_bf16 v[200:203], a[128:131], a[80:83], 0
    s_mov_b32 s66, 2621440
    buffer_load_dwordx4 v20, s[8:11], s80 offen offset:0 lds
    v_mfma_f32_16x16x32_bf16 v[200:203], a[132:135], a[84:87], v[200:203]
    s_mov_b32 s67, 0x00020000
    buffer_load_dwordx4 v21, s[8:11], s80 offen offset:1024 lds
    v_mfma_f32_16x16x32_bf16 v[204:207], a[132:135], a[92:95], 0
    s_bfe_u32 s4, s2, 0x20001
    s_and_b32 s5, s2, 1
    s_lshl_b32 s5, s5, 3
    v_mfma_f32_16x16x32_bf16 v[204:207], a[128:131], a[88:91], v[204:207]
    s_waitcnt lgkmcnt(4)
    s_bfe_u32 s6, s2, 0x30003
    s_add_u32 s5, s5, s6
    v_mfma_f32_16x16x32_bf16 v[220:223], a[136:139], a[88:91], 0
    s_lshr_b32 s6, s2, 6
    ds_read_b64_tr_b16 a[152:153], v43 offset:49160
    s_lshl_b32 s7, s5, 1
    v_mfma_f32_16x16x32_bf16 v[220:223], a[140:143], a[92:95], v[220:223]
    s_lshr_b32 s3, s76, 1
    ds_read_b64_tr_b16 a[154:155], v43 offset:50184
    s_add_u32 s3, s7, s3
    v_mfma_f32_16x16x32_bf16 v[216:219], a[140:143], a[84:87], 0
    s_mul_i32 s7, s3, 745472
    ds_read_b64_tr_b16 a[156:157], v43 offset:57352
    s_add_u32 s7, s7, 4194304
    v_mfma_f32_16x16x32_bf16 v[216:219], a[136:139], a[80:83], v[216:219]
    s_and_b32 s91, s79, 4096
    ds_read_b64_tr_b16 a[158:159], v43 offset:58376
    s_add_u32 s7, s7, s91
    v_mfma_f32_16x16x32_bf16 v[212:215], a[136:139], a[72:75], 0
    s_add_u32 s56, s40, s7
    s_addc_u32 s57, s41, 0
    s_mov_b32 s58, 741376
    v_mfma_f32_16x16x32_bf16 v[212:215], a[140:143], a[76:79], v[212:215]
    s_mov_b32 s59, 0x00020000
    buffer_load_dwordx4 v22, s[8:11], s80 offen offset:2048 lds
    v_mfma_f32_16x16x32_bf16 v[208:211], a[140:143], a[68:71], 0
    s_lshl_b32 s7, s6, 2
    buffer_load_dwordx4 v23, s[8:11], s80 offen offset:3072 lds
    v_mfma_f32_16x16x32_bf16 v[208:211], a[136:139], a[64:67], v[208:211]
    s_waitcnt lgkmcnt(4)
    s_add_u32 m0, s101, 69632
    s_mov_b32 s80, 41216
    v_mfma_f32_16x16x32_bf16 v[224:227], a[144:147], a[64:67], 0
    s_add_u32 s7, s7, s76
    ds_read_b64_tr_b16 a[128:129], v48 offset:0
    s_mul_i32 s7, s7, 5120
    v_mfma_f32_16x16x32_bf16 v[224:227], a[148:151], a[68:71], v[224:227]
    s_add_u32 s7, s7, 33554432
    ds_read_b64_tr_b16 a[130:131], v48 offset:512
    s_add_u32 s60, s40, s7
    s_addc_u32 s61, s41, 0
    v_mfma_f32_16x16x32_bf16 v[228:231], a[148:151], a[76:79], 0
    s_mov_b32 s62, 7377920
    ds_read_b64_tr_b16 a[132:133], v48 offset:4096
    s_mov_b32 s63, 0x00020000
    v_mfma_f32_16x16x32_bf16 v[228:231], a[144:147], a[72:75], v[228:231]
    s_lshl_b32 s3, s3, 2
    ds_read_b64_tr_b16 a[134:135], v48 offset:4608
    s_add_u32 s3, s3, s4
    v_mfma_f32_16x16x32_bf16 v[232:235], a[144:147], a[80:83], 0
    s_mul_i32 s91, s3, 20480
    buffer_load_dwordx4 v20, s[8:11], s80 offen offset:0 lds
    v_mfma_f32_16x16x32_bf16 v[232:235], a[148:151], a[84:87], v[232:235]
    s_lshl_b32 s7, s6, 1
    buffer_load_dwordx4 v21, s[8:11], s80 offen offset:1024 lds
    v_mfma_f32_16x16x32_bf16 v[236:239], a[148:151], a[92:95], 0
    s_and_b32 s3, s76, 1
    s_add_u32 s7, s7, s3
    s_mul_i32 s7, s7, 160
    v_mfma_f32_16x16x32_bf16 v[236:239], a[144:147], a[88:91], v[236:239]
    s_waitcnt lgkmcnt(4)
    s_add_u32 s91, s91, s7
    s_lshr_b32 s7, s5, 1
    v_mfma_f32_16x16x32_bf16 v[252:255], a[152:155], a[88:91], 0
    s_lshl_b32 s7, s7, 2
    ds_read_b64_tr_b16 a[136:137], v49 offset:0
    s_add_u32 s7, s7, s4
    v_mfma_f32_16x16x32_bf16 v[252:255], a[156:159], a[92:95], v[252:255]
    s_lshl_b32 s7, s7, 8
    ds_read_b64_tr_b16 a[138:139], v49 offset:512
    s_add_u32 s95, s7, 20480
    v_mfma_f32_16x16x32_bf16 v[248:251], a[156:159], a[84:87], 0
    s_mul_i32 s7, s4, 7
    ds_read_b64_tr_b16 a[140:141], v49 offset:4096
    s_add_u32 s7, s7, 64
    v_mfma_f32_16x16x32_bf16 v[248:251], a[152:155], a[80:83], v[248:251]
    s_lshl_b32 s87, s7, 13
    ds_read_b64_tr_b16 a[142:143], v49 offset:4608
    s_mul_i32 s88, s7, 81920
    v_mfma_f32_16x16x32_bf16 v[244:247], a[152:155], a[72:75], 0
    s_lshl_b32 s89, s4, 17
    buffer_load_dwordx4 v22, s[8:11], s80 offen offset:2048 lds
    v_mfma_f32_16x16x32_bf16 v[244:247], a[156:159], a[76:79], v[244:247]
    s_mul_i32 s90, s4, 1310720
    buffer_load_dwordx4 v23, s[8:11], s80 offen offset:3072 lds
    v_mfma_f32_16x16x32_bf16 v[240:243], a[156:159], a[68:71], 0
    s_add_u32 m0, s79, 32768
    s_mov_b32 s80, 1048576
    s_lshl_b32 s5, s5, 2
    v_mfma_f32_16x16x32_bf16 v[240:243], a[152:155], a[64:67], v[240:243]
    s_waitcnt lgkmcnt(4)
    s_add_u32 s5, s5, s6
    s_lshl_b32 s5, s5, 8
    v_mfma_f32_16x16x32_bf16 v[64:67], a[128:131], a[64:67], 0
    s_waitcnt vmcnt(14)
    ds_read_b64_tr_b16 a[144:145], v50 offset:0
    ds_read_b128 a[96:99], v24 offset:0
    v_mfma_f32_16x16x32_bf16 v[64:67], a[132:135], a[68:71], v[64:67]
    s_add_u32 s5, s5, 28672
    ds_read_b64_tr_b16 a[146:147], v50 offset:512
    ds_read_b128 a[100:103], v25 offset:0
    v_mfma_f32_16x16x32_bf16 v[68:71], a[132:135], a[76:79], 0
    s_cmp_eq_u32 s4, 0
    s_cselect_b32 s5, s5, 16777216
    ds_read_b64_tr_b16 a[148:149], v50 offset:4096
    v_mfma_f32_16x16x32_bf16 v[68:71], a[128:131], a[72:75], v[68:71]
    s_add_u32 s52, s40, 33554432
    s_addc_u32 s53, s41, 0
    ds_read_b64_tr_b16 a[150:151], v50 offset:4608
    v_mfma_f32_16x16x32_bf16 v[72:75], a[128:131], a[80:83], 0
    s_mov_b32 s54, 7454720
    ds_read_b128 a[104:107], v24 offset:2048
    ds_read_b128 a[108:111], v25 offset:2048
    v_mfma_f32_16x16x32_bf16 v[72:75], a[132:135], a[84:87], v[72:75]
    s_mov_b32 s55, 0x00020000
    ds_read_b128 a[112:115], v24 offset:4096
    ds_read_b128 a[116:119], v25 offset:4096
    v_mfma_f32_16x16x32_bf16 v[76:79], a[132:135], a[92:95], 0
    s_add_u32 s86, s100, 131072
    ds_read_b128 a[120:123], v24 offset:6144
    ds_read_b128 a[124:127], v25 offset:6144
    v_mfma_f32_16x16x32_bf16 v[76:79], a[128:131], a[88:91], v[76:79]
    s_mov_b32 s42, 45056
    buffer_load_dwordx4 v52, s[12:15], s80 offen offset:0 lds
    v_smfmac_f32_16x16x64_bf16 a[200:203], v[36:39], a[128:135], v35
    s_waitcnt lgkmcnt(12)
    buffer_load_dwordx4 v53, s[12:15], s80 offen offset:1024 lds
    v_mfma_f32_16x16x32_bf16 v[92:95], a[136:139], a[88:91], 0
    s_mov_b32 s43, 0x00020000
    ds_read_b64_tr_b16 a[152:153], v51 offset:0
    v_xor_b32 v24, 0x10000, v24
    v_mfma_f32_16x16x32_bf16 v[92:95], a[140:143], a[92:95], v[92:95]
    s_lshl_b32 s92, s78, 5
    ds_read_b64_tr_b16 a[154:155], v51 offset:512
    v_xor_b32 v25, 0x10000, v25
    v_mfma_f32_16x16x32_bf16 v[88:91], a[140:143], a[84:87], 0
    s_lshl_b32 s7, s78, 8
    ds_read_b64_tr_b16 a[156:157], v51 offset:4096
    s_add_u32 s93, s7, 16384
    v_mfma_f32_16x16x32_bf16 v[88:91], a[136:139], a[80:83], v[88:91]
    s_lshl_b32 s7, s78, 2
    ds_read_b64_tr_b16 a[158:159], v51 offset:4608
    s_lshr_b32 s6, s77, 3
    v_mfma_f32_16x16x32_bf16 v[84:87], a[136:139], a[72:75], 0
    s_add_u32 s7, s7, s6
    buffer_load_dwordx4 v54, s[12:15], s80 offen offset:2048 lds
    v_mfma_f32_16x16x32_bf16 v[84:87], a[140:143], a[76:79], v[84:87]
    s_lshl_b32 s7, s7, 8
    buffer_load_dwordx4 v55, s[12:15], s80 offen offset:3072 lds
    v_mfma_f32_16x16x32_bf16 v[80:83], a[140:143], a[68:71], 0
    s_add_u32 m0, s100, 147456
    s_mov_b32 s80, 442368
    s_add_u32 s94, s7, 20480
    v_mfma_f32_16x16x32_bf16 v[80:83], a[136:139], a[64:67], v[80:83]
    s_add_u32 s68, s79, 0
    s_add_u32 s72, s79, 65536
    s_add_u32 s69, s79, 16384
    v_smfmac_f32_16x16x64_bf16 a[204:207], v[36:39], a[136:143], v35
    s_waitcnt lgkmcnt(10)
    s_add_u32 s73, s79, 81920
    s_add_u32 s70, s79, 32768
    v_mfma_f32_16x16x32_bf16 v[96:99], a[144:147], a[64:67], 0
    s_waitcnt vmcnt(12)
    s_barrier
    s_add_u32 s74, s79, 98304
    v_mfma_f32_16x16x32_bf16 v[96:99], a[148:151], a[68:71], v[96:99]
    s_add_u32 s71, s79, 49152
    ds_read_b64_tr_b16 a[128:129], v40 offset:32768
    s_add_u32 s75, s79, 114688
    v_mfma_f32_16x16x32_bf16 v[100:103], a[148:151], a[76:79], 0
    s_mov_b32 s82, 0
    ds_read_b64_tr_b16 a[130:131], v40 offset:33792
    s_cmp_eq_u32 s77, 0
    s_cselect_b32 s6, s93, 16777216
    v_mfma_f32_16x16x32_bf16 v[100:103], a[144:147], a[72:75], v[100:103]
    s_and_b32 s7, s77, 7
    s_cselect_b32 s7, 16777216, s94
    ds_read_b64_tr_b16 a[132:133], v40 offset:40960
    v_mfma_f32_16x16x32_bf16 v[104:107], a[144:147], a[80:83], 0
    ds_read_b64_tr_b16 a[134:135], v40 offset:41984
    v_mfma_f32_16x16x32_bf16 v[104:107], a[148:151], a[84:87], v[104:107]
    buffer_load_dwordx4 v56, s[16:19], s80 offen offset:0 lds
    v_mfma_f32_16x16x32_bf16 v[108:111], a[148:151], a[92:95], 0
    v_lshl_add_u32 v26, v62, 2, s5
    v_mov_b32 v27, 16777216
    v_mfma_f32_16x16x32_bf16 v[108:111], a[144:147], a[88:91], v[108:111]
    s_waitcnt lgkmcnt(4)
    v_cmp_gt_u32 vcc, 8, v62
    v_mfma_f32_16x16x32_bf16 v[124:127], a[152:155], a[88:91], 0
    ds_read_b64_tr_b16 a[136:137], v40 offset:32776
    v_cndmask_b32 v26, v27, v26, vcc
    v_mfma_f32_16x16x32_bf16 v[124:127], a[156:159], a[92:95], v[124:127]
    ds_read_b64_tr_b16 a[138:139], v40 offset:33800
    v_mov_b32 v27, s6
    v_mfma_f32_16x16x32_bf16 v[120:123], a[156:159], a[84:87], 0
    ds_read_b64_tr_b16 a[140:141], v40 offset:40968
    v_cmp_eq_u32 vcc, 8, v62
    v_mfma_f32_16x16x32_bf16 v[120:123], a[152:155], a[80:83], v[120:123]
    ds_read_b64_tr_b16 a[142:143], v40 offset:41992
    v_mfma_f32_16x16x32_bf16 v[116:119], a[152:155], a[72:75], 0
    buffer_load_dwordx4 v57, s[16:19], s80 offen offset:1024 lds
    v_mfma_f32_16x16x32_bf16 v[116:119], a[156:159], a[76:79], v[116:119]
    v_cndmask_b32 v26, v26, v27, vcc
    v_mov_b32 v27, s7
    v_mfma_f32_16x16x32_bf16 v[112:115], a[156:159], a[68:71], 0
    v_cmp_eq_u32 vcc, 9, v62
    v_mfma_f32_16x16x32_bf16 v[112:115], a[152:155], a[64:67], v[112:115]
    s_waitcnt lgkmcnt(4)
    v_cndmask_b32 v26, v26, v27, vcc
    v_mov_b32 v27, 0
    v_mfma_f32_16x16x32_bf16 v[128:131], a[128:131], a[96:99], v[128:131]
    s_add_u32 m0, s101, 0
    ds_read_b64_tr_b16 a[144:145], v41 offset:32768
    s_mov_b32 s80, 384
    v_mfma_f32_16x16x32_bf16 v[128:131], a[132:135], a[100:103], v[128:131]
    ds_read_b64_tr_b16 a[146:147], v41 offset:33792
    v_mfma_f32_16x16x32_bf16 v[132:135], a[132:135], a[108:111], v[132:135]
    ds_read_b64_tr_b16 a[148:149], v41 offset:40960
    v_mfma_f32_16x16x32_bf16 v[132:135], a[128:131], a[104:107], v[132:135]
    ds_read_b64_tr_b16 a[150:151], v41 offset:41984
    v_mfma_f32_16x16x32_bf16 v[136:139], a[128:131], a[112:115], v[136:139]
    buffer_load_dwordx4 v20, s[8:11], s80 offen offset:0 lds
    v_mfma_f32_16x16x32_bf16 v[136:139], a[132:135], a[116:119], v[136:139]
    buffer_load_dwordx4 v21, s[8:11], s80 offen offset:1024 lds
    v_mfma_f32_16x16x32_bf16 v[140:143], a[132:135], a[124:127], v[140:143]
    buffer_load_dwordx4 v22, s[8:11], s80 offen offset:2048 lds
    v_mfma_f32_16x16x32_bf16 v[140:143], a[128:131], a[120:123], v[140:143]
    v_smfmac_f32_16x16x64_bf16 a[192:195], v[36:39], a[128:135], v35
    s_waitcnt lgkmcnt(4)
    v_mfma_f32_16x16x32_bf16 v[156:159], a[136:139], a[120:123], v[156:159]
    ds_read_b64_tr_b16 a[152:153], v41 offset:32776
    v_mfma_f32_16x16x32_bf16 v[156:159], a[140:143], a[124:127], v[156:159]
    ds_read_b64_tr_b16 a[154:155], v41 offset:33800
    v_mfma_f32_16x16x32_bf16 v[152:155], a[140:143], a[116:119], v[152:155]
    ds_read_b64_tr_b16 a[156:157], v41 offset:40968
    v_mfma_f32_16x16x32_bf16 v[152:155], a[136:139], a[112:115], v[152:155]
    ds_read_b64_tr_b16 a[158:159], v41 offset:41992
    v_mfma_f32_16x16x32_bf16 v[148:151], a[136:139], a[104:107], v[148:151]
    buffer_load_dwordx4 v23, s[8:11], s80 offen offset:3072 lds
    v_mfma_f32_16x16x32_bf16 v[148:151], a[140:143], a[108:111], v[148:151]
    s_add_u32 m0, s101, 4096
    s_mov_b32 s80, 41344
    v_mfma_f32_16x16x32_bf16 v[144:147], a[140:143], a[100:103], v[144:147]
    buffer_load_dwordx4 v20, s[8:11], s80 offen offset:0 lds
    v_mfma_f32_16x16x32_bf16 v[144:147], a[136:139], a[96:99], v[144:147]
    v_smfmac_f32_16x16x64_bf16 a[196:199], v[36:39], a[136:143], v35
    s_waitcnt lgkmcnt(4)
    v_mfma_f32_16x16x32_bf16 v[160:163], a[144:147], a[96:99], v[160:163]
    ds_read_b64_tr_b16 a[128:129], v42 offset:32768
    v_mfma_f32_16x16x32_bf16 v[160:163], a[148:151], a[100:103], v[160:163]
    ds_read_b64_tr_b16 a[130:131], v42 offset:33792
    v_mfma_f32_16x16x32_bf16 v[164:167], a[148:151], a[108:111], v[164:167]
    ds_read_b64_tr_b16 a[132:133], v42 offset:40960
    v_mfma_f32_16x16x32_bf16 v[164:167], a[144:147], a[104:107], v[164:167]
    ds_read_b64_tr_b16 a[134:135], v42 offset:41984
    v_mfma_f32_16x16x32_bf16 v[168:171], a[144:147], a[112:115], v[168:171]
    buffer_load_dwordx4 v21, s[8:11], s80 offen offset:1024 lds
    v_mfma_f32_16x16x32_bf16 v[168:171], a[148:151], a[116:119], v[168:171]
    buffer_load_dwordx4 v22, s[8:11], s80 offen offset:2048 lds
    v_mfma_f32_16x16x32_bf16 v[172:175], a[148:151], a[124:127], v[172:175]
    v_mfma_f32_16x16x32_bf16 v[172:175], a[144:147], a[120:123], v[172:175]
    s_waitcnt lgkmcnt(4)
    v_mfma_f32_16x16x32_bf16 v[188:191], a[152:155], a[120:123], v[188:191]
    ds_read_b64_tr_b16 a[136:137], v42 offset:32776
    v_mfma_f32_16x16x32_bf16 v[188:191], a[156:159], a[124:127], v[188:191]
    ds_read_b64_tr_b16 a[138:139], v42 offset:33800
    v_mfma_f32_16x16x32_bf16 v[184:187], a[156:159], a[116:119], v[184:187]
    ds_read_b64_tr_b16 a[140:141], v42 offset:40968
    v_mfma_f32_16x16x32_bf16 v[184:187], a[152:155], a[112:115], v[184:187]
    ds_read_b64_tr_b16 a[142:143], v42 offset:41992
    v_mfma_f32_16x16x32_bf16 v[180:183], a[152:155], a[104:107], v[180:183]
    buffer_load_dwordx4 v23, s[8:11], s80 offen offset:3072 lds
    v_mfma_f32_16x16x32_bf16 v[180:183], a[156:159], a[108:111], v[180:183]
    s_add_u32 m0, s79, 49152
    s_mov_b32 s80, 1572864
    v_mfma_f32_16x16x32_bf16 v[176:179], a[156:159], a[100:103], v[176:179]
    buffer_load_dwordx4 v52, s[12:15], s80 offen offset:0 lds
    v_mfma_f32_16x16x32_bf16 v[176:179], a[152:155], a[96:99], v[176:179]
    s_waitcnt lgkmcnt(4)
    v_mfma_f32_16x16x32_bf16 v[192:195], a[128:131], a[96:99], v[192:195]
    ds_read_b64_tr_b16 a[144:145], v43 offset:32768
    v_mfma_f32_16x16x32_bf16 v[192:195], a[132:135], a[100:103], v[192:195]
    ds_read_b64_tr_b16 a[146:147], v43 offset:33792
    v_mfma_f32_16x16x32_bf16 v[196:199], a[132:135], a[108:111], v[196:199]
    ds_read_b64_tr_b16 a[148:149], v43 offset:40960
    v_mfma_f32_16x16x32_bf16 v[196:199], a[128:131], a[104:107], v[196:199]
    ds_read_b64_tr_b16 a[150:151], v43 offset:41984
    v_mfma_f32_16x16x32_bf16 v[200:203], a[128:131], a[112:115], v[200:203]
    buffer_load_dwordx4 v53, s[12:15], s80 offen offset:1024 lds
    v_mfma_f32_16x16x32_bf16 v[200:203], a[132:135], a[116:119], v[200:203]
    buffer_load_dwordx4 v54, s[12:15], s80 offen offset:2048 lds
    v_mfma_f32_16x16x32_bf16 v[204:207], a[132:135], a[124:127], v[204:207]
    v_mfma_f32_16x16x32_bf16 v[204:207], a[128:131], a[120:123], v[204:207]
    s_waitcnt lgkmcnt(4)
    v_mfma_f32_16x16x32_bf16 v[220:223], a[136:139], a[120:123], v[220:223]
    ds_read_b64_tr_b16 a[152:153], v43 offset:32776
    v_mfma_f32_16x16x32_bf16 v[220:223], a[140:143], a[124:127], v[220:223]
    ds_read_b64_tr_b16 a[154:155], v43 offset:33800
    v_mfma_f32_16x16x32_bf16 v[216:219], a[140:143], a[116:119], v[216:219]
    ds_read_b64_tr_b16 a[156:157], v43 offset:40968
    v_mfma_f32_16x16x32_bf16 v[216:219], a[136:139], a[112:115], v[216:219]
    ds_read_b64_tr_b16 a[158:159], v43 offset:41992
    v_mfma_f32_16x16x32_bf16 v[212:215], a[136:139], a[104:107], v[212:215]
    buffer_load_dwordx4 v55, s[12:15], s80 offen offset:3072 lds
    v_mfma_f32_16x16x32_bf16 v[212:215], a[140:143], a[108:111], v[212:215]
    s_add_u32 m0, s100, 155648
    s_mov_b32 s80, 663552
    v_mfma_f32_16x16x32_bf16 v[208:211], a[140:143], a[100:103], v[208:211]
    buffer_load_dwordx4 v56, s[16:19], s80 offen offset:0 lds
    v_mfma_f32_16x16x32_bf16 v[208:211], a[136:139], a[96:99], v[208:211]
    s_waitcnt lgkmcnt(4)
    v_mfma_f32_16x16x32_bf16 v[224:227], a[144:147], a[96:99], v[224:227]
    ds_read_b64_tr_b16 a[128:129], v48 offset:8192
    v_mfma_f32_16x16x32_bf16 v[224:227], a[148:151], a[100:103], v[224:227]
    ds_read_b64_tr_b16 a[130:131], v48 offset:8704
    v_mfma_f32_16x16x32_bf16 v[228:231], a[148:151], a[108:111], v[228:231]
    ds_read_b64_tr_b16 a[132:133], v48 offset:12288
    v_mfma_f32_16x16x32_bf16 v[228:231], a[144:147], a[104:107], v[228:231]
    ds_read_b64_tr_b16 a[134:135], v48 offset:12800
    v_mfma_f32_16x16x32_bf16 v[232:235], a[144:147], a[112:115], v[232:235]
    buffer_load_dwordx4 v57, s[16:19], s80 offen offset:1024 lds
    v_mfma_f32_16x16x32_bf16 v[232:235], a[148:151], a[116:119], v[232:235]
    buffer_store_dword v27, v26, s[40:43], 0 offen sc1
    v_mfma_f32_16x16x32_bf16 v[236:239], a[148:151], a[124:127], v[236:239]
    v_mfma_f32_16x16x32_bf16 v[236:239], a[144:147], a[120:123], v[236:239]
    s_waitcnt lgkmcnt(4)
    v_mfma_f32_16x16x32_bf16 v[252:255], a[152:155], a[120:123], v[252:255]
    ds_read_b64_tr_b16 a[136:137], v49 offset:8192
    v_mfma_f32_16x16x32_bf16 v[252:255], a[156:159], a[124:127], v[252:255]
    ds_read_b64_tr_b16 a[138:139], v49 offset:8704
    v_mfma_f32_16x16x32_bf16 v[248:251], a[156:159], a[116:119], v[248:251]
    ds_read_b64_tr_b16 a[140:141], v49 offset:12288
    v_mfma_f32_16x16x32_bf16 v[248:251], a[152:155], a[112:115], v[248:251]
    ds_read_b64_tr_b16 a[142:143], v49 offset:12800
    v_mfma_f32_16x16x32_bf16 v[244:247], a[152:155], a[104:107], v[244:247]
    v_mfma_f32_16x16x32_bf16 v[244:247], a[156:159], a[108:111], v[244:247]
    v_mfma_f32_16x16x32_bf16 v[240:243], a[156:159], a[100:103], v[240:243]
    v_mfma_f32_16x16x32_bf16 v[240:243], a[152:155], a[96:99], v[240:243]
    s_waitcnt lgkmcnt(4)
    v_mfma_f32_16x16x32_bf16 v[64:67], a[128:131], a[96:99], v[64:67]
    s_waitcnt vmcnt(21)
    ds_read_b64_tr_b16 a[144:145], v50 offset:8192
    ds_read_b128 a[64:67], v24 offset:0
    v_mfma_f32_16x16x32_bf16 v[64:67], a[132:135], a[100:103], v[64:67]
    ds_read_b64_tr_b16 a[146:147], v50 offset:8704
    ds_read_b128 a[68:71], v25 offset:0
    v_mfma_f32_16x16x32_bf16 v[68:71], a[132:135], a[108:111], v[68:71]
    ds_read_b64_tr_b16 a[148:149], v50 offset:12288
    ds_read_b128 a[72:75], v24 offset:2048
    v_mfma_f32_16x16x32_bf16 v[68:71], a[128:131], a[104:107], v[68:71]
    ds_read_b64_tr_b16 a[150:151], v50 offset:12800
    ds_read_b128 a[76:79], v25 offset:2048
    v_mfma_f32_16x16x32_bf16 v[72:75], a[128:131], a[112:115], v[72:75]
    ds_read_b128 a[80:83], v24 offset:4096
    ds_read_b128 a[84:87], v25 offset:4096
    v_mfma_f32_16x16x32_bf16 v[72:75], a[132:135], a[116:119], v[72:75]
    ds_read_b128 a[88:91], v24 offset:6144
    ds_read_b128 a[92:95], v25 offset:6144
    v_mfma_f32_16x16x32_bf16 v[76:79], a[132:135], a[124:127], v[76:79]
    v_xor_b32 v24, 0x10000, v24
    v_xor_b32 v25, 0x10000, v25
    v_mfma_f32_16x16x32_bf16 v[76:79], a[128:131], a[120:123], v[76:79]
    v_smfmac_f32_16x16x64_bf16 a[200:203], v[36:39], a[128:135], v35
    s_waitcnt lgkmcnt(12)
    v_mfma_f32_16x16x32_bf16 v[92:95], a[136:139], a[120:123], v[92:95]
    ds_read_b64_tr_b16 a[152:153], v51 offset:8192
    v_mfma_f32_16x16x32_bf16 v[92:95], a[140:143], a[124:127], v[92:95]
    ds_read_b64_tr_b16 a[154:155], v51 offset:8704
    v_mfma_f32_16x16x32_bf16 v[88:91], a[140:143], a[116:119], v[88:91]
    ds_read_b64_tr_b16 a[156:157], v51 offset:12288
    v_mfma_f32_16x16x32_bf16 v[88:91], a[136:139], a[112:115], v[88:91]
    ds_read_b64_tr_b16 a[158:159], v51 offset:12800
    v_mfma_f32_16x16x32_bf16 v[84:87], a[136:139], a[104:107], v[84:87]
    v_mfma_f32_16x16x32_bf16 v[84:87], a[140:143], a[108:111], v[84:87]
    v_mfma_f32_16x16x32_bf16 v[80:83], a[140:143], a[100:103], v[80:83]
    v_mfma_f32_16x16x32_bf16 v[80:83], a[136:139], a[96:99], v[80:83]
    v_smfmac_f32_16x16x64_bf16 a[204:207], v[36:39], a[136:143], v35
    s_waitcnt lgkmcnt(9)
    v_mfma_f32_16x16x32_bf16 v[96:99], a[144:147], a[96:99], v[96:99]
    s_waitcnt vmcnt(15)
    s_barrier
    v_mfma_f32_16x16x32_bf16 v[96:99], a[148:151], a[100:103], v[96:99]
    v_xor_b32 v40, 0x10000, v40
    ds_read_b64_tr_b16 a[128:129], v40 offset:32768
    v_mfma_f32_16x16x32_bf16 v[100:103], a[148:151], a[108:111], v[100:103]
    ds_read_b64_tr_b16 a[130:131], v40 offset:33792
    v_mfma_f32_16x16x32_bf16 v[100:103], a[144:147], a[104:107], v[100:103]
    ds_read_b64_tr_b16 a[132:133], v40 offset:40960
    v_mfma_f32_16x16x32_bf16 v[104:107], a[144:147], a[112:115], v[104:107]
    ds_read_b64_tr_b16 a[134:135], v40 offset:41984
    v_mfma_f32_16x16x32_bf16 v[104:107], a[148:151], a[116:119], v[104:107]
    v_mfma_f32_16x16x32_bf16 v[108:111], a[148:151], a[124:127], v[108:111]
    v_mfma_f32_16x16x32_bf16 v[108:111], a[144:147], a[120:123], v[108:111]
    s_waitcnt lgkmcnt(4)
    v_mfma_f32_16x16x32_bf16 v[124:127], a[152:155], a[120:123], v[124:127]
    ds_read_b64_tr_b16 a[136:137], v40 offset:32776
    v_mfma_f32_16x16x32_bf16 v[124:127], a[156:159], a[124:127], v[124:127]
    ds_read_b64_tr_b16 a[138:139], v40 offset:33800
    v_mfma_f32_16x16x32_bf16 v[120:123], a[156:159], a[116:119], v[120:123]
    ds_read_b64_tr_b16 a[140:141], v40 offset:40968
    v_mfma_f32_16x16x32_bf16 v[120:123], a[152:155], a[112:115], v[120:123]
    ds_read_b64_tr_b16 a[142:143], v40 offset:41992
    v_mfma_f32_16x16x32_bf16 v[116:119], a[152:155], a[104:107], v[116:119]
    v_mfma_f32_16x16x32_bf16 v[116:119], a[156:159], a[108:111], v[116:119]
    v_mfma_f32_16x16x32_bf16 v[112:115], a[156:159], a[100:103], v[112:115]
    v_mfma_f32_16x16x32_bf16 v[112:115], a[152:155], a[96:99], v[112:115]
    s_waitcnt lgkmcnt(4)
    v_mfma_f32_16x16x32_bf16 v[128:131], a[128:131], a[64:67], v[128:131]
    v_xor_b32 v41, 0x10000, v41
    ds_read_b64_tr_b16 a[144:145], v41 offset:32768
    v_mfma_f32_16x16x32_bf16 v[128:131], a[132:135], a[68:71], v[128:131]
    ds_read_b64_tr_b16 a[146:147], v41 offset:33792
    v_mfma_f32_16x16x32_bf16 v[132:135], a[132:135], a[76:79], v[132:135]
    ds_read_b64_tr_b16 a[148:149], v41 offset:40960
    v_mfma_f32_16x16x32_bf16 v[132:135], a[128:131], a[72:75], v[132:135]
    ds_read_b64_tr_b16 a[150:151], v41 offset:41984
    v_mfma_f32_16x16x32_bf16 v[136:139], a[128:131], a[80:83], v[136:139]
    buffer_load_dwordx4 v[2:5], v13, s[8:11], 0 offen
    v_mfma_f32_16x16x32_bf16 v[136:139], a[132:135], a[84:87], v[136:139]
    buffer_load_dwordx4 v[6:9], v13, s[8:11], 0 offen offset:512
    v_mfma_f32_16x16x32_bf16 v[140:143], a[132:135], a[92:95], v[140:143]
    v_mfma_f32_16x16x32_bf16 v[140:143], a[128:131], a[88:91], v[140:143]
    v_smfmac_f32_16x16x64_bf16 a[192:195], v[36:39], a[128:135], v35
    s_waitcnt lgkmcnt(4)
    v_mfma_f32_16x16x32_bf16 v[156:159], a[136:139], a[88:91], v[156:159]
    ds_read_b64_tr_b16 a[152:153], v41 offset:32776
    v_mfma_f32_16x16x32_bf16 v[156:159], a[140:143], a[92:95], v[156:159]
    ds_read_b64_tr_b16 a[154:155], v41 offset:33800
    v_mfma_f32_16x16x32_bf16 v[152:155], a[140:143], a[84:87], v[152:155]
    ds_read_b64_tr_b16 a[156:157], v41 offset:40968
    v_mfma_f32_16x16x32_bf16 v[152:155], a[136:139], a[80:83], v[152:155]
    ds_read_b64_tr_b16 a[158:159], v41 offset:41992
    v_mfma_f32_16x16x32_bf16 v[148:151], a[136:139], a[72:75], v[148:151]
    buffer_load_dwordx2 v[10:11], v14, s[8:11], 0 offen offset:1024
    v_mfma_f32_16x16x32_bf16 v[148:151], a[140:143], a[76:79], v[148:151]
    s_add_u32 m0, s101, 65536
    s_mov_b32 s80, 512
    v_mfma_f32_16x16x32_bf16 v[144:147], a[140:143], a[68:71], v[144:147]
    buffer_load_dwordx4 v20, s[8:11], s80 offen offset:0 lds
    v_mfma_f32_16x16x32_bf16 v[144:147], a[136:139], a[64:67], v[144:147]
    v_smfmac_f32_16x16x64_bf16 a[196:199], v[36:39], a[136:143], v35
    s_waitcnt lgkmcnt(4)
    v_mfma_f32_16x16x32_bf16 v[160:163], a[144:147], a[64:67], v[160:163]
    v_xor_b32 v42, 0x10000, v42
    ds_read_b64_tr_b16 a[128:129], v42 offset:32768
    v_mfma_f32_16x16x32_bf16 v[160:163], a[148:151], a[68:71], v[160:163]
    ds_read_b64_tr_b16 a[130:131], v42 offset:33792
    v_mfma_f32_16x16x32_bf16 v[164:167], a[148:151], a[76:79], v[164:167]
    ds_read_b64_tr_b16 a[132:133], v42 offset:40960
    v_mfma_f32_16x16x32_bf16 v[164:167], a[144:147], a[72:75], v[164:167]
    ds_read_b64_tr_b16 a[134:135], v42 offset:41984
    v_mfma_f32_16x16x32_bf16 v[168:171], a[144:147], a[80:83], v[168:171]
    buffer_load_dwordx4 v21, s[8:11], s80 offen offset:1024 lds
    v_mfma_f32_16x16x32_bf16 v[168:171], a[148:151], a[84:87], v[168:171]
    buffer_load_dwordx4 v22, s[8:11], s80 offen offset:2048 lds
    v_mfma_f32_16x16x32_bf16 v[172:175], a[148:151], a[92:95], v[172:175]
    v_mfma_f32_16x16x32_bf16 v[172:175], a[144:147], a[88:91], v[172:175]
    s_waitcnt lgkmcnt(4)
    v_mfma_f32_16x16x32_bf16 v[188:191], a[152:155], a[88:91], v[188:191]
    ds_read_b64_tr_b16 a[136:137], v42 offset:32776
    v_mfma_f32_16x16x32_bf16 v[188:191], a[156:159], a[92:95], v[188:191]
    ds_read_b64_tr_b16 a[138:139], v42 offset:33800
    v_mfma_f32_16x16x32_bf16 v[184:187], a[156:159], a[84:87], v[184:187]
    ds_read_b64_tr_b16 a[140:141], v42 offset:40968
    v_mfma_f32_16x16x32_bf16 v[184:187], a[152:155], a[80:83], v[184:187]
    ds_read_b64_tr_b16 a[142:143], v42 offset:41992
    v_mfma_f32_16x16x32_bf16 v[180:183], a[152:155], a[72:75], v[180:183]
    buffer_load_dwordx4 v23, s[8:11], s80 offen offset:3072 lds
    v_mfma_f32_16x16x32_bf16 v[180:183], a[156:159], a[76:79], v[180:183]
    s_add_u32 m0, s101, 69632
    s_mov_b32 s80, 41472
    v_mfma_f32_16x16x32_bf16 v[176:179], a[156:159], a[68:71], v[176:179]
    buffer_load_dwordx4 v20, s[8:11], s80 offen offset:0 lds
    v_mfma_f32_16x16x32_bf16 v[176:179], a[152:155], a[64:67], v[176:179]
    s_waitcnt lgkmcnt(4)
    v_mfma_f32_16x16x32_bf16 v[192:195], a[128:131], a[64:67], v[192:195]
    v_xor_b32 v43, 0x10000, v43
    ds_read_b64_tr_b16 a[144:145], v43 offset:32768
    v_mfma_f32_16x16x32_bf16 v[192:195], a[132:135], a[68:71], v[192:195]
    ds_read_b64_tr_b16 a[146:147], v43 offset:33792
    v_mfma_f32_16x16x32_bf16 v[196:199], a[132:135], a[76:79], v[196:199]
    ds_read_b64_tr_b16 a[148:149], v43 offset:40960
    v_mfma_f32_16x16x32_bf16 v[196:199], a[128:131], a[72:75], v[196:199]
    ds_read_b64_tr_b16 a[150:151], v43 offset:41984
    v_mfma_f32_16x16x32_bf16 v[200:203], a[128:131], a[80:83], v[200:203]
    buffer_load_dwordx4 v21, s[8:11], s80 offen offset:1024 lds
    v_mfma_f32_16x16x32_bf16 v[200:203], a[132:135], a[84:87], v[200:203]
    buffer_load_dwordx4 v22, s[8:11], s80 offen offset:2048 lds
    v_mfma_f32_16x16x32_bf16 v[204:207], a[132:135], a[92:95], v[204:207]
    v_mfma_f32_16x16x32_bf16 v[204:207], a[128:131], a[88:91], v[204:207]
    s_waitcnt lgkmcnt(4)
    v_mfma_f32_16x16x32_bf16 v[220:223], a[136:139], a[88:91], v[220:223]
    ds_read_b64_tr_b16 a[152:153], v43 offset:32776
    v_mfma_f32_16x16x32_bf16 v[220:223], a[140:143], a[92:95], v[220:223]
    ds_read_b64_tr_b16 a[154:155], v43 offset:33800
    v_mfma_f32_16x16x32_bf16 v[216:219], a[140:143], a[84:87], v[216:219]
    ds_read_b64_tr_b16 a[156:157], v43 offset:40968
    v_mfma_f32_16x16x32_bf16 v[216:219], a[136:139], a[80:83], v[216:219]
    ds_read_b64_tr_b16 a[158:159], v43 offset:41992
    v_mfma_f32_16x16x32_bf16 v[212:215], a[136:139], a[72:75], v[212:215]
    buffer_load_dwordx4 v23, s[8:11], s80 offen offset:3072 lds
    v_mfma_f32_16x16x32_bf16 v[212:215], a[140:143], a[76:79], v[212:215]
    s_add_u32 m0, s79, 114688
    s_mov_b32 s80, 2097152
    v_mfma_f32_16x16x32_bf16 v[208:211], a[140:143], a[68:71], v[208:211]
    v_mfma_f32_16x16x32_bf16 v[208:211], a[136:139], a[64:67], v[208:211]
    s_waitcnt lgkmcnt(4)
    v_mfma_f32_16x16x32_bf16 v[224:227], a[144:147], a[64:67], v[224:227]
    ds_read_b64_tr_b16 a[128:129], v48 offset:16384
    v_mfma_f32_16x16x32_bf16 v[224:227], a[148:151], a[68:71], v[224:227]
    ds_read_b64_tr_b16 a[130:131], v48 offset:16896
    v_mfma_f32_16x16x32_bf16 v[228:231], a[148:151], a[76:79], v[228:231]
    ds_read_b64_tr_b16 a[132:133], v48 offset:20480
    v_mfma_f32_16x16x32_bf16 v[228:231], a[144:147], a[72:75], v[228:231]
    ds_read_b64_tr_b16 a[134:135], v48 offset:20992
    v_mfma_f32_16x16x32_bf16 v[232:235], a[144:147], a[80:83], v[232:235]
    buffer_load_dwordx4 v52, s[12:15], s80 offen offset:0 lds
    v_mfma_f32_16x16x32_bf16 v[232:235], a[148:151], a[84:87], v[232:235]
    v_mfma_f32_16x16x32_bf16 v[236:239], a[148:151], a[92:95], v[236:239]
    v_mfma_f32_16x16x32_bf16 v[236:239], a[144:147], a[88:91], v[236:239]
    s_waitcnt lgkmcnt(4)
    v_mfma_f32_16x16x32_bf16 v[252:255], a[152:155], a[88:91], v[252:255]
    ds_read_b64_tr_b16 a[136:137], v49 offset:16384
    v_mfma_f32_16x16x32_bf16 v[252:255], a[156:159], a[92:95], v[252:255]
    ds_read_b64_tr_b16 a[138:139], v49 offset:16896
    v_mfma_f32_16x16x32_bf16 v[248:251], a[156:159], a[84:87], v[248:251]
    ds_read_b64_tr_b16 a[140:141], v49 offset:20480
    v_mfma_f32_16x16x32_bf16 v[248:251], a[152:155], a[80:83], v[248:251]
    ds_read_b64_tr_b16 a[142:143], v49 offset:20992
    v_mfma_f32_16x16x32_bf16 v[244:247], a[152:155], a[72:75], v[244:247]
    buffer_load_dwordx4 v53, s[12:15], s80 offen offset:1024 lds
    v_mfma_f32_16x16x32_bf16 v[244:247], a[156:159], a[76:79], v[244:247]
    v_mfma_f32_16x16x32_bf16 v[240:243], a[156:159], a[68:71], v[240:243]
    v_mfma_f32_16x16x32_bf16 v[240:243], a[152:155], a[64:67], v[240:243]
    s_waitcnt lgkmcnt(4)
    v_mfma_f32_16x16x32_bf16 v[64:67], a[128:131], a[64:67], v[64:67]
    s_waitcnt vmcnt(20)
    ds_read_b64_tr_b16 a[144:145], v50 offset:16384
    ds_read_b128 a[96:99], v24 offset:0
    v_mfma_f32_16x16x32_bf16 v[64:67], a[132:135], a[68:71], v[64:67]
    ds_read_b64_tr_b16 a[146:147], v50 offset:16896
    ds_read_b128 a[100:103], v25 offset:0
    v_mfma_f32_16x16x32_bf16 v[68:71], a[132:135], a[76:79], v[68:71]
    ds_read_b64_tr_b16 a[148:149], v50 offset:20480
    ds_read_b128 a[104:107], v24 offset:2048
    v_mfma_f32_16x16x32_bf16 v[68:71], a[128:131], a[72:75], v[68:71]
    ds_read_b64_tr_b16 a[150:151], v50 offset:20992
    ds_read_b128 a[108:111], v25 offset:2048
    v_mfma_f32_16x16x32_bf16 v[72:75], a[128:131], a[80:83], v[72:75]
    ds_read_b128 a[112:115], v24 offset:4096
    ds_read_b128 a[116:119], v25 offset:4096
    v_mfma_f32_16x16x32_bf16 v[72:75], a[132:135], a[84:87], v[72:75]
    ds_read_b128 a[120:123], v24 offset:6144
    ds_read_b128 a[124:127], v25 offset:6144
    v_mfma_f32_16x16x32_bf16 v[76:79], a[132:135], a[92:95], v[76:79]
    buffer_load_dwordx4 v54, s[12:15], s80 offen offset:2048 lds
    v_mfma_f32_16x16x32_bf16 v[76:79], a[128:131], a[88:91], v[76:79]
    v_xor_b32 v24, 0x10000, v24
    v_xor_b32 v25, 0x10000, v25
    v_smfmac_f32_16x16x64_bf16 a[200:203], v[36:39], a[128:135], v35
    s_waitcnt lgkmcnt(12)
    v_mfma_f32_16x16x32_bf16 v[92:95], a[136:139], a[88:91], v[92:95]
    ds_read_b64_tr_b16 a[152:153], v51 offset:16384
    v_mfma_f32_16x16x32_bf16 v[92:95], a[140:143], a[92:95], v[92:95]
    ds_read_b64_tr_b16 a[154:155], v51 offset:16896
    v_mfma_f32_16x16x32_bf16 v[88:91], a[140:143], a[84:87], v[88:91]
    ds_read_b64_tr_b16 a[156:157], v51 offset:20480
    v_mfma_f32_16x16x32_bf16 v[88:91], a[136:139], a[80:83], v[88:91]
    ds_read_b64_tr_b16 a[158:159], v51 offset:20992
    v_mfma_f32_16x16x32_bf16 v[84:87], a[136:139], a[72:75], v[84:87]
    buffer_load_dwordx4 v55, s[12:15], s80 offen offset:3072 lds
    v_mfma_f32_16x16x32_bf16 v[84:87], a[140:143], a[76:79], v[84:87]
    s_add_u32 m0, s100, 131072
    s_mov_b32 s80, 884736
    v_mfma_f32_16x16x32_bf16 v[80:83], a[140:143], a[68:71], v[80:83]
    v_mfma_f32_16x16x32_bf16 v[80:83], a[136:139], a[64:67], v[80:83]
    v_smfmac_f32_16x16x64_bf16 a[204:207], v[36:39], a[136:143], v35
    s_waitcnt lgkmcnt(9)
    v_mfma_f32_16x16x32_bf16 v[96:99], a[144:147], a[64:67], v[96:99]
    s_waitcnt vmcnt(16)
    s_barrier
    v_mfma_f32_16x16x32_bf16 v[96:99], a[148:151], a[68:71], v[96:99]
    ds_read_b64_tr_b16 a[128:129], v40 offset:49152
    v_mfma_f32_16x16x32_bf16 v[100:103], a[148:151], a[76:79], v[100:103]
    ds_read_b64_tr_b16 a[130:131], v40 offset:50176
    v_mfma_f32_16x16x32_bf16 v[100:103], a[144:147], a[72:75], v[100:103]
    ds_read_b64_tr_b16 a[132:133], v40 offset:57344
    v_mfma_f32_16x16x32_bf16 v[104:107], a[144:147], a[80:83], v[104:107]
    ds_read_b64_tr_b16 a[134:135], v40 offset:58368
    v_mfma_f32_16x16x32_bf16 v[104:107], a[148:151], a[84:87], v[104:107]
    buffer_load_dwordx4 v56, s[16:19], s80 offen offset:0 lds
    v_mfma_f32_16x16x32_bf16 v[108:111], a[148:151], a[92:95], v[108:111]
    v_mfma_f32_16x16x32_bf16 v[108:111], a[144:147], a[88:91], v[108:111]
    s_waitcnt lgkmcnt(4)
    v_mfma_f32_16x16x32_bf16 v[124:127], a[152:155], a[88:91], v[124:127]
    ds_read_b64_tr_b16 a[136:137], v40 offset:49160
    v_mfma_f32_16x16x32_bf16 v[124:127], a[156:159], a[92:95], v[124:127]
    ds_read_b64_tr_b16 a[138:139], v40 offset:50184
    v_mfma_f32_16x16x32_bf16 v[120:123], a[156:159], a[84:87], v[120:123]
    ds_read_b64_tr_b16 a[140:141], v40 offset:57352
    v_mfma_f32_16x16x32_bf16 v[120:123], a[152:155], a[80:83], v[120:123]
    ds_read_b64_tr_b16 a[142:143], v40 offset:58376
    v_mfma_f32_16x16x32_bf16 v[116:119], a[152:155], a[72:75], v[116:119]
    buffer_load_dwordx4 v57, s[16:19], s80 offen offset:1024 lds
    v_mfma_f32_16x16x32_bf16 v[116:119], a[156:159], a[76:79], v[116:119]
    v_mfma_f32_16x16x32_bf16 v[112:115], a[156:159], a[68:71], v[112:115]
    v_mfma_f32_16x16x32_bf16 v[112:115], a[152:155], a[64:67], v[112:115]
    s_waitcnt lgkmcnt(4)
    v_mfma_f32_16x16x32_bf16 v[128:131], a[128:131], a[96:99], v[128:131]
    s_add_u32 m0, s101, 0
    ds_read_b64_tr_b16 a[144:145], v41 offset:49152
    s_mov_b32 s80, 640
    v_mfma_f32_16x16x32_bf16 v[128:131], a[132:135], a[100:103], v[128:131]
    s_waitcnt vmcnt(14)
    ds_read_b64_tr_b16 a[146:147], v41 offset:50176
    v_lshlrev_b32 v12, 16, v2
    v_mfma_f32_16x16x32_bf16 v[132:135], a[132:135], a[108:111], v[132:135]
    ds_read_b64_tr_b16 a[148:149], v41 offset:57344
    v_and_b32 v13, 0xffff0000, v2
    v_mfma_f32_16x16x32_bf16 v[132:135], a[128:131], a[104:107], v[132:135]
    ds_read_b64_tr_b16 a[150:151], v41 offset:58368
    v_mfma_f32_16x16x32_bf16 v[136:139], a[128:131], a[112:115], v[136:139]
    buffer_load_dwordx4 v20, s[8:11], s80 offen offset:0 lds
    v_mfma_f32_16x16x32_bf16 v[136:139], a[132:135], a[116:119], v[136:139]
    buffer_load_dwordx4 v21, s[8:11], s80 offen offset:1024 lds
    v_mfma_f32_16x16x32_bf16 v[140:143], a[132:135], a[124:127], v[140:143]
    v_lshlrev_b32 v14, 16, v3
    v_and_b32 v15, 0xffff0000, v3
    v_mfma_f32_16x16x32_bf16 v[140:143], a[128:131], a[120:123], v[140:143]
    v_add_f32 v12, v12, v14
    v_add_f32 v13, v13, v15
    v_smfmac_f32_16x16x64_bf16 a[192:195], v[36:39], a[128:135], v35
    s_waitcnt lgkmcnt(4)
    v_lshlrev_b32 v14, 16, v4
    v_and_b32 v15, 0xffff0000, v4
    v_mfma_f32_16x16x32_bf16 v[156:159], a[136:139], a[120:123], v[156:159]
    ds_read_b64_tr_b16 a[152:153], v41 offset:49160
    v_add_f32 v12, v12, v14
    v_mfma_f32_16x16x32_bf16 v[156:159], a[140:143], a[124:127], v[156:159]
    ds_read_b64_tr_b16 a[154:155], v41 offset:50184
    v_add_f32 v13, v13, v15
    v_mfma_f32_16x16x32_bf16 v[152:155], a[140:143], a[116:119], v[152:155]
    ds_read_b64_tr_b16 a[156:157], v41 offset:57352
    v_lshlrev_b32 v14, 16, v5
    v_mfma_f32_16x16x32_bf16 v[152:155], a[136:139], a[112:115], v[152:155]
    ds_read_b64_tr_b16 a[158:159], v41 offset:58376
    v_mfma_f32_16x16x32_bf16 v[148:151], a[136:139], a[104:107], v[148:151]
    buffer_load_dwordx4 v22, s[8:11], s80 offen offset:2048 lds
    v_mfma_f32_16x16x32_bf16 v[148:151], a[140:143], a[108:111], v[148:151]
    buffer_load_dwordx4 v23, s[8:11], s80 offen offset:3072 lds
    v_mfma_f32_16x16x32_bf16 v[144:147], a[140:143], a[100:103], v[144:147]
    s_add_u32 m0, s101, 4096
    s_mov_b32 s80, 41600
    v_and_b32 v15, 0xffff0000, v5
    v_mfma_f32_16x16x32_bf16 v[144:147], a[136:139], a[96:99], v[144:147]
    v_add_f32 v12, v12, v14
    v_add_f32 v13, v13, v15
    v_smfmac_f32_16x16x64_bf16 a[196:199], v[36:39], a[136:143], v35
    s_waitcnt lgkmcnt(4)
    v_lshlrev_b32 v14, 16, v6
    v_and_b32 v15, 0xffff0000, v6
    v_mfma_f32_16x16x32_bf16 v[160:163], a[144:147], a[96:99], v[160:163]
    ds_read_b64_tr_b16 a[128:129], v42 offset:49152
    v_add_f32 v12, v12, v14
    v_mfma_f32_16x16x32_bf16 v[160:163], a[148:151], a[100:103], v[160:163]
    ds_read_b64_tr_b16 a[130:131], v42 offset:50176
    v_add_f32 v13, v13, v15
    v_mfma_f32_16x16x32_bf16 v[164:167], a[148:151], a[108:111], v[164:167]
    ds_read_b64_tr_b16 a[132:133], v42 offset:57344
    v_lshlrev_b32 v14, 16, v7
    v_mfma_f32_16x16x32_bf16 v[164:167], a[144:147], a[104:107], v[164:167]
    ds_read_b64_tr_b16 a[134:135], v42 offset:58368
    v_mfma_f32_16x16x32_bf16 v[168:171], a[144:147], a[112:115], v[168:171]
    buffer_load_dwordx4 v20, s[8:11], s80 offen offset:0 lds
    v_mfma_f32_16x16x32_bf16 v[168:171], a[148:151], a[116:119], v[168:171]
    v_and_b32 v15, 0xffff0000, v7
    v_add_f32 v12, v12, v14
    v_mfma_f32_16x16x32_bf16 v[172:175], a[148:151], a[124:127], v[172:175]
    v_add_f32 v13, v13, v15
    v_lshlrev_b32 v14, 16, v8
    v_mfma_f32_16x16x32_bf16 v[172:175], a[144:147], a[120:123], v[172:175]
    s_waitcnt lgkmcnt(4)
    v_and_b32 v15, 0xffff0000, v8
    v_add_f32 v12, v12, v14
    v_mfma_f32_16x16x32_bf16 v[188:191], a[152:155], a[120:123], v[188:191]
    ds_read_b64_tr_b16 a[136:137], v42 offset:49160
    v_add_f32 v13, v13, v15
    v_mfma_f32_16x16x32_bf16 v[188:191], a[156:159], a[124:127], v[188:191]
    ds_read_b64_tr_b16 a[138:139], v42 offset:50184
    v_lshlrev_b32 v14, 16, v9
    v_mfma_f32_16x16x32_bf16 v[184:187], a[156:159], a[116:119], v[184:187]
    ds_read_b64_tr_b16 a[140:141], v42 offset:57352
    v_and_b32 v15, 0xffff0000, v9
    v_mfma_f32_16x16x32_bf16 v[184:187], a[152:155], a[112:115], v[184:187]
    ds_read_b64_tr_b16 a[142:143], v42 offset:58376
    v_mfma_f32_16x16x32_bf16 v[180:183], a[152:155], a[104:107], v[180:183]
    buffer_load_dwordx4 v21, s[8:11], s80 offen offset:1024 lds
    v_mfma_f32_16x16x32_bf16 v[180:183], a[156:159], a[108:111], v[180:183]
    v_add_f32 v12, v12, v14
    v_add_f32 v13, v13, v15
    v_mfma_f32_16x16x32_bf16 v[176:179], a[156:159], a[100:103], v[176:179]
    v_lshlrev_b32 v14, 16, v10
    v_and_b32 v15, 0xffff0000, v10
    v_mfma_f32_16x16x32_bf16 v[176:179], a[152:155], a[96:99], v[176:179]
    s_waitcnt lgkmcnt(4)
    v_add_f32 v12, v12, v14
    v_add_f32 v13, v13, v15
    v_mfma_f32_16x16x32_bf16 v[192:195], a[128:131], a[96:99], v[192:195]
    ds_read_b64_tr_b16 a[144:145], v43 offset:49152
    v_lshlrev_b32 v14, 16, v11
    v_mfma_f32_16x16x32_bf16 v[192:195], a[132:135], a[100:103], v[192:195]
    ds_read_b64_tr_b16 a[146:147], v43 offset:50176
    v_and_b32 v15, 0xffff0000, v11
    v_mfma_f32_16x16x32_bf16 v[196:199], a[132:135], a[108:111], v[196:199]
    ds_read_b64_tr_b16 a[148:149], v43 offset:57344
    v_add_f32 v12, v12, v14
    v_mfma_f32_16x16x32_bf16 v[196:199], a[128:131], a[104:107], v[196:199]
    ds_read_b64_tr_b16 a[150:151], v43 offset:58368
    v_mfma_f32_16x16x32_bf16 v[200:203], a[128:131], a[112:115], v[200:203]
    buffer_load_dwordx4 v22, s[8:11], s80 offen offset:2048 lds
    v_mfma_f32_16x16x32_bf16 v[200:203], a[132:135], a[116:119], v[200:203]
    v_add_f32 v13, v13, v15
    v_add_f32 v12, v12, v13
    v_mfma_f32_16x16x32_bf16 v[204:207], a[132:135], a[124:127], v[204:207]
    v_mfma_f32_16x16x32_bf16 v[204:207], a[128:131], a[120:123], v[204:207]
    s_waitcnt lgkmcnt(4)
    v_add_f32_dpp v12, v12, v12 row_ror:8 row_mask:0xf bank_mask:0xf
    v_mfma_f32_16x16x32_bf16 v[220:223], a[136:139], a[120:123], v[220:223]
    ds_read_b64_tr_b16 a[152:153], v43 offset:49160
    v_add_f32_dpp v12, v12, v12 row_ror:4 row_mask:0xf bank_mask:0xf
    v_mfma_f32_16x16x32_bf16 v[220:223], a[140:143], a[124:127], v[220:223]
    ds_read_b64_tr_b16 a[154:155], v43 offset:50184
    v_add_f32_dpp v12, v12, v12 row_ror:2 row_mask:0xf bank_mask:0xf
    v_mfma_f32_16x16x32_bf16 v[216:219], a[140:143], a[116:119], v[216:219]
    ds_read_b64_tr_b16 a[156:157], v43 offset:57352
    v_add_f32_dpp v12, v12, v12 row_ror:1 row_mask:0xf bank_mask:0xf
    v_mfma_f32_16x16x32_bf16 v[216:219], a[136:139], a[112:115], v[216:219]
    ds_read_b64_tr_b16 a[158:159], v43 offset:58376
    v_mfma_f32_16x16x32_bf16 v[212:215], a[136:139], a[104:107], v[212:215]
    buffer_load_dwordx4 v23, s[8:11], s80 offen offset:3072 lds
    v_mfma_f32_16x16x32_bf16 v[212:215], a[140:143], a[108:111], v[212:215]
    s_add_u32 m0, s79, 98304
    s_mov_b32 s80, 2621440
    v_mov_b32 v13, v12
    v_mfma_f32_16x16x32_bf16 v[208:211], a[140:143], a[100:103], v[208:211]
    v_mfma_f32_16x16x32_bf16 v[208:211], a[136:139], a[96:99], v[208:211]
    s_waitcnt lgkmcnt(4)
    v_permlane16_swap_b32 v12, v13
    v_mfma_f32_16x16x32_bf16 v[224:227], a[144:147], a[96:99], v[224:227]
    ds_read_b64_tr_b16 a[128:129], v48 offset:24576
    v_add_f32 v12, v12, v13
    v_mfma_f32_16x16x32_bf16 v[224:227], a[148:151], a[100:103], v[224:227]
    ds_read_b64_tr_b16 a[130:131], v48 offset:25088
    v_mul_f32 v12, 0x3acccccd, v12
    v_mfma_f32_16x16x32_bf16 v[228:231], a[148:151], a[108:111], v[228:231]
    ds_read_b64_tr_b16 a[132:133], v48 offset:28672
    v_mov_b32 v16, v12
    v_mfma_f32_16x16x32_bf16 v[228:231], a[144:147], a[104:107], v[228:231]
    ds_read_b64_tr_b16 a[134:135], v48 offset:29184
    v_mfma_f32_16x16x32_bf16 v[232:235], a[144:147], a[112:115], v[232:235]
    buffer_load_dwordx4 v52, s[12:15], s80 offen offset:0 lds
    v_mfma_f32_16x16x32_bf16 v[232:235], a[148:151], a[116:119], v[232:235]
    v_lshlrev_b32 v14, 16, v2
    v_and_b32 v15, 0xffff0000, v2
    v_mfma_f32_16x16x32_bf16 v[236:239], a[148:151], a[124:127], v[236:239]
    v_sub_f32 v14, v14, v16
    v_sub_f32 v15, v15, v16
    v_mfma_f32_16x16x32_bf16 v[236:239], a[144:147], a[120:123], v[236:239]
    s_waitcnt lgkmcnt(4)
    v_mul_f32 v12, v14, v14
    v_mul_f32 v13, v15, v15
    v_mfma_f32_16x16x32_bf16 v[252:255], a[152:155], a[120:123], v[252:255]
    ds_read_b64_tr_b16 a[136:137], v49 offset:24576
    v_lshlrev_b32 v14, 16, v3
    v_mfma_f32_16x16x32_bf16 v[252:255], a[156:159], a[124:127], v[252:255]
    ds_read_b64_tr_b16 a[138:139], v49 offset:25088
    v_and_b32 v15, 0xffff0000, v3
    v_mfma_f32_16x16x32_bf16 v[248:251], a[156:159], a[116:119], v[248:251]
    ds_read_b64_tr_b16 a[140:141], v49 offset:28672
    v_sub_f32 v14, v14, v16
    v_mfma_f32_16x16x32_bf16 v[248:251], a[152:155], a[112:115], v[248:251]
    ds_read_b64_tr_b16 a[142:143], v49 offset:29184
    v_mfma_f32_16x16x32_bf16 v[244:247], a[152:155], a[104:107], v[244:247]
    buffer_load_dwordx4 v53, s[12:15], s80 offen offset:1024 lds
    v_mfma_f32_16x16x32_bf16 v[244:247], a[156:159], a[108:111], v[244:247]
    v_sub_f32 v15, v15, v16
    v_fmac_f32 v12, v14, v14
    v_mfma_f32_16x16x32_bf16 v[240:243], a[156:159], a[100:103], v[240:243]
    v_fmac_f32 v13, v15, v15
    v_lshlrev_b32 v14, 16, v4
    v_mfma_f32_16x16x32_bf16 v[240:243], a[152:155], a[96:99], v[240:243]
    s_waitcnt lgkmcnt(4)
    v_and_b32 v15, 0xffff0000, v4
    v_sub_f32 v14, v14, v16
    v_mfma_f32_16x16x32_bf16 v[64:67], a[128:131], a[96:99], v[64:67]
    s_waitcnt vmcnt(16)
    ds_read_b64_tr_b16 a[144:145], v50 offset:24576
    ds_read_b128 a[64:67], v24 offset:0
    v_mfma_f32_16x16x32_bf16 v[64:67], a[132:135], a[100:103], v[64:67]
    ds_read_b64_tr_b16 a[146:147], v50 offset:25088
    ds_read_b128 a[68:71], v25 offset:0
    v_mfma_f32_16x16x32_bf16 v[68:71], a[132:135], a[108:111], v[68:71]
    ds_read_b64_tr_b16 a[148:149], v50 offset:28672
    ds_read_b128 a[72:75], v24 offset:2048
    v_mfma_f32_16x16x32_bf16 v[68:71], a[128:131], a[104:107], v[68:71]
    ds_read_b64_tr_b16 a[150:151], v50 offset:29184
    ds_read_b128 a[76:79], v25 offset:2048
    v_mfma_f32_16x16x32_bf16 v[72:75], a[128:131], a[112:115], v[72:75]
    ds_read_b128 a[80:83], v24 offset:4096
    ds_read_b128 a[84:87], v25 offset:4096
    v_mfma_f32_16x16x32_bf16 v[72:75], a[132:135], a[116:119], v[72:75]
    ds_read_b128 a[88:91], v24 offset:6144
    ds_read_b128 a[92:95], v25 offset:6144
    v_mfma_f32_16x16x32_bf16 v[76:79], a[132:135], a[124:127], v[76:79]
    buffer_load_dwordx4 v54, s[12:15], s80 offen offset:2048 lds
    v_mfma_f32_16x16x32_bf16 v[76:79], a[128:131], a[120:123], v[76:79]
    v_xor_b32 v24, 0x10000, v24
    v_xor_b32 v25, 0x10000, v25
    v_smfmac_f32_16x16x64_bf16 a[200:203], v[36:39], a[128:135], v35
    s_waitcnt lgkmcnt(12)
    v_sub_f32 v15, v15, v16
    v_fmac_f32 v12, v14, v14
    v_mfma_f32_16x16x32_bf16 v[92:95], a[136:139], a[120:123], v[92:95]
    ds_read_b64_tr_b16 a[152:153], v51 offset:24576
    v_fmac_f32 v13, v15, v15
    v_mfma_f32_16x16x32_bf16 v[92:95], a[140:143], a[124:127], v[92:95]
    ds_read_b64_tr_b16 a[154:155], v51 offset:25088
    v_lshlrev_b32 v14, 16, v5
    v_mfma_f32_16x16x32_bf16 v[88:91], a[140:143], a[116:119], v[88:91]
    ds_read_b64_tr_b16 a[156:157], v51 offset:28672
    v_and_b32 v15, 0xffff0000, v5
    v_mfma_f32_16x16x32_bf16 v[88:91], a[136:139], a[112:115], v[88:91]
    ds_read_b64_tr_b16 a[158:159], v51 offset:29184
    v_mfma_f32_16x16x32_bf16 v[84:87], a[136:139], a[104:107], v[84:87]
    buffer_load_dwordx4 v55, s[12:15], s80 offen offset:3072 lds
    v_mfma_f32_16x16x32_bf16 v[84:87], a[140:143], a[108:111], v[84:87]
    s_add_u32 m0, s100, 139264
    s_mov_b32 s80, 1105920
    v_sub_f32 v14, v14, v16
    v_mfma_f32_16x16x32_bf16 v[80:83], a[140:143], a[100:103], v[80:83]
    v_sub_f32 v15, v15, v16
    v_fmac_f32 v12, v14, v14
    v_mfma_f32_16x16x32_bf16 v[80:83], a[136:139], a[96:99], v[80:83]
    v_fmac_f32 v13, v15, v15
    v_lshlrev_b32 v14, 16, v6
    v_smfmac_f32_16x16x64_bf16 a[204:207], v[36:39], a[136:143], v35
    s_waitcnt lgkmcnt(9)
    v_and_b32 v15, 0xffff0000, v6
    v_sub_f32 v14, v14, v16
    v_mfma_f32_16x16x32_bf16 v[96:99], a[144:147], a[96:99], v[96:99]
    s_waitcnt vmcnt(12)
    s_barrier
    v_sub_f32 v15, v15, v16
    v_mfma_f32_16x16x32_bf16 v[96:99], a[148:151], a[100:103], v[96:99]
    v_xor_b32 v40, 0x10000, v40
    ds_read_b64_tr_b16 a[128:129], v40 offset:49152
    v_mfma_f32_16x16x32_bf16 v[100:103], a[148:151], a[108:111], v[100:103]
    ds_read_b64_tr_b16 a[130:131], v40 offset:50176
    v_fmac_f32 v12, v14, v14
    v_mfma_f32_16x16x32_bf16 v[100:103], a[144:147], a[104:107], v[100:103]
    ds_read_b64_tr_b16 a[132:133], v40 offset:57344
    v_fmac_f32 v13, v15, v15
    v_mfma_f32_16x16x32_bf16 v[104:107], a[144:147], a[112:115], v[104:107]
    ds_read_b64_tr_b16 a[134:135], v40 offset:58368
    v_mfma_f32_16x16x32_bf16 v[104:107], a[148:151], a[116:119], v[104:107]
    buffer_load_dwordx4 v56, s[16:19], s80 offen offset:0 lds
    v_mfma_f32_16x16x32_bf16 v[108:111], a[148:151], a[124:127], v[108:111]
    v_lshlrev_b32 v14, 16, v7
    v_and_b32 v15, 0xffff0000, v7
    v_mfma_f32_16x16x32_bf16 v[108:111], a[144:147], a[120:123], v[108:111]
    s_waitcnt lgkmcnt(4)
    v_sub_f32 v14, v14, v16
    v_sub_f32 v15, v15, v16
    v_mfma_f32_16x16x32_bf16 v[124:127], a[152:155], a[120:123], v[124:127]
    ds_read_b64_tr_b16 a[136:137], v40 offset:49160
    v_fmac_f32 v12, v14, v14
    v_mfma_f32_16x16x32_bf16 v[124:127], a[156:159], a[124:127], v[124:127]
    ds_read_b64_tr_b16 a[138:139], v40 offset:50184
    v_fmac_f32 v13, v15, v15
    v_mfma_f32_16x16x32_bf16 v[120:123], a[156:159], a[116:119], v[120:123]
    ds_read_b64_tr_b16 a[140:141], v40 offset:57352
    v_lshlrev_b32 v14, 16, v8
    v_mfma_f32_16x16x32_bf16 v[120:123], a[152:155], a[112:115], v[120:123]
    ds_read_b64_tr_b16 a[142:143], v40 offset:58376
    v_mfma_f32_16x16x32_bf16 v[116:119], a[152:155], a[104:107], v[116:119]
    buffer_load_dwordx4 v57, s[16:19], s80 offen offset:1024 lds
    v_mfma_f32_16x16x32_bf16 v[116:119], a[156:159], a[108:111], v[116:119]
    v_and_b32 v15, 0xffff0000, v8
    v_sub_f32 v14, v14, v16
    v_mfma_f32_16x16x32_bf16 v[112:115], a[156:159], a[100:103], v[112:115]
    v_sub_f32 v15, v15, v16
    v_fmac_f32 v12, v14, v14
    v_mfma_f32_16x16x32_bf16 v[112:115], a[152:155], a[96:99], v[112:115]
    s_waitcnt lgkmcnt(4)
    v_fmac_f32 v13, v15, v15
    v_lshlrev_b32 v14, 16, v9
    v_mfma_f32_16x16x32_bf16 v[128:131], a[128:131], a[64:67], v[128:131]
    s_add_u32 m0, s101, 65536
    v_xor_b32 v41, 0x10000, v41
    ds_read_b64_tr_b16 a[144:145], v41 offset:49152
    v_mfma_f32_16x16x32_bf16 v[128:131], a[132:135], a[68:71], v[128:131]
    s_mov_b32 s80, 768
    ds_read_b64_tr_b16 a[146:147], v41 offset:50176
    v_and_b32 v15, 0xffff0000, v9
    v_mfma_f32_16x16x32_bf16 v[132:135], a[132:135], a[76:79], v[132:135]
    ds_read_b64_tr_b16 a[148:149], v41 offset:57344
    v_sub_f32 v14, v14, v16
    v_mfma_f32_16x16x32_bf16 v[132:135], a[128:131], a[72:75], v[132:135]
    ds_read_b64_tr_b16 a[150:151], v41 offset:58368
    v_mfma_f32_16x16x32_bf16 v[136:139], a[128:131], a[80:83], v[136:139]
    buffer_load_dwordx4 v20, s[8:11], s80 offen offset:0 lds
    v_mfma_f32_16x16x32_bf16 v[136:139], a[132:135], a[84:87], v[136:139]
    buffer_load_dwordx4 v21, s[8:11], s80 offen offset:1024 lds
    v_mfma_f32_16x16x32_bf16 v[140:143], a[132:135], a[92:95], v[140:143]
    v_sub_f32 v15, v15, v16
    v_fmac_f32 v12, v14, v14
    v_mfma_f32_16x16x32_bf16 v[140:143], a[128:131], a[88:91], v[140:143]
    v_fmac_f32 v13, v15, v15
    v_lshlrev_b32 v14, 16, v10
    v_smfmac_f32_16x16x64_bf16 a[192:195], v[36:39], a[128:135], v35
    s_waitcnt lgkmcnt(4)
    v_and_b32 v15, 0xffff0000, v10
    v_sub_f32 v14, v14, v16
    v_mfma_f32_16x16x32_bf16 v[156:159], a[136:139], a[88:91], v[156:159]
    ds_read_b64_tr_b16 a[152:153], v41 offset:49160
    v_sub_f32 v15, v15, v16
    v_mfma_f32_16x16x32_bf16 v[156:159], a[140:143], a[92:95], v[156:159]
    ds_read_b64_tr_b16 a[154:155], v41 offset:50184
    v_fmac_f32 v12, v14, v14
    v_mfma_f32_16x16x32_bf16 v[152:155], a[140:143], a[84:87], v[152:155]
    ds_read_b64_tr_b16 a[156:157], v41 offset:57352
    v_fmac_f32 v13, v15, v15
    v_mfma_f32_16x16x32_bf16 v[152:155], a[136:139], a[80:83], v[152:155]
    ds_read_b64_tr_b16 a[158:159], v41 offset:58376
    v_mfma_f32_16x16x32_bf16 v[148:151], a[136:139], a[72:75], v[148:151]
    buffer_load_dwordx4 v22, s[8:11], s80 offen offset:2048 lds
    v_mfma_f32_16x16x32_bf16 v[148:151], a[140:143], a[76:79], v[148:151]
    buffer_load_dwordx4 v23, s[8:11], s80 offen offset:3072 lds
    v_mfma_f32_16x16x32_bf16 v[144:147], a[140:143], a[68:71], v[144:147]
    s_add_u32 m0, s101, 69632
    s_mov_b32 s80, 41728
    v_lshlrev_b32 v14, 16, v11
    v_mfma_f32_16x16x32_bf16 v[144:147], a[136:139], a[64:67], v[144:147]
    v_and_b32 v15, 0xffff0000, v11
    v_sub_f32 v14, v14, v16
    v_smfmac_f32_16x16x64_bf16 a[196:199], v[36:39], a[136:143], v35
    s_waitcnt lgkmcnt(4)
    v_sub_f32 v15, v15, v16
    v_fmac_f32 v12, v14, v14
    v_mfma_f32_16x16x32_bf16 v[160:163], a[144:147], a[64:67], v[160:163]
    v_xor_b32 v42, 0x10000, v42
    ds_read_b64_tr_b16 a[128:129], v42 offset:49152
    v_mfma_f32_16x16x32_bf16 v[160:163], a[148:151], a[68:71], v[160:163]
    ds_read_b64_tr_b16 a[130:131], v42 offset:50176
    v_fmac_f32 v13, v15, v15
    v_mfma_f32_16x16x32_bf16 v[164:167], a[148:151], a[76:79], v[164:167]
    ds_read_b64_tr_b16 a[132:133], v42 offset:57344
    v_add_f32 v12, v12, v13
    v_mfma_f32_16x16x32_bf16 v[164:167], a[144:147], a[72:75], v[164:167]
    ds_read_b64_tr_b16 a[134:135], v42 offset:58368
    v_mfma_f32_16x16x32_bf16 v[168:171], a[144:147], a[80:83], v[168:171]
    buffer_load_dwordx4 v20, s[8:11], s80 offen offset:0 lds
    v_mfma_f32_16x16x32_bf16 v[168:171], a[148:151], a[84:87], v[168:171]
    v_add_f32_dpp v12, v12, v12 row_ror:8 row_mask:0xf bank_mask:0xf
    v_mfma_f32_16x16x32_bf16 v[172:175], a[148:151], a[92:95], v[172:175]
    v_mfma_f32_16x16x32_bf16 v[172:175], a[144:147], a[88:91], v[172:175]
    s_waitcnt lgkmcnt(4)
    v_add_f32_dpp v12, v12, v12 row_ror:4 row_mask:0xf bank_mask:0xf
    v_mfma_f32_16x16x32_bf16 v[188:191], a[152:155], a[88:91], v[188:191]
    ds_read_b64_tr_b16 a[136:137], v42 offset:49160
    v_add_f32_dpp v12, v12, v12 row_ror:2 row_mask:0xf bank_mask:0xf
    v_mfma_f32_16x16x32_bf16 v[188:191], a[156:159], a[92:95], v[188:191]
    ds_read_b64_tr_b16 a[138:139], v42 offset:50184
    v_add_f32_dpp v12, v12, v12 row_ror:1 row_mask:0xf bank_mask:0xf
    v_mfma_f32_16x16x32_bf16 v[184:187], a[156:159], a[84:87], v[184:187]
    ds_read_b64_tr_b16 a[140:141], v42 offset:57352
    v_mov_b32 v13, v12
    v_mfma_f32_16x16x32_bf16 v[184:187], a[152:155], a[80:83], v[184:187]
    ds_read_b64_tr_b16 a[142:143], v42 offset:58376
    v_mfma_f32_16x16x32_bf16 v[180:183], a[152:155], a[72:75], v[180:183]
    buffer_load_dwordx4 v21, s[8:11], s80 offen offset:1024 lds
    v_mfma_f32_16x16x32_bf16 v[180:183], a[156:159], a[76:79], v[180:183]
    v_permlane16_swap_b32 v12, v13
    v_mfma_f32_16x16x32_bf16 v[176:179], a[156:159], a[68:71], v[176:179]
    v_add_f32 v12, v12, v13
    v_mul_f32 v12, 0x3acccccd, v12
    v_mfma_f32_16x16x32_bf16 v[176:179], a[152:155], a[64:67], v[176:179]
    s_waitcnt lgkmcnt(4)
    v_cvt_pk_bf16_f32 v13, v12, v16
    v_and_b32 v16, 0xffff0000, v13
    v_mfma_f32_16x16x32_bf16 v[192:195], a[128:131], a[64:67], v[192:195]
    v_xor_b32 v43, 0x10000, v43
    ds_read_b64_tr_b16 a[144:145], v43 offset:49152
    v_mfma_f32_16x16x32_bf16 v[192:195], a[132:135], a[68:71], v[192:195]
    ds_read_b64_tr_b16 a[146:147], v43 offset:50176
    v_lshlrev_b32 v12, 16, v13
    v_mfma_f32_16x16x32_bf16 v[196:199], a[132:135], a[76:79], v[196:199]
    ds_read_b64_tr_b16 a[148:149], v43 offset:57344
    v_xor_b32 v16, 0x80000000, v16
    v_mfma_f32_16x16x32_bf16 v[196:199], a[128:131], a[72:75], v[196:199]
    ds_read_b64_tr_b16 a[150:151], v43 offset:58368
    v_mfma_f32_16x16x32_bf16 v[200:203], a[128:131], a[80:83], v[200:203]
    buffer_load_dwordx4 v22, s[8:11], s80 offen offset:2048 lds
    v_mfma_f32_16x16x32_bf16 v[200:203], a[132:135], a[84:87], v[200:203]
    buffer_load_dwordx4 v23, s[8:11], s80 offen offset:3072 lds
    v_mfma_f32_16x16x32_bf16 v[204:207], a[132:135], a[92:95], v[204:207]
    s_add_u32 m0, s79, 32768
    s_mov_b32 s80, 3145728
    v_add_f32 v12, 0x3727c5ac, v12
    v_mfma_f32_16x16x32_bf16 v[204:207], a[128:131], a[88:91], v[204:207]
    s_waitcnt lgkmcnt(4)
    v_cvt_pk_bf16_f32 v12, v12, v12
    v_lshlrev_b32 v12, 16, v12
    v_mfma_f32_16x16x32_bf16 v[220:223], a[136:139], a[88:91], v[220:223]
    ds_read_b64_tr_b16 a[152:153], v43 offset:49160
    v_mfma_f32_16x16x32_bf16 v[220:223], a[140:143], a[92:95], v[220:223]
    ds_read_b64_tr_b16 a[154:155], v43 offset:50184
    v_mfma_f32_16x16x32_bf16 v[216:219], a[140:143], a[84:87], v[216:219]
    ds_read_b64_tr_b16 a[156:157], v43 offset:57352
    v_mfma_f32_16x16x32_bf16 v[216:219], a[136:139], a[80:83], v[216:219]
    ds_read_b64_tr_b16 a[158:159], v43 offset:58376
    v_mfma_f32_16x16x32_bf16 v[212:215], a[136:139], a[72:75], v[212:215]
    buffer_load_dwordx4 v52, s[12:15], s80 offen offset:0 lds
    v_mfma_f32_16x16x32_bf16 v[212:215], a[140:143], a[76:79], v[212:215]
    buffer_load_dwordx4 v53, s[12:15], s80 offen offset:1024 lds
    v_mfma_f32_16x16x32_bf16 v[208:211], a[140:143], a[68:71], v[208:211]
    v_sqrt_f32 v12, v12
    v_mfma_f32_16x16x32_bf16 v[208:211], a[136:139], a[64:67], v[208:211]
    s_waitcnt lgkmcnt(4)
    v_cvt_pk_bf16_f32 v12, v12, v12
    v_lshlrev_b32 v12, 16, v12
    v_mfma_f32_16x16x32_bf16 v[224:227], a[144:147], a[64:67], v[224:227]
    ds_read_b64_tr_b16 a[128:129], v48 offset:0
    v_mfma_f32_16x16x32_bf16 v[224:227], a[148:151], a[68:71], v[224:227]
    ds_read_b64_tr_b16 a[130:131], v48 offset:512
    v_mfma_f32_16x16x32_bf16 v[228:231], a[148:151], a[76:79], v[228:231]
    ds_read_b64_tr_b16 a[132:133], v48 offset:4096
    v_mfma_f32_16x16x32_bf16 v[228:231], a[144:147], a[72:75], v[228:231]
    ds_read_b64_tr_b16 a[134:135], v48 offset:4608
    v_mfma_f32_16x16x32_bf16 v[232:235], a[144:147], a[80:83], v[232:235]
    buffer_load_dwordx4 v54, s[12:15], s80 offen offset:2048 lds
    v_mfma_f32_16x16x32_bf16 v[232:235], a[148:151], a[84:87], v[232:235]
    buffer_load_dwordx4 v55, s[12:15], s80 offen offset:3072 lds
    v_mfma_f32_16x16x32_bf16 v[236:239], a[148:151], a[92:95], v[236:239]
    s_add_u32 m0, s100, 147456
    s_mov_b32 s80, 1327104
    v_mfma_f32_16x16x32_bf16 v[236:239], a[144:147], a[88:91], v[236:239]
    s_waitcnt lgkmcnt(4)
    v_rcp_f32 v17, v12
    v_mfma_f32_16x16x32_bf16 v[252:255], a[152:155], a[88:91], v[252:255]
    s_nop 0
    ds_read_b64_tr_b16 a[136:137], v49 offset:0
    v_mfma_f32_16x16x32_bf16 v[252:255], a[156:159], a[92:95], v[252:255]
    ds_read_b64_tr_b16 a[138:139], v49 offset:512
    v_mfma_f32_16x16x32_bf16 v[248:251], a[156:159], a[84:87], v[248:251]
    ds_read_b64_tr_b16 a[140:141], v49 offset:4096
    v_mfma_f32_16x16x32_bf16 v[248:251], a[152:155], a[80:83], v[248:251]
    ds_read_b64_tr_b16 a[142:143], v49 offset:4608
    v_mfma_f32_16x16x32_bf16 v[244:247], a[152:155], a[72:75], v[244:247]
    buffer_load_dwordx4 v56, s[16:19], s80 offen offset:0 lds
    v_mfma_f32_16x16x32_bf16 v[244:247], a[156:159], a[76:79], v[244:247]
    buffer_load_dwordx4 v57, s[16:19], s80 offen offset:1024 lds
    v_mfma_f32_16x16x32_bf16 v[240:243], a[156:159], a[68:71], v[240:243]
    v_mfma_f32_16x16x32_bf16 v[240:243], a[152:155], a[64:67], v[240:243]
    s_waitcnt lgkmcnt(4)
    v_mfma_f32_16x16x32_bf16 v[64:67], a[128:131], a[64:67], v[64:67]
    s_waitcnt vmcnt(20)
    ds_read_b64_tr_b16 a[144:145], v50 offset:0
    ds_read_b128 a[96:99], v24 offset:0
    v_mfma_f32_16x16x32_bf16 v[64:67], a[132:135], a[68:71], v[64:67]
    ds_read_b64_tr_b16 a[146:147], v50 offset:512
    ds_read_b128 a[100:103], v25 offset:0
    v_mfma_f32_16x16x32_bf16 v[68:71], a[132:135], a[76:79], v[68:71]
    ds_read_b64_tr_b16 a[148:149], v50 offset:4096
    ds_read_b128 a[104:107], v24 offset:2048
    v_mfma_f32_16x16x32_bf16 v[68:71], a[128:131], a[72:75], v[68:71]
    ds_read_b64_tr_b16 a[150:151], v50 offset:4608
    ds_read_b128 a[108:111], v25 offset:2048
    v_mfma_f32_16x16x32_bf16 v[72:75], a[128:131], a[80:83], v[72:75]
    ds_read_b128 a[112:115], v24 offset:4096
    ds_read_b128 a[116:119], v25 offset:4096
    v_mfma_f32_16x16x32_bf16 v[72:75], a[132:135], a[84:87], v[72:75]
    ds_read_b128 a[120:123], v24 offset:6144
    ds_read_b128 a[124:127], v25 offset:6144
    v_mfma_f32_16x16x32_bf16 v[76:79], a[132:135], a[92:95], v[76:79]
    buffer_store_dwordx2 v[16:17], v19, s[40:43], 0 offen sc1
    v_mfma_f32_16x16x32_bf16 v[76:79], a[128:131], a[88:91], v[76:79]
    v_xor_b32 v24, 0x10000, v24
    v_xor_b32 v25, 0x10000, v25
    v_smfmac_f32_16x16x64_bf16 a[200:203], v[36:39], a[128:135], v35
    s_waitcnt lgkmcnt(12)
    v_mfma_f32_16x16x32_bf16 v[92:95], a[136:139], a[88:91], v[92:95]
    ds_read_b64_tr_b16 a[152:153], v51 offset:0
    v_mfma_f32_16x16x32_bf16 v[92:95], a[140:143], a[92:95], v[92:95]
    ds_read_b64_tr_b16 a[154:155], v51 offset:512
    v_mfma_f32_16x16x32_bf16 v[88:91], a[140:143], a[84:87], v[88:91]
    ds_read_b64_tr_b16 a[156:157], v51 offset:4096
    v_mfma_f32_16x16x32_bf16 v[88:91], a[136:139], a[80:83], v[88:91]
    ds_read_b64_tr_b16 a[158:159], v51 offset:4608
    v_mfma_f32_16x16x32_bf16 v[84:87], a[136:139], a[72:75], v[84:87]
    v_mfma_f32_16x16x32_bf16 v[84:87], a[140:143], a[76:79], v[84:87]
    v_mfma_f32_16x16x32_bf16 v[80:83], a[140:143], a[68:71], v[80:83]
    v_mfma_f32_16x16x32_bf16 v[80:83], a[136:139], a[64:67], v[80:83]
    v_smfmac_f32_16x16x64_bf16 a[204:207], v[36:39], a[136:143], v35
    s_waitcnt lgkmcnt(9)
    v_mfma_f32_16x16x32_bf16 v[96:99], a[144:147], a[64:67], v[96:99]
    s_waitcnt vmcnt(15)
    s_barrier
    v_mfma_f32_16x16x32_bf16 v[96:99], a[148:151], a[68:71], v[96:99]
    ds_read_b64_tr_b16 a[128:129], v40 offset:32768
    v_mfma_f32_16x16x32_bf16 v[100:103], a[148:151], a[76:79], v[100:103]
    ds_read_b64_tr_b16 a[130:131], v40 offset:33792
    v_mfma_f32_16x16x32_bf16 v[100:103], a[144:147], a[72:75], v[100:103]
    ds_read_b64_tr_b16 a[132:133], v40 offset:40960
    v_mfma_f32_16x16x32_bf16 v[104:107], a[144:147], a[80:83], v[104:107]
    ds_read_b64_tr_b16 a[134:135], v40 offset:41984
    v_mfma_f32_16x16x32_bf16 v[104:107], a[148:151], a[84:87], v[104:107]
    v_mfma_f32_16x16x32_bf16 v[108:111], a[148:151], a[92:95], v[108:111]
    v_mfma_f32_16x16x32_bf16 v[108:111], a[144:147], a[88:91], v[108:111]
    s_waitcnt lgkmcnt(4)
    v_mfma_f32_16x16x32_bf16 v[124:127], a[152:155], a[88:91], v[124:127]
    ds_read_b64_tr_b16 a[136:137], v40 offset:32776
    v_mfma_f32_16x16x32_bf16 v[124:127], a[156:159], a[92:95], v[124:127]
    ds_read_b64_tr_b16 a[138:139], v40 offset:33800
    v_mfma_f32_16x16x32_bf16 v[120:123], a[156:159], a[84:87], v[120:123]
    ds_read_b64_tr_b16 a[140:141], v40 offset:40968
    v_mfma_f32_16x16x32_bf16 v[120:123], a[152:155], a[80:83], v[120:123]
    ds_read_b64_tr_b16 a[142:143], v40 offset:41992
    v_mfma_f32_16x16x32_bf16 v[116:119], a[152:155], a[72:75], v[116:119]
    v_mfma_f32_16x16x32_bf16 v[116:119], a[156:159], a[76:79], v[116:119]
    v_mfma_f32_16x16x32_bf16 v[112:115], a[156:159], a[68:71], v[112:115]
    v_mfma_f32_16x16x32_bf16 v[112:115], a[152:155], a[64:67], v[112:115]
    s_waitcnt lgkmcnt(4)
    v_mfma_f32_16x16x32_bf16 v[128:131], a[128:131], a[96:99], v[128:131]
    s_add_u32 m0, s101, 0
    ds_read_b64_tr_b16 a[144:145], v41 offset:32768
    s_mov_b32 s80, 896
    v_mfma_f32_16x16x32_bf16 v[128:131], a[132:135], a[100:103], v[128:131]
    ds_read_b64_tr_b16 a[146:147], v41 offset:33792
    v_mfma_f32_16x16x32_bf16 v[132:135], a[132:135], a[108:111], v[132:135]
    ds_read_b64_tr_b16 a[148:149], v41 offset:40960
    v_mfma_f32_16x16x32_bf16 v[132:135], a[128:131], a[104:107], v[132:135]
    ds_read_b64_tr_b16 a[150:151], v41 offset:41984
    v_mfma_f32_16x16x32_bf16 v[136:139], a[128:131], a[112:115], v[136:139]
    buffer_load_dwordx4 v20, s[8:11], s80 offen offset:0 lds
    v_mfma_f32_16x16x32_bf16 v[136:139], a[132:135], a[116:119], v[136:139]
    buffer_load_dwordx4 v21, s[8:11], s80 offen offset:1024 lds
    v_mfma_f32_16x16x32_bf16 v[140:143], a[132:135], a[124:127], v[140:143]
    v_mfma_f32_16x16x32_bf16 v[140:143], a[128:131], a[120:123], v[140:143]
    v_smfmac_f32_16x16x64_bf16 a[192:195], v[36:39], a[128:135], v35
    s_waitcnt lgkmcnt(4)
    v_mfma_f32_16x16x32_bf16 v[156:159], a[136:139], a[120:123], v[156:159]
    ds_read_b64_tr_b16 a[152:153], v41 offset:32776
    v_mfma_f32_16x16x32_bf16 v[156:159], a[140:143], a[124:127], v[156:159]
    ds_read_b64_tr_b16 a[154:155], v41 offset:33800
    v_mfma_f32_16x16x32_bf16 v[152:155], a[140:143], a[116:119], v[152:155]
    ds_read_b64_tr_b16 a[156:157], v41 offset:40968
    v_mfma_f32_16x16x32_bf16 v[152:155], a[136:139], a[112:115], v[152:155]
    ds_read_b64_tr_b16 a[158:159], v41 offset:41992
    v_mfma_f32_16x16x32_bf16 v[148:151], a[136:139], a[104:107], v[148:151]
    buffer_load_dwordx4 v22, s[8:11], s80 offen offset:2048 lds
    v_mfma_f32_16x16x32_bf16 v[148:151], a[140:143], a[108:111], v[148:151]
    buffer_load_dwordx4 v23, s[8:11], s80 offen offset:3072 lds
    v_mfma_f32_16x16x32_bf16 v[144:147], a[140:143], a[100:103], v[144:147]
    s_add_u32 m0, s101, 4096
    s_mov_b32 s80, 41856
    v_mfma_f32_16x16x32_bf16 v[144:147], a[136:139], a[96:99], v[144:147]
    v_smfmac_f32_16x16x64_bf16 a[196:199], v[36:39], a[136:143], v35
    s_waitcnt lgkmcnt(4)
    v_mfma_f32_16x16x32_bf16 v[160:163], a[144:147], a[96:99], v[160:163]
    ds_read_b64_tr_b16 a[128:129], v42 offset:32768
    v_mfma_f32_16x16x32_bf16 v[160:163], a[148:151], a[100:103], v[160:163]
    ds_read_b64_tr_b16 a[130:131], v42 offset:33792
    v_mfma_f32_16x16x32_bf16 v[164:167], a[148:151], a[108:111], v[164:167]
    ds_read_b64_tr_b16 a[132:133], v42 offset:40960
    v_mfma_f32_16x16x32_bf16 v[164:167], a[144:147], a[104:107], v[164:167]
    ds_read_b64_tr_b16 a[134:135], v42 offset:41984
    v_mfma_f32_16x16x32_bf16 v[168:171], a[144:147], a[112:115], v[168:171]
    buffer_load_dwordx4 v20, s[8:11], s80 offen offset:0 lds
    v_mfma_f32_16x16x32_bf16 v[168:171], a[148:151], a[116:119], v[168:171]
    v_mfma_f32_16x16x32_bf16 v[172:175], a[148:151], a[124:127], v[172:175]
    v_mfma_f32_16x16x32_bf16 v[172:175], a[144:147], a[120:123], v[172:175]
    s_waitcnt lgkmcnt(4)
    v_mfma_f32_16x16x32_bf16 v[188:191], a[152:155], a[120:123], v[188:191]
    ds_read_b64_tr_b16 a[136:137], v42 offset:32776
    v_mfma_f32_16x16x32_bf16 v[188:191], a[156:159], a[124:127], v[188:191]
    ds_read_b64_tr_b16 a[138:139], v42 offset:33800
    v_mfma_f32_16x16x32_bf16 v[184:187], a[156:159], a[116:119], v[184:187]
    ds_read_b64_tr_b16 a[140:141], v42 offset:40968
    v_mfma_f32_16x16x32_bf16 v[184:187], a[152:155], a[112:115], v[184:187]
    ds_read_b64_tr_b16 a[142:143], v42 offset:41992
    v_mfma_f32_16x16x32_bf16 v[180:183], a[152:155], a[104:107], v[180:183]
    buffer_load_dwordx4 v21, s[8:11], s80 offen offset:1024 lds
    v_mfma_f32_16x16x32_bf16 v[180:183], a[156:159], a[108:111], v[180:183]
    v_mfma_f32_16x16x32_bf16 v[176:179], a[156:159], a[100:103], v[176:179]
    v_mfma_f32_16x16x32_bf16 v[176:179], a[152:155], a[96:99], v[176:179]
    s_waitcnt lgkmcnt(4)
    v_mfma_f32_16x16x32_bf16 v[192:195], a[128:131], a[96:99], v[192:195]
    ds_read_b64_tr_b16 a[144:145], v43 offset:32768
    v_mfma_f32_16x16x32_bf16 v[192:195], a[132:135], a[100:103], v[192:195]
    ds_read_b64_tr_b16 a[146:147], v43 offset:33792
    v_mfma_f32_16x16x32_bf16 v[196:199], a[132:135], a[108:111], v[196:199]
    ds_read_b64_tr_b16 a[148:149], v43 offset:40960
    v_mfma_f32_16x16x32_bf16 v[196:199], a[128:131], a[104:107], v[196:199]
    ds_read_b64_tr_b16 a[150:151], v43 offset:41984
    v_mfma_f32_16x16x32_bf16 v[200:203], a[128:131], a[112:115], v[200:203]
    buffer_load_dwordx4 v22, s[8:11], s80 offen offset:2048 lds
    v_mfma_f32_16x16x32_bf16 v[200:203], a[132:135], a[116:119], v[200:203]
    v_mfma_f32_16x16x32_bf16 v[204:207], a[132:135], a[124:127], v[204:207]
    v_mfma_f32_16x16x32_bf16 v[204:207], a[128:131], a[120:123], v[204:207]
    s_waitcnt lgkmcnt(4)
    v_mfma_f32_16x16x32_bf16 v[220:223], a[136:139], a[120:123], v[220:223]
    ds_read_b64_tr_b16 a[152:153], v43 offset:32776
    v_mfma_f32_16x16x32_bf16 v[220:223], a[140:143], a[124:127], v[220:223]
    ds_read_b64_tr_b16 a[154:155], v43 offset:33800
    v_mfma_f32_16x16x32_bf16 v[216:219], a[140:143], a[116:119], v[216:219]
    ds_read_b64_tr_b16 a[156:157], v43 offset:40968
    v_mfma_f32_16x16x32_bf16 v[216:219], a[136:139], a[112:115], v[216:219]
    ds_read_b64_tr_b16 a[158:159], v43 offset:41992
    v_mfma_f32_16x16x32_bf16 v[212:215], a[136:139], a[104:107], v[212:215]
    buffer_load_dwordx4 v23, s[8:11], s80 offen offset:3072 lds
    v_mfma_f32_16x16x32_bf16 v[212:215], a[140:143], a[108:111], v[212:215]
    s_add_u32 m0, s79, 49152
    s_mov_b32 s80, 3670016
    v_mfma_f32_16x16x32_bf16 v[208:211], a[140:143], a[100:103], v[208:211]
    v_mfma_f32_16x16x32_bf16 v[208:211], a[136:139], a[96:99], v[208:211]
    s_waitcnt lgkmcnt(4)
    v_mfma_f32_16x16x32_bf16 v[224:227], a[144:147], a[96:99], v[224:227]
    ds_read_b64_tr_b16 a[128:129], v48 offset:8192
    v_mfma_f32_16x16x32_bf16 v[224:227], a[148:151], a[100:103], v[224:227]
    ds_read_b64_tr_b16 a[130:131], v48 offset:8704
    v_mfma_f32_16x16x32_bf16 v[228:231], a[148:151], a[108:111], v[228:231]
    ds_read_b64_tr_b16 a[132:133], v48 offset:12288
    v_mfma_f32_16x16x32_bf16 v[228:231], a[144:147], a[104:107], v[228:231]
    ds_read_b64_tr_b16 a[134:135], v48 offset:12800
    v_mfma_f32_16x16x32_bf16 v[232:235], a[144:147], a[112:115], v[232:235]
    buffer_load_dwordx4 v52, s[12:15], s80 offen offset:0 lds
    v_mfma_f32_16x16x32_bf16 v[232:235], a[148:151], a[116:119], v[232:235]
    v_mfma_f32_16x16x32_bf16 v[236:239], a[148:151], a[124:127], v[236:239]
    v_mfma_f32_16x16x32_bf16 v[236:239], a[144:147], a[120:123], v[236:239]
    s_waitcnt lgkmcnt(4)
    v_mfma_f32_16x16x32_bf16 v[252:255], a[152:155], a[120:123], v[252:255]
    ds_read_b64_tr_b16 a[136:137], v49 offset:8192
    v_mfma_f32_16x16x32_bf16 v[252:255], a[156:159], a[124:127], v[252:255]
    ds_read_b64_tr_b16 a[138:139], v49 offset:8704
    v_mfma_f32_16x16x32_bf16 v[248:251], a[156:159], a[116:119], v[248:251]
    ds_read_b64_tr_b16 a[140:141], v49 offset:12288
    v_mfma_f32_16x16x32_bf16 v[248:251], a[152:155], a[112:115], v[248:251]
    ds_read_b64_tr_b16 a[142:143], v49 offset:12800
    v_mfma_f32_16x16x32_bf16 v[244:247], a[152:155], a[104:107], v[244:247]
    buffer_load_dwordx4 v53, s[12:15], s80 offen offset:1024 lds
    v_mfma_f32_16x16x32_bf16 v[244:247], a[156:159], a[108:111], v[244:247]
    v_mfma_f32_16x16x32_bf16 v[240:243], a[156:159], a[100:103], v[240:243]
    v_mfma_f32_16x16x32_bf16 v[240:243], a[152:155], a[96:99], v[240:243]
    s_waitcnt lgkmcnt(4)
    v_mfma_f32_16x16x32_bf16 v[64:67], a[128:131], a[96:99], v[64:67]
    s_waitcnt vmcnt(17)
    ds_read_b64_tr_b16 a[144:145], v50 offset:8192
    ds_read_b128 a[64:67], v24 offset:0
    v_mfma_f32_16x16x32_bf16 v[64:67], a[132:135], a[100:103], v[64:67]
    ds_read_b64_tr_b16 a[146:147], v50 offset:8704
    ds_read_b128 a[68:71], v25 offset:0
    v_mfma_f32_16x16x32_bf16 v[68:71], a[132:135], a[108:111], v[68:71]
    ds_read_b64_tr_b16 a[148:149], v50 offset:12288
    ds_read_b128 a[72:75], v24 offset:2048
    v_mfma_f32_16x16x32_bf16 v[68:71], a[128:131], a[104:107], v[68:71]
    ds_read_b64_tr_b16 a[150:151], v50 offset:12800
    ds_read_b128 a[76:79], v25 offset:2048
    v_mfma_f32_16x16x32_bf16 v[72:75], a[128:131], a[112:115], v[72:75]
    ds_read_b128 a[80:83], v24 offset:4096
    ds_read_b128 a[84:87], v25 offset:4096
    v_mfma_f32_16x16x32_bf16 v[72:75], a[132:135], a[116:119], v[72:75]
    ds_read_b128 a[88:91], v24 offset:6144
    ds_read_b128 a[92:95], v25 offset:6144
    v_mfma_f32_16x16x32_bf16 v[76:79], a[132:135], a[124:127], v[76:79]
    buffer_load_dwordx4 v54, s[12:15], s80 offen offset:2048 lds
    v_mfma_f32_16x16x32_bf16 v[76:79], a[128:131], a[120:123], v[76:79]
    v_xor_b32 v24, 0x10000, v24
    v_xor_b32 v25, 0x10000, v25
    v_smfmac_f32_16x16x64_bf16 a[200:203], v[36:39], a[128:135], v35
    s_waitcnt lgkmcnt(12)
    v_mfma_f32_16x16x32_bf16 v[92:95], a[136:139], a[120:123], v[92:95]
    ds_read_b64_tr_b16 a[152:153], v51 offset:8192
    v_mfma_f32_16x16x32_bf16 v[92:95], a[140:143], a[124:127], v[92:95]
    ds_read_b64_tr_b16 a[154:155], v51 offset:8704
    v_mfma_f32_16x16x32_bf16 v[88:91], a[140:143], a[116:119], v[88:91]
    ds_read_b64_tr_b16 a[156:157], v51 offset:12288
    v_mfma_f32_16x16x32_bf16 v[88:91], a[136:139], a[112:115], v[88:91]
    ds_read_b64_tr_b16 a[158:159], v51 offset:12800
    v_mfma_f32_16x16x32_bf16 v[84:87], a[136:139], a[104:107], v[84:87]
    buffer_load_dwordx4 v55, s[12:15], s80 offen offset:3072 lds
    v_mfma_f32_16x16x32_bf16 v[84:87], a[140:143], a[108:111], v[84:87]
    s_add_u32 m0, s100, 155648
    s_mov_b32 s80, 1548288
    v_mfma_f32_16x16x32_bf16 v[80:83], a[140:143], a[100:103], v[80:83]
    v_mfma_f32_16x16x32_bf16 v[80:83], a[136:139], a[96:99], v[80:83]
    v_smfmac_f32_16x16x64_bf16 a[204:207], v[36:39], a[136:143], v35
    s_waitcnt lgkmcnt(9)
    v_mfma_f32_16x16x32_bf16 v[96:99], a[144:147], a[96:99], v[96:99]
    s_waitcnt vmcnt(12)
    s_barrier
    v_mfma_f32_16x16x32_bf16 v[96:99], a[148:151], a[100:103], v[96:99]
    v_xor_b32 v40, 0x10000, v40
    ds_read_b64_tr_b16 a[128:129], v40 offset:32768
    v_mfma_f32_16x16x32_bf16 v[100:103], a[148:151], a[108:111], v[100:103]
    ds_read_b64_tr_b16 a[130:131], v40 offset:33792
    v_mfma_f32_16x16x32_bf16 v[100:103], a[144:147], a[104:107], v[100:103]
    ds_read_b64_tr_b16 a[132:133], v40 offset:40960
    v_mfma_f32_16x16x32_bf16 v[104:107], a[144:147], a[112:115], v[104:107]
    ds_read_b64_tr_b16 a[134:135], v40 offset:41984
    v_mfma_f32_16x16x32_bf16 v[104:107], a[148:151], a[116:119], v[104:107]
    buffer_atomic_add v32, v33, s[36:39], s92 offen
    v_mfma_f32_16x16x32_bf16 v[108:111], a[148:151], a[124:127], v[108:111]
    buffer_load_dwordx4 v56, s[16:19], s80 offen offset:0 lds
    v_mfma_f32_16x16x32_bf16 v[108:111], a[144:147], a[120:123], v[108:111]
    s_waitcnt lgkmcnt(4)
    v_mfma_f32_16x16x32_bf16 v[124:127], a[152:155], a[120:123], v[124:127]
    ds_read_b64_tr_b16 a[136:137], v40 offset:32776
    v_mfma_f32_16x16x32_bf16 v[124:127], a[156:159], a[124:127], v[124:127]
    ds_read_b64_tr_b16 a[138:139], v40 offset:33800
    v_mfma_f32_16x16x32_bf16 v[120:123], a[156:159], a[116:119], v[120:123]
    ds_read_b64_tr_b16 a[140:141], v40 offset:40968
    v_mfma_f32_16x16x32_bf16 v[120:123], a[152:155], a[112:115], v[120:123]
    ds_read_b64_tr_b16 a[142:143], v40 offset:41992
    v_mfma_f32_16x16x32_bf16 v[116:119], a[152:155], a[104:107], v[116:119]
    buffer_load_dwordx4 v57, s[16:19], s80 offen offset:1024 lds
    v_mfma_f32_16x16x32_bf16 v[116:119], a[156:159], a[108:111], v[116:119]
    v_mfma_f32_16x16x32_bf16 v[112:115], a[156:159], a[100:103], v[112:115]
    v_mfma_f32_16x16x32_bf16 v[112:115], a[152:155], a[96:99], v[112:115]
    s_waitcnt lgkmcnt(4)
    v_mfma_f32_16x16x32_bf16 v[128:131], a[128:131], a[64:67], v[128:131]
    s_add_u32 m0, s101, 65536
    v_xor_b32 v41, 0x10000, v41
    ds_read_b64_tr_b16 a[144:145], v41 offset:32768
    v_mfma_f32_16x16x32_bf16 v[128:131], a[132:135], a[68:71], v[128:131]
    s_mov_b32 s80, 1024
    ds_read_b64_tr_b16 a[146:147], v41 offset:33792
    v_accvgpr_write_b32 a160, 0
    v_mfma_f32_16x16x32_bf16 v[132:135], a[132:135], a[76:79], v[132:135]
    ds_read_b64_tr_b16 a[148:149], v41 offset:40960
    v_accvgpr_write_b32 a161, 0
    v_mfma_f32_16x16x32_bf16 v[132:135], a[128:131], a[72:75], v[132:135]
    ds_read_b64_tr_b16 a[150:151], v41 offset:41984
    v_mfma_f32_16x16x32_bf16 v[136:139], a[128:131], a[80:83], v[136:139]
    buffer_load_dwordx4 v20, s[8:11], s80 offen offset:0 lds
    v_mfma_f32_16x16x32_bf16 v[136:139], a[132:135], a[84:87], v[136:139]
    buffer_load_dwordx4 v21, s[8:11], s80 offen offset:1024 lds
    v_mfma_f32_16x16x32_bf16 v[140:143], a[132:135], a[92:95], v[140:143]
    v_accvgpr_write_b32 a162, 0
    v_accvgpr_write_b32 a163, 0
    v_mfma_f32_16x16x32_bf16 v[140:143], a[128:131], a[88:91], v[140:143]
    v_accvgpr_write_b32 a164, 0
    v_accvgpr_write_b32 a165, 0
    v_smfmac_f32_16x16x64_bf16 a[192:195], v[36:39], a[128:135], v35
    s_waitcnt lgkmcnt(4)
    v_accvgpr_write_b32 a166, 0
    v_accvgpr_write_b32 a167, 0
    v_mfma_f32_16x16x32_bf16 v[156:159], a[136:139], a[88:91], v[156:159]
    ds_read_b64_tr_b16 a[152:153], v41 offset:32776
    v_accvgpr_write_b32 a168, 0
    v_mfma_f32_16x16x32_bf16 v[156:159], a[140:143], a[92:95], v[156:159]
    ds_read_b64_tr_b16 a[154:155], v41 offset:33800
    v_accvgpr_write_b32 a169, 0
    v_mfma_f32_16x16x32_bf16 v[152:155], a[140:143], a[84:87], v[152:155]
    ds_read_b64_tr_b16 a[156:157], v41 offset:40968
    v_accvgpr_write_b32 a170, 0
    v_mfma_f32_16x16x32_bf16 v[152:155], a[136:139], a[80:83], v[152:155]
    ds_read_b64_tr_b16 a[158:159], v41 offset:41992
    v_mfma_f32_16x16x32_bf16 v[148:151], a[136:139], a[72:75], v[148:151]
    buffer_load_dwordx4 v22, s[8:11], s80 offen offset:2048 lds
    v_mfma_f32_16x16x32_bf16 v[148:151], a[140:143], a[76:79], v[148:151]
    buffer_load_dwordx4 v23, s[8:11], s80 offen offset:3072 lds
    v_mfma_f32_16x16x32_bf16 v[144:147], a[140:143], a[68:71], v[144:147]
    s_add_u32 m0, s101, 69632
    s_mov_b32 s80, 41984
    v_accvgpr_write_b32 a171, 0
    v_mfma_f32_16x16x32_bf16 v[144:147], a[136:139], a[64:67], v[144:147]
    v_accvgpr_write_b32 a172, 0
    v_accvgpr_write_b32 a173, 0
    v_smfmac_f32_16x16x64_bf16 a[196:199], v[36:39], a[136:143], v35
    s_waitcnt lgkmcnt(4)
    v_accvgpr_write_b32 a174, 0
    v_accvgpr_write_b32 a175, 0
    v_mfma_f32_16x16x32_bf16 v[160:163], a[144:147], a[64:67], v[160:163]
    v_xor_b32 v42, 0x10000, v42
    ds_read_b64_tr_b16 a[128:129], v42 offset:32768
    v_mfma_f32_16x16x32_bf16 v[160:163], a[148:151], a[68:71], v[160:163]
    ds_read_b64_tr_b16 a[130:131], v42 offset:33792
    v_mfma_f32_16x16x32_bf16 v[164:167], a[148:151], a[76:79], v[164:167]
    ds_read_b64_tr_b16 a[132:133], v42 offset:40960
    v_mfma_f32_16x16x32_bf16 v[164:167], a[144:147], a[72:75], v[164:167]
    ds_read_b64_tr_b16 a[134:135], v42 offset:41984
    v_mfma_f32_16x16x32_bf16 v[168:171], a[144:147], a[80:83], v[168:171]
    buffer_load_dwordx4 v20, s[8:11], s80 offen offset:0 lds
    v_mfma_f32_16x16x32_bf16 v[168:171], a[148:151], a[84:87], v[168:171]
    v_mfma_f32_16x16x32_bf16 v[172:175], a[148:151], a[92:95], v[172:175]
    v_mfma_f32_16x16x32_bf16 v[172:175], a[144:147], a[88:91], v[172:175]
    s_waitcnt lgkmcnt(4)
    v_mfma_f32_16x16x32_bf16 v[188:191], a[152:155], a[88:91], v[188:191]
    ds_read_b64_tr_b16 a[136:137], v42 offset:32776
    v_mfma_f32_16x16x32_bf16 v[188:191], a[156:159], a[92:95], v[188:191]
    ds_read_b64_tr_b16 a[138:139], v42 offset:33800
    v_mfma_f32_16x16x32_bf16 v[184:187], a[156:159], a[84:87], v[184:187]
    ds_read_b64_tr_b16 a[140:141], v42 offset:40968
    v_mfma_f32_16x16x32_bf16 v[184:187], a[152:155], a[80:83], v[184:187]
    ds_read_b64_tr_b16 a[142:143], v42 offset:41992
    v_mfma_f32_16x16x32_bf16 v[180:183], a[152:155], a[72:75], v[180:183]
    buffer_load_dwordx4 v21, s[8:11], s80 offen offset:1024 lds
    v_mfma_f32_16x16x32_bf16 v[180:183], a[156:159], a[76:79], v[180:183]
    v_mfma_f32_16x16x32_bf16 v[176:179], a[156:159], a[68:71], v[176:179]
    v_mfma_f32_16x16x32_bf16 v[176:179], a[152:155], a[64:67], v[176:179]
    s_waitcnt lgkmcnt(4)
    v_mfma_f32_16x16x32_bf16 v[192:195], a[128:131], a[64:67], v[192:195]
    v_xor_b32 v43, 0x10000, v43
    ds_read_b64_tr_b16 a[144:145], v43 offset:32768
    v_mfma_f32_16x16x32_bf16 v[192:195], a[132:135], a[68:71], v[192:195]
    ds_read_b64_tr_b16 a[146:147], v43 offset:33792
    v_mfma_f32_16x16x32_bf16 v[196:199], a[132:135], a[76:79], v[196:199]
    ds_read_b64_tr_b16 a[148:149], v43 offset:40960
    v_mfma_f32_16x16x32_bf16 v[196:199], a[128:131], a[72:75], v[196:199]
    ds_read_b64_tr_b16 a[150:151], v43 offset:41984
    v_mfma_f32_16x16x32_bf16 v[200:203], a[128:131], a[80:83], v[200:203]
    buffer_load_dwordx4 v22, s[8:11], s80 offen offset:2048 lds
    v_mfma_f32_16x16x32_bf16 v[200:203], a[132:135], a[84:87], v[200:203]
    v_mfma_f32_16x16x32_bf16 v[204:207], a[132:135], a[92:95], v[204:207]
    v_mfma_f32_16x16x32_bf16 v[204:207], a[128:131], a[88:91], v[204:207]
    s_waitcnt lgkmcnt(4)
    v_mfma_f32_16x16x32_bf16 v[220:223], a[136:139], a[88:91], v[220:223]
    ds_read_b64_tr_b16 a[152:153], v43 offset:32776
    v_mfma_f32_16x16x32_bf16 v[220:223], a[140:143], a[92:95], v[220:223]
    ds_read_b64_tr_b16 a[154:155], v43 offset:33800
    v_mfma_f32_16x16x32_bf16 v[216:219], a[140:143], a[84:87], v[216:219]
    ds_read_b64_tr_b16 a[156:157], v43 offset:40968
    v_mfma_f32_16x16x32_bf16 v[216:219], a[136:139], a[80:83], v[216:219]
    ds_read_b64_tr_b16 a[158:159], v43 offset:41992
    v_mfma_f32_16x16x32_bf16 v[212:215], a[136:139], a[72:75], v[212:215]
    buffer_load_dwordx4 v23, s[8:11], s80 offen offset:3072 lds
    v_mfma_f32_16x16x32_bf16 v[212:215], a[140:143], a[76:79], v[212:215]
    s_add_u32 m0, s79, 114688
    s_mov_b32 s80, 4194304
    v_mfma_f32_16x16x32_bf16 v[208:211], a[140:143], a[68:71], v[208:211]
    v_mfma_f32_16x16x32_bf16 v[208:211], a[136:139], a[64:67], v[208:211]
    s_waitcnt lgkmcnt(4)
    v_mfma_f32_16x16x32_bf16 v[224:227], a[144:147], a[64:67], v[224:227]
    ds_read_b64_tr_b16 a[128:129], v48 offset:16384
    v_mfma_f32_16x16x32_bf16 v[224:227], a[148:151], a[68:71], v[224:227]
    ds_read_b64_tr_b16 a[130:131], v48 offset:16896
    v_mfma_f32_16x16x32_bf16 v[228:231], a[148:151], a[76:79], v[228:231]
    ds_read_b64_tr_b16 a[132:133], v48 offset:20480
    v_mfma_f32_16x16x32_bf16 v[228:231], a[144:147], a[72:75], v[228:231]
    ds_read_b64_tr_b16 a[134:135], v48 offset:20992
    v_mfma_f32_16x16x32_bf16 v[232:235], a[144:147], a[80:83], v[232:235]
    buffer_load_dwordx4 v52, s[12:15], s80 offen offset:0 lds
    v_mfma_f32_16x16x32_bf16 v[232:235], a[148:151], a[84:87], v[232:235]
    v_mfma_f32_16x16x32_bf16 v[236:239], a[148:151], a[92:95], v[236:239]
    v_mfma_f32_16x16x32_bf16 v[236:239], a[144:147], a[88:91], v[236:239]
    s_waitcnt lgkmcnt(4)
    v_mfma_f32_16x16x32_bf16 v[252:255], a[152:155], a[88:91], v[252:255]
    ds_read_b64_tr_b16 a[136:137], v49 offset:16384
    v_mfma_f32_16x16x32_bf16 v[252:255], a[156:159], a[92:95], v[252:255]
    ds_read_b64_tr_b16 a[138:139], v49 offset:16896
    v_mfma_f32_16x16x32_bf16 v[248:251], a[156:159], a[84:87], v[248:251]
    ds_read_b64_tr_b16 a[140:141], v49 offset:20480
    v_mfma_f32_16x16x32_bf16 v[248:251], a[152:155], a[80:83], v[248:251]
    ds_read_b64_tr_b16 a[142:143], v49 offset:20992
    v_mfma_f32_16x16x32_bf16 v[244:247], a[152:155], a[72:75], v[244:247]
    buffer_load_dwordx4 v53, s[12:15], s80 offen offset:1024 lds
    v_mfma_f32_16x16x32_bf16 v[244:247], a[156:159], a[76:79], v[244:247]
    v_mfma_f32_16x16x32_bf16 v[240:243], a[156:159], a[68:71], v[240:243]
    v_mfma_f32_16x16x32_bf16 v[240:243], a[152:155], a[64:67], v[240:243]
    s_waitcnt lgkmcnt(4)
    v_mfma_f32_16x16x32_bf16 v[64:67], a[128:131], a[64:67], v[64:67]
    s_waitcnt vmcnt(17)
    ds_read_b64_tr_b16 a[144:145], v50 offset:16384
    ds_read_b128 a[96:99], v24 offset:0
    v_mfma_f32_16x16x32_bf16 v[64:67], a[132:135], a[68:71], v[64:67]
    ds_read_b64_tr_b16 a[146:147], v50 offset:16896
    ds_read_b128 a[100:103], v25 offset:0
    v_mfma_f32_16x16x32_bf16 v[68:71], a[132:135], a[76:79], v[68:71]
    ds_read_b64_tr_b16 a[148:149], v50 offset:20480
    ds_read_b128 a[104:107], v24 offset:2048
    v_mfma_f32_16x16x32_bf16 v[68:71], a[128:131], a[72:75], v[68:71]
    ds_read_b64_tr_b16 a[150:151], v50 offset:20992
    ds_read_b128 a[108:111], v25 offset:2048
    v_mfma_f32_16x16x32_bf16 v[72:75], a[128:131], a[80:83], v[72:75]
    ds_read_b128 a[112:115], v24 offset:4096
    ds_read_b128 a[116:119], v25 offset:4096
    v_mfma_f32_16x16x32_bf16 v[72:75], a[132:135], a[84:87], v[72:75]
    ds_read_b128 a[120:123], v24 offset:6144
    ds_read_b128 a[124:127], v25 offset:6144
    v_mfma_f32_16x16x32_bf16 v[76:79], a[132:135], a[92:95], v[76:79]
    buffer_load_dwordx4 v54, s[12:15], s80 offen offset:2048 lds
    v_mfma_f32_16x16x32_bf16 v[76:79], a[128:131], a[88:91], v[76:79]
    v_xor_b32 v24, 0x10000, v24
    v_xor_b32 v25, 0x10000, v25
    v_smfmac_f32_16x16x64_bf16 a[200:203], v[36:39], a[128:135], v35
    s_waitcnt lgkmcnt(12)
    v_mfma_f32_16x16x32_bf16 v[92:95], a[136:139], a[88:91], v[92:95]
    ds_read_b64_tr_b16 a[152:153], v51 offset:16384
    v_mfma_f32_16x16x32_bf16 v[92:95], a[140:143], a[92:95], v[92:95]
    ds_read_b64_tr_b16 a[154:155], v51 offset:16896
    v_mfma_f32_16x16x32_bf16 v[88:91], a[140:143], a[84:87], v[88:91]
    ds_read_b64_tr_b16 a[156:157], v51 offset:20480
    v_mfma_f32_16x16x32_bf16 v[88:91], a[136:139], a[80:83], v[88:91]
    ds_read_b64_tr_b16 a[158:159], v51 offset:20992
    v_mfma_f32_16x16x32_bf16 v[84:87], a[136:139], a[72:75], v[84:87]
    buffer_load_dwordx4 v55, s[12:15], s80 offen offset:3072 lds
    v_mfma_f32_16x16x32_bf16 v[84:87], a[140:143], a[76:79], v[84:87]
    s_add_u32 m0, s100, 131072
    s_mov_b32 s80, 1769472
    v_mfma_f32_16x16x32_bf16 v[80:83], a[140:143], a[68:71], v[80:83]
    v_mfma_f32_16x16x32_bf16 v[80:83], a[136:139], a[64:67], v[80:83]
    v_smfmac_f32_16x16x64_bf16 a[204:207], v[36:39], a[136:143], v35
    s_waitcnt lgkmcnt(9)
    v_mfma_f32_16x16x32_bf16 v[96:99], a[144:147], a[64:67], v[96:99]
    s_waitcnt vmcnt(12)
    s_barrier
    v_mfma_f32_16x16x32_bf16 v[96:99], a[148:151], a[68:71], v[96:99]
    ds_read_b64_tr_b16 a[128:129], v40 offset:49152
    v_mfma_f32_16x16x32_bf16 v[100:103], a[148:151], a[76:79], v[100:103]
    ds_read_b64_tr_b16 a[130:131], v40 offset:50176
    v_mfma_f32_16x16x32_bf16 v[100:103], a[144:147], a[72:75], v[100:103]
    ds_read_b64_tr_b16 a[132:133], v40 offset:57344
    v_mfma_f32_16x16x32_bf16 v[104:107], a[144:147], a[80:83], v[104:107]
    ds_read_b64_tr_b16 a[134:135], v40 offset:58368
    v_mfma_f32_16x16x32_bf16 v[104:107], a[148:151], a[84:87], v[104:107]
    buffer_load_dwordx4 v56, s[16:19], s80 offen offset:0 lds
    v_mfma_f32_16x16x32_bf16 v[108:111], a[148:151], a[92:95], v[108:111]
    v_mfma_f32_16x16x32_bf16 v[108:111], a[144:147], a[88:91], v[108:111]
    s_waitcnt lgkmcnt(4)
    v_mfma_f32_16x16x32_bf16 v[124:127], a[152:155], a[88:91], v[124:127]
    ds_read_b64_tr_b16 a[136:137], v40 offset:49160
    v_mfma_f32_16x16x32_bf16 v[124:127], a[156:159], a[92:95], v[124:127]
    ds_read_b64_tr_b16 a[138:139], v40 offset:50184
    v_mfma_f32_16x16x32_bf16 v[120:123], a[156:159], a[84:87], v[120:123]
    ds_read_b64_tr_b16 a[140:141], v40 offset:57352
    v_mfma_f32_16x16x32_bf16 v[120:123], a[152:155], a[80:83], v[120:123]
    ds_read_b64_tr_b16 a[142:143], v40 offset:58376
    v_mfma_f32_16x16x32_bf16 v[116:119], a[152:155], a[72:75], v[116:119]
    buffer_load_dwordx4 v57, s[16:19], s80 offen offset:1024 lds
    v_mfma_f32_16x16x32_bf16 v[116:119], a[156:159], a[76:79], v[116:119]
    v_mfma_f32_16x16x32_bf16 v[112:115], a[156:159], a[68:71], v[112:115]
    v_mfma_f32_16x16x32_bf16 v[112:115], a[152:155], a[64:67], v[112:115]
    s_waitcnt lgkmcnt(4)
    v_mfma_f32_16x16x32_bf16 v[128:131], a[128:131], a[96:99], v[128:131]
    s_add_u32 m0, s101, 0
    ds_read_b64_tr_b16 a[144:145], v41 offset:49152
    s_mov_b32 s80, 1152
    v_mfma_f32_16x16x32_bf16 v[128:131], a[132:135], a[100:103], v[128:131]
    s_lshl_b32 s5, s76, 2
    ds_read_b64_tr_b16 a[146:147], v41 offset:50176
    v_xor_b32 v26, v28, v29
    v_mfma_f32_16x16x32_bf16 v[132:135], a[132:135], a[108:111], v[132:135]
    ds_read_b64_tr_b16 a[148:149], v41 offset:57344
    v_xor_b32 v27, s5, v26
    v_mfma_f32_16x16x32_bf16 v[132:135], a[128:131], a[104:107], v[132:135]
    ds_read_b64_tr_b16 a[150:151], v41 offset:58368
    v_mfma_f32_16x16x32_bf16 v[136:139], a[128:131], a[112:115], v[136:139]
    buffer_load_dwordx4 v20, s[8:11], s80 offen offset:0 lds
    v_mfma_f32_16x16x32_bf16 v[136:139], a[132:135], a[116:119], v[136:139]
    buffer_load_dwordx4 v21, s[8:11], s80 offen offset:1024 lds
    v_mfma_f32_16x16x32_bf16 v[140:143], a[132:135], a[124:127], v[140:143]
    v_lshlrev_b32 v27, 4, v27
    v_lshl_add_u32 v2, v28, 8, v27
    v_mfma_f32_16x16x32_bf16 v[140:143], a[128:131], a[120:123], v[140:143]
    v_xor_b32 v3, 64, v2
    v_xor_b32 v4, 128, v2
    v_smfmac_f32_16x16x64_bf16 a[192:195], v[36:39], a[128:135], v35
    s_waitcnt lgkmcnt(4)
    v_xor_b32 v5, 192, v2
    v_lshlrev_b32 v27, 8, v29
    v_mfma_f32_16x16x32_bf16 v[156:159], a[136:139], a[120:123], v[156:159]
    ds_read_b64_tr_b16 a[152:153], v41 offset:49160
    v_add_u32 v27, s79, v27
    v_mfma_f32_16x16x32_bf16 v[156:159], a[140:143], a[124:127], v[156:159]
    ds_read_b64_tr_b16 a[154:155], v41 offset:50184
    v_lshl_add_u32 v14, v26, 4, v27
    v_mfma_f32_16x16x32_bf16 v[152:155], a[140:143], a[116:119], v[152:155]
    ds_read_b64_tr_b16 a[156:157], v41 offset:57352
    v_xor_b32 v15, 64, v14
    v_mfma_f32_16x16x32_bf16 v[152:155], a[136:139], a[112:115], v[152:155]
    ds_read_b64_tr_b16 a[158:159], v41 offset:58376
    v_mfma_f32_16x16x32_bf16 v[148:151], a[136:139], a[104:107], v[148:151]
    buffer_load_dwordx4 v22, s[8:11], s80 offen offset:2048 lds
    v_mfma_f32_16x16x32_bf16 v[148:151], a[140:143], a[108:111], v[148:151]
    buffer_load_dwordx4 v23, s[8:11], s80 offen offset:3072 lds
    v_mfma_f32_16x16x32_bf16 v[144:147], a[140:143], a[100:103], v[144:147]
    s_add_u32 m0, s101, 4096
    s_mov_b32 s80, 42112
    v_xor_b32 v16, 128, v14
    v_mfma_f32_16x16x32_bf16 v[144:147], a[136:139], a[96:99], v[144:147]
    v_xor_b32 v17, 192, v14
    v_lshlrev_b32 v26, 1, v29
    v_smfmac_f32_16x16x64_bf16 a[196:199], v[36:39], a[136:143], v35
    s_waitcnt lgkmcnt(4)
    v_xor_b32 v26, v26, v28
    v_lshl_add_u32 v18, v26, 4, v27
    v_mfma_f32_16x16x32_bf16 v[160:163], a[144:147], a[96:99], v[160:163]
    ds_read_b64_tr_b16 a[128:129], v42 offset:49152
    v_xor_b32 v19, 128, v18
    v_mfma_f32_16x16x32_bf16 v[160:163], a[148:151], a[100:103], v[160:163]
    ds_read_b64_tr_b16 a[130:131], v42 offset:50176
    v_lshrrev_b32 v27, 2, v0
    v_mfma_f32_16x16x32_bf16 v[164:167], a[148:151], a[108:111], v[164:167]
    ds_read_b64_tr_b16 a[132:133], v42 offset:57344
    v_lshlrev_b32 v27, 8, v27
    v_mfma_f32_16x16x32_bf16 v[164:167], a[144:147], a[104:107], v[164:167]
    ds_read_b64_tr_b16 a[134:135], v42 offset:58368
    v_mfma_f32_16x16x32_bf16 v[168:171], a[144:147], a[112:115], v[168:171]
    buffer_load_dwordx4 v20, s[8:11], s80 offen offset:0 lds
    v_mfma_f32_16x16x32_bf16 v[168:171], a[148:151], a[116:119], v[168:171]
    v_lshl_add_u32 v27, v31, 3, v27
    v_add_u32 v27, 65536, v27
    v_mfma_f32_16x16x32_bf16 v[172:175], a[148:151], a[124:127], v[172:175]
    v_lshl_add_u32 v6, v30, 5, v27
    v_xor_b32 v7, 32, v6
    v_mfma_f32_16x16x32_bf16 v[172:175], a[144:147], a[120:123], v[172:175]
    s_waitcnt lgkmcnt(4)
    v_xor_b32 v8, 64, v6
    v_xor_b32 v9, 96, v6
    v_mfma_f32_16x16x32_bf16 v[188:191], a[152:155], a[120:123], v[188:191]
    ds_read_b64_tr_b16 a[136:137], v42 offset:49160
    v_xor_b32 v10, 128, v6
    v_mfma_f32_16x16x32_bf16 v[188:191], a[156:159], a[124:127], v[188:191]
    ds_read_b64_tr_b16 a[138:139], v42 offset:50184
    v_xor_b32 v11, 160, v6
    v_mfma_f32_16x16x32_bf16 v[184:187], a[156:159], a[116:119], v[184:187]
    ds_read_b64_tr_b16 a[140:141], v42 offset:57352
    v_xor_b32 v12, 192, v6
    v_mfma_f32_16x16x32_bf16 v[184:187], a[152:155], a[112:115], v[184:187]
    ds_read_b64_tr_b16 a[142:143], v42 offset:58376
    v_mfma_f32_16x16x32_bf16 v[180:183], a[152:155], a[104:107], v[180:183]
    buffer_load_dwordx4 v21, s[8:11], s80 offen offset:1024 lds
    v_mfma_f32_16x16x32_bf16 v[180:183], a[156:159], a[108:111], v[180:183]
    v_xor_b32 v13, 224, v6
    v_mfma_f32_16x16x32_bf16 v[176:179], a[156:159], a[100:103], v[176:179]
    v_mfma_f32_16x16x32_bf16 v[176:179], a[152:155], a[96:99], v[176:179]
    s_waitcnt lgkmcnt(4)
    v_mfma_f32_16x16x32_bf16 v[192:195], a[128:131], a[96:99], v[192:195]
    ds_read_b64_tr_b16 a[144:145], v43 offset:49152
    v_mfma_f32_16x16x32_bf16 v[192:195], a[132:135], a[100:103], v[192:195]
    ds_read_b64_tr_b16 a[146:147], v43 offset:50176
    v_mfma_f32_16x16x32_bf16 v[196:199], a[132:135], a[108:111], v[196:199]
    ds_read_b64_tr_b16 a[148:149], v43 offset:57344
    v_mfma_f32_16x16x32_bf16 v[196:199], a[128:131], a[104:107], v[196:199]
    ds_read_b64_tr_b16 a[150:151], v43 offset:58368
    v_mfma_f32_16x16x32_bf16 v[200:203], a[128:131], a[112:115], v[200:203]
    buffer_load_dwordx4 v22, s[8:11], s80 offen offset:2048 lds
    v_mfma_f32_16x16x32_bf16 v[200:203], a[132:135], a[116:119], v[200:203]
    v_mfma_f32_16x16x32_bf16 v[204:207], a[132:135], a[124:127], v[204:207]
    v_mfma_f32_16x16x32_bf16 v[204:207], a[128:131], a[120:123], v[204:207]
    s_waitcnt lgkmcnt(4)
    v_mfma_f32_16x16x32_bf16 v[220:223], a[136:139], a[120:123], v[220:223]
    ds_read_b64_tr_b16 a[152:153], v43 offset:49160
    v_mfma_f32_16x16x32_bf16 v[220:223], a[140:143], a[124:127], v[220:223]
    ds_read_b64_tr_b16 a[154:155], v43 offset:50184
    v_mfma_f32_16x16x32_bf16 v[216:219], a[140:143], a[116:119], v[216:219]
    ds_read_b64_tr_b16 a[156:157], v43 offset:57352
    v_mfma_f32_16x16x32_bf16 v[216:219], a[136:139], a[112:115], v[216:219]
    ds_read_b64_tr_b16 a[158:159], v43 offset:58376
    v_mfma_f32_16x16x32_bf16 v[212:215], a[136:139], a[104:107], v[212:215]
    buffer_load_dwordx4 v23, s[8:11], s80 offen offset:3072 lds
    v_mfma_f32_16x16x32_bf16 v[212:215], a[140:143], a[108:111], v[212:215]
    s_add_u32 m0, s79, 98304
    s_mov_b32 s80, 4718592
    v_mfma_f32_16x16x32_bf16 v[208:211], a[140:143], a[100:103], v[208:211]
    v_mfma_f32_16x16x32_bf16 v[208:211], a[136:139], a[96:99], v[208:211]
    s_waitcnt lgkmcnt(4)
    v_mfma_f32_16x16x32_bf16 v[224:227], a[144:147], a[96:99], v[224:227]
    ds_read_b64_tr_b16 a[128:129], v48 offset:24576
    v_mfma_f32_16x16x32_bf16 v[224:227], a[148:151], a[100:103], v[224:227]
    ds_read_b64_tr_b16 a[130:131], v48 offset:25088
    v_mfma_f32_16x16x32_bf16 v[228:231], a[148:151], a[108:111], v[228:231]
    ds_read_b64_tr_b16 a[132:133], v48 offset:28672
    v_mfma_f32_16x16x32_bf16 v[228:231], a[144:147], a[104:107], v[228:231]
    ds_read_b64_tr_b16 a[134:135], v48 offset:29184
    v_mfma_f32_16x16x32_bf16 v[232:235], a[144:147], a[112:115], v[232:235]
    buffer_load_dwordx4 v52, s[12:15], s80 offen offset:0 lds
    v_mfma_f32_16x16x32_bf16 v[232:235], a[148:151], a[116:119], v[232:235]
    v_mfma_f32_16x16x32_bf16 v[236:239], a[148:151], a[124:127], v[236:239]
    v_mfma_f32_16x16x32_bf16 v[236:239], a[144:147], a[120:123], v[236:239]
    s_waitcnt lgkmcnt(4)
    v_mfma_f32_16x16x32_bf16 v[252:255], a[152:155], a[120:123], v[252:255]
    ds_read_b64_tr_b16 a[136:137], v49 offset:24576
    v_mfma_f32_16x16x32_bf16 v[252:255], a[156:159], a[124:127], v[252:255]
    ds_read_b64_tr_b16 a[138:139], v49 offset:25088
    v_mfma_f32_16x16x32_bf16 v[248:251], a[156:159], a[116:119], v[248:251]
    ds_read_b64_tr_b16 a[140:141], v49 offset:28672
    v_mfma_f32_16x16x32_bf16 v[248:251], a[152:155], a[112:115], v[248:251]
    ds_read_b64_tr_b16 a[142:143], v49 offset:29184
    v_mfma_f32_16x16x32_bf16 v[244:247], a[152:155], a[104:107], v[244:247]
    buffer_load_dwordx4 v53, s[12:15], s80 offen offset:1024 lds
    v_mfma_f32_16x16x32_bf16 v[244:247], a[156:159], a[108:111], v[244:247]
    v_mfma_f32_16x16x32_bf16 v[240:243], a[156:159], a[100:103], v[240:243]
    v_mfma_f32_16x16x32_bf16 v[240:243], a[152:155], a[96:99], v[240:243]
    s_waitcnt lgkmcnt(4)
    v_mfma_f32_16x16x32_bf16 v[64:67], a[128:131], a[96:99], v[64:67]
    s_waitcnt vmcnt(16)
    ds_read_b64_tr_b16 a[144:145], v50 offset:24576
    ds_read_b128 a[64:67], v24 offset:0
    v_mfma_f32_16x16x32_bf16 v[64:67], a[132:135], a[100:103], v[64:67]
    ds_read_b64_tr_b16 a[146:147], v50 offset:25088
    ds_read_b128 a[68:71], v25 offset:0
    v_mfma_f32_16x16x32_bf16 v[68:71], a[132:135], a[108:111], v[68:71]
    ds_read_b64_tr_b16 a[148:149], v50 offset:28672
    ds_read_b128 a[72:75], v24 offset:2048
    v_mfma_f32_16x16x32_bf16 v[68:71], a[128:131], a[104:107], v[68:71]
    ds_read_b64_tr_b16 a[150:151], v50 offset:29184
    ds_read_b128 a[76:79], v25 offset:2048
    v_mfma_f32_16x16x32_bf16 v[72:75], a[128:131], a[112:115], v[72:75]
    ds_read_b128 a[80:83], v24 offset:4096
    ds_read_b128 a[84:87], v25 offset:4096
    v_mfma_f32_16x16x32_bf16 v[72:75], a[132:135], a[116:119], v[72:75]
    ds_read_b128 a[88:91], v24 offset:6144
    ds_read_b128 a[92:95], v25 offset:6144
    v_mfma_f32_16x16x32_bf16 v[76:79], a[132:135], a[124:127], v[76:79]
    buffer_load_dwordx4 v54, s[12:15], s80 offen offset:2048 lds
    v_mfma_f32_16x16x32_bf16 v[76:79], a[128:131], a[120:123], v[76:79]
    v_xor_b32 v24, 0x10000, v24
    v_xor_b32 v25, 0x10000, v25
    v_smfmac_f32_16x16x64_bf16 a[200:203], v[36:39], a[128:135], v35
    s_waitcnt lgkmcnt(12)
    v_mfma_f32_16x16x32_bf16 v[92:95], a[136:139], a[120:123], v[92:95]
    ds_read_b64_tr_b16 a[152:153], v51 offset:24576
    v_mfma_f32_16x16x32_bf16 v[92:95], a[140:143], a[124:127], v[92:95]
    ds_read_b64_tr_b16 a[154:155], v51 offset:25088
    v_mfma_f32_16x16x32_bf16 v[88:91], a[140:143], a[116:119], v[88:91]
    ds_read_b64_tr_b16 a[156:157], v51 offset:28672
    v_mfma_f32_16x16x32_bf16 v[88:91], a[136:139], a[112:115], v[88:91]
    ds_read_b64_tr_b16 a[158:159], v51 offset:29184
    v_mfma_f32_16x16x32_bf16 v[84:87], a[136:139], a[104:107], v[84:87]
    buffer_load_dwordx4 v55, s[12:15], s80 offen offset:3072 lds
    v_mfma_f32_16x16x32_bf16 v[84:87], a[140:143], a[108:111], v[84:87]
    s_add_u32 m0, s100, 139264
    s_mov_b32 s80, 1990656
    v_mfma_f32_16x16x32_bf16 v[80:83], a[140:143], a[100:103], v[80:83]
    v_mfma_f32_16x16x32_bf16 v[80:83], a[136:139], a[96:99], v[80:83]
    v_smfmac_f32_16x16x64_bf16 a[204:207], v[36:39], a[136:143], v35
    s_waitcnt lgkmcnt(9)
    v_mfma_f32_16x16x32_bf16 v[96:99], a[144:147], a[96:99], v[96:99]
    s_waitcnt lgkmcnt(4)
    s_waitcnt vmcnt(12)
    s_barrier
    v_mfma_f32_16x16x32_bf16 v[96:99], a[148:151], a[100:103], v[96:99]
    v_xor_b32 v40, 0x10000, v40
    ds_read_b64_tr_b16 a[128:129], v40 offset:49152
    v_mfma_f32_16x16x32_bf16 v[100:103], a[148:151], a[108:111], v[100:103]
    ds_read_b64_tr_b16 a[130:131], v40 offset:50176
    v_mfma_f32_16x16x32_bf16 v[100:103], a[144:147], a[104:107], v[100:103]
    ds_read_b64_tr_b16 a[132:133], v40 offset:57344
    v_mfma_f32_16x16x32_bf16 v[104:107], a[144:147], a[112:115], v[104:107]
    ds_read_b64_tr_b16 a[134:135], v40 offset:58368
    v_mfma_f32_16x16x32_bf16 v[104:107], a[148:151], a[116:119], v[104:107]
    buffer_load_dwordx4 v56, s[16:19], s80 offen offset:0 lds
    v_mfma_f32_16x16x32_bf16 v[108:111], a[148:151], a[124:127], v[108:111]
    v_mfma_f32_16x16x32_bf16 v[108:111], a[144:147], a[120:123], v[108:111]
    s_waitcnt lgkmcnt(4)
    v_mfma_f32_16x16x32_bf16 v[124:127], a[152:155], a[120:123], v[124:127]
    ds_read_b64_tr_b16 a[136:137], v40 offset:49160
    v_mfma_f32_16x16x32_bf16 v[124:127], a[156:159], a[124:127], v[124:127]
    ds_read_b64_tr_b16 a[138:139], v40 offset:50184
    v_mfma_f32_16x16x32_bf16 v[120:123], a[156:159], a[116:119], v[120:123]
    ds_read_b64_tr_b16 a[140:141], v40 offset:57352
    v_mfma_f32_16x16x32_bf16 v[120:123], a[152:155], a[112:115], v[120:123]
    ds_read_b64_tr_b16 a[142:143], v40 offset:58376
    v_mfma_f32_16x16x32_bf16 v[116:119], a[152:155], a[104:107], v[116:119]
    buffer_load_dwordx4 v57, s[16:19], s80 offen offset:1024 lds
    v_mfma_f32_16x16x32_bf16 v[116:119], a[156:159], a[108:111], v[116:119]
    v_mfma_f32_16x16x32_bf16 v[112:115], a[156:159], a[100:103], v[112:115]
    v_mfma_f32_16x16x32_bf16 v[112:115], a[152:155], a[96:99], v[112:115]
    s_waitcnt lgkmcnt(4)
    v_mfma_f32_16x16x32_bf16 v[128:131], a[128:131], a[64:67], v[128:131]
    s_bfe_u32 s4, s2, 0x20001
    v_xor_b32 v41, 0x10000, v41
    ds_read_b64_tr_b16 a[144:145], v41 offset:49152
    v_mfma_f32_16x16x32_bf16 v[128:131], a[132:135], a[68:71], v[128:131]
    s_and_b32 s5, s2, 1
    ds_read_b64_tr_b16 a[146:147], v41 offset:50176
    v_and_b32 v62, 7, v0
    v_mfma_f32_16x16x32_bf16 v[132:135], a[132:135], a[76:79], v[132:135]
    s_lshl_b32 s5, s5, 3
    ds_read_b64_tr_b16 a[148:149], v41 offset:57344
    v_lshlrev_b32 v62, 5, v62
    v_mfma_f32_16x16x32_bf16 v[132:135], a[128:131], a[72:75], v[132:135]
    s_bfe_u32 s6, s2, 0x30003
    ds_read_b64_tr_b16 a[150:151], v41 offset:58368
    s_add_u32 s5, s5, s6
    v_mfma_f32_16x16x32_bf16 v[136:139], a[128:131], a[80:83], v[136:139]
    s_lshr_b32 s6, s2, 6
    buffer_load_dword v63, v62, s[36:39], 0 offen sc1
    v_mfma_f32_16x16x32_bf16 v[136:139], a[132:135], a[84:87], v[136:139]
    s_mov_b32 m0, s72
    s_mov_b32 s80, 0
    s_lshl_b32 s5, s5, 2
    v_mfma_f32_16x16x32_bf16 v[140:143], a[132:135], a[92:95], v[140:143]
    s_add_u32 s5, s5, s6
    s_lshl_b32 s13, s5, 8
    s_add_u32 s13, s13, 28672
    v_mfma_f32_16x16x32_bf16 v[140:143], a[128:131], a[88:91], v[140:143]
    s_mul_i32 s5, s5, 262144
    s_mul_i32 s6, s76, 16384
    s_add_u32 s5, s5, s6
    v_smfmac_f32_16x16x64_bf16 a[192:195], v[36:39], a[128:135], v35
    s_waitcnt lgkmcnt(4)
    s_add_u32 s5, s5, 100663296
    s_add_u32 s48, s40, s5
    s_addc_u32 s49, s41, 0
    v_mfma_f32_16x16x32_bf16 v[156:159], a[136:139], a[88:91], v[156:159]
    s_mov_b32 s50, 212992
    ds_read_b64_tr_b16 a[152:153], v41 offset:49160
    s_mov_b32 s51, 0x00020000
    v_mfma_f32_16x16x32_bf16 v[156:159], a[140:143], a[92:95], v[156:159]
    s_mul_i32 s15, s76, 5120
    ds_read_b64_tr_b16 a[154:155], v41 offset:50184
    s_xor_b32 s5, s4, 1
    v_mfma_f32_16x16x32_bf16 v[152:155], a[140:143], a[84:87], v[152:155]
    s_mul_i32 s5, s5, 65536
    ds_read_b64_tr_b16 a[156:157], v41 offset:57352
    s_add_u32 s17, s5, 0
    v_mfma_f32_16x16x32_bf16 v[152:155], a[136:139], a[80:83], v[152:155]
    s_xor_b32 s5, s4, 2
    ds_read_b64_tr_b16 a[158:159], v41 offset:58376
    s_mul_i32 s5, s5, 65536
    v_mfma_f32_16x16x32_bf16 v[148:151], a[136:139], a[72:75], v[148:151]
    s_add_u32 s18, s5, 2560
    buffer_load_dwordx4 v18, s[24:27], s80 offen offset:0 lds
    v_mfma_f32_16x16x32_bf16 v[148:151], a[140:143], a[76:79], v[148:151]
    s_xor_b32 s5, s4, 3
    s_mul_i32 s5, s5, 65536
    s_add_u32 s19, s5, 5120
    v_mfma_f32_16x16x32_bf16 v[144:147], a[140:143], a[68:71], v[144:147]
    s_mul_i32 s16, s4, 65536
    s_add_u32 s14, s16, 2560
    s_add_u32 s12, s16, 5120
    v_mfma_f32_16x16x32_bf16 v[144:147], a[136:139], a[64:67], v[144:147]
    v_and_b32 v20, 7, v0
    v_lshlrev_b32 v20, 8, v20
    v_smfmac_f32_16x16x64_bf16 a[196:199], v[36:39], a[136:143], v35
    s_waitcnt lgkmcnt(4)
    v_add_u32 v20, 16384, v20
    s_mul_i32 s5, s76, 10240
    v_mfma_f32_16x16x32_bf16 v[160:163], a[144:147], a[64:67], v[160:163]
    v_xor_b32 v42, 0x10000, v42
    ds_read_b64_tr_b16 a[128:129], v42 offset:49152
    v_mfma_f32_16x16x32_bf16 v[160:163], a[148:151], a[68:71], v[160:163]
    ds_read_b64_tr_b16 a[130:131], v42 offset:50176
    v_mul_u32_u24 v27, 1280, v29
    v_mfma_f32_16x16x32_bf16 v[164:167], a[148:151], a[76:79], v[164:167]
    ds_read_b64_tr_b16 a[132:133], v42 offset:57344
    v_add_u32 v27, s5, v27
    v_mfma_f32_16x16x32_bf16 v[164:167], a[144:147], a[72:75], v[164:167]
    ds_read_b64_tr_b16 a[134:135], v42 offset:58368
    v_mfma_f32_16x16x32_bf16 v[168:171], a[144:147], a[80:83], v[168:171]
    buffer_load_dwordx4 v19, s[24:27], s80 offen offset:1024 lds
    v_mfma_f32_16x16x32_bf16 v[168:171], a[148:151], a[84:87], v[168:171]
    v_lshlrev_b32 v26, 2, v29
    v_xor_b32 v26, v26, v28
    v_mfma_f32_16x16x32_bf16 v[172:175], a[148:151], a[92:95], v[172:175]
    v_lshl_add_u32 v22, v26, 4, v27
    v_lshrrev_b32 v26, 2, v0
    v_mfma_f32_16x16x32_bf16 v[172:175], a[144:147], a[88:91], v[172:175]
    s_waitcnt lgkmcnt(4)
    v_and_b32 v27, 3, v26
    v_xor_b32 v27, s76, v27
    v_mfma_f32_16x16x32_bf16 v[188:191], a[152:155], a[88:91], v[188:191]
    ds_read_b64_tr_b16 a[136:137], v42 offset:49160
    v_lshlrev_b32 v27, 6, v27
    v_mfma_f32_16x16x32_bf16 v[188:191], a[156:159], a[92:95], v[188:191]
    ds_read_b64_tr_b16 a[138:139], v42 offset:50184
    v_lshl_add_u32 v27, v26, 8, v27
    v_mfma_f32_16x16x32_bf16 v[184:187], a[156:159], a[84:87], v[184:187]
    ds_read_b64_tr_b16 a[140:141], v42 offset:57352
    v_lshl_add_u32 v27, v31, 3, v27
    v_mfma_f32_16x16x32_bf16 v[184:187], a[152:155], a[80:83], v[184:187]
    ds_read_b64_tr_b16 a[142:143], v42 offset:58376
    v_mfma_f32_16x16x32_bf16 v[180:183], a[152:155], a[72:75], v[180:183]
    buffer_load_dwordx4 v18, s[24:27], s80 offen offset:2048 lds
    v_mfma_f32_16x16x32_bf16 v[180:183], a[156:159], a[76:79], v[180:183]
    v_add_u32 v23, 131072, v27
    v_mfma_f32_16x16x32_bf16 v[176:179], a[156:159], a[68:71], v[176:179]
    v_mfma_f32_16x16x32_bf16 v[176:179], a[152:155], a[64:67], v[176:179]
    s_waitcnt lgkmcnt(4)
    v_mfma_f32_16x16x32_bf16 v[192:195], a[128:131], a[64:67], v[192:195]
    v_xor_b32 v43, 0x10000, v43
    ds_read_b64_tr_b16 a[144:145], v43 offset:49152
    v_mfma_f32_16x16x32_bf16 v[192:195], a[132:135], a[68:71], v[192:195]
    ds_read_b64_tr_b16 a[146:147], v43 offset:50176
    v_mfma_f32_16x16x32_bf16 v[196:199], a[132:135], a[76:79], v[196:199]
    ds_read_b64_tr_b16 a[148:149], v43 offset:57344
    v_mfma_f32_16x16x32_bf16 v[196:199], a[128:131], a[72:75], v[196:199]
    ds_read_b64_tr_b16 a[150:151], v43 offset:58368
    v_mfma_f32_16x16x32_bf16 v[200:203], a[128:131], a[80:83], v[200:203]
    buffer_load_dwordx4 v19, s[24:27], s80 offen offset:3072 lds
    v_mfma_f32_16x16x32_bf16 v[200:203], a[132:135], a[84:87], v[200:203]
    s_mov_b32 m0, s73
    s_mov_b32 s80, 16384
    v_mfma_f32_16x16x32_bf16 v[204:207], a[132:135], a[92:95], v[204:207]
    v_mfma_f32_16x16x32_bf16 v[204:207], a[128:131], a[88:91], v[204:207]
    s_waitcnt lgkmcnt(4)
    v_mfma_f32_16x16x32_bf16 v[220:223], a[136:139], a[88:91], v[220:223]
    ds_read_b64_tr_b16 a[152:153], v43 offset:49160
    v_mfma_f32_16x16x32_bf16 v[220:223], a[140:143], a[92:95], v[220:223]
    ds_read_b64_tr_b16 a[154:155], v43 offset:50184
    v_mfma_f32_16x16x32_bf16 v[216:219], a[140:143], a[84:87], v[216:219]
    ds_read_b64_tr_b16 a[156:157], v43 offset:57352
    v_mfma_f32_16x16x32_bf16 v[216:219], a[136:139], a[80:83], v[216:219]
    ds_read_b64_tr_b16 a[158:159], v43 offset:58376
    v_mfma_f32_16x16x32_bf16 v[212:215], a[136:139], a[72:75], v[212:215]
    buffer_load_dwordx4 v18, s[24:27], s80 offen offset:0 lds
    v_mfma_f32_16x16x32_bf16 v[212:215], a[140:143], a[76:79], v[212:215]
    v_mfma_f32_16x16x32_bf16 v[208:211], a[140:143], a[68:71], v[208:211]
    v_mfma_f32_16x16x32_bf16 v[208:211], a[136:139], a[64:67], v[208:211]
    s_waitcnt lgkmcnt(4)
    v_mfma_f32_16x16x32_bf16 v[224:227], a[144:147], a[64:67], v[224:227]
    ds_read_b64_tr_b16 a[128:129], v48 offset:0
    v_mfma_f32_16x16x32_bf16 v[224:227], a[148:151], a[68:71], v[224:227]
    ds_read_b64_tr_b16 a[130:131], v48 offset:512
    v_mfma_f32_16x16x32_bf16 v[228:231], a[148:151], a[76:79], v[228:231]
    ds_read_b64_tr_b16 a[132:133], v48 offset:4096
    v_mfma_f32_16x16x32_bf16 v[228:231], a[144:147], a[72:75], v[228:231]
    ds_read_b64_tr_b16 a[134:135], v48 offset:4608
    v_mfma_f32_16x16x32_bf16 v[232:235], a[144:147], a[80:83], v[232:235]
    buffer_load_dwordx4 v19, s[24:27], s80 offen offset:1024 lds
    v_mfma_f32_16x16x32_bf16 v[232:235], a[148:151], a[84:87], v[232:235]
    v_mfma_f32_16x16x32_bf16 v[236:239], a[148:151], a[92:95], v[236:239]
    v_mfma_f32_16x16x32_bf16 v[236:239], a[144:147], a[88:91], v[236:239]
    s_waitcnt lgkmcnt(4)
    v_mfma_f32_16x16x32_bf16 v[252:255], a[152:155], a[88:91], v[252:255]
    ds_read_b64_tr_b16 a[136:137], v49 offset:0
    v_mfma_f32_16x16x32_bf16 v[252:255], a[156:159], a[92:95], v[252:255]
    ds_read_b64_tr_b16 a[138:139], v49 offset:512
    v_mfma_f32_16x16x32_bf16 v[248:251], a[156:159], a[84:87], v[248:251]
    ds_read_b64_tr_b16 a[140:141], v49 offset:4096
    v_mfma_f32_16x16x32_bf16 v[248:251], a[152:155], a[80:83], v[248:251]
    ds_read_b64_tr_b16 a[142:143], v49 offset:4608
    v_mfma_f32_16x16x32_bf16 v[244:247], a[152:155], a[72:75], v[244:247]
    buffer_load_dwordx4 v18, s[24:27], s80 offen offset:2048 lds
    v_mfma_f32_16x16x32_bf16 v[244:247], a[156:159], a[76:79], v[244:247]
    v_mfma_f32_16x16x32_bf16 v[240:243], a[156:159], a[68:71], v[240:243]
    v_mfma_f32_16x16x32_bf16 v[240:243], a[152:155], a[64:67], v[240:243]
    s_waitcnt lgkmcnt(4)
    v_mfma_f32_16x16x32_bf16 v[64:67], a[128:131], a[64:67], v[64:67]
    s_waitcnt vmcnt(14)
    ds_read_b64_tr_b16 a[144:145], v50 offset:0
    ds_read_b128 a[96:99], v24 offset:0
    v_mfma_f32_16x16x32_bf16 v[64:67], a[132:135], a[68:71], v[64:67]
    ds_read_b64_tr_b16 a[146:147], v50 offset:512
    ds_read_b128 a[100:103], v25 offset:0
    v_mfma_f32_16x16x32_bf16 v[68:71], a[132:135], a[76:79], v[68:71]
    ds_read_b64_tr_b16 a[148:149], v50 offset:4096
    ds_read_b128 a[104:107], v24 offset:2048
    v_mfma_f32_16x16x32_bf16 v[68:71], a[128:131], a[72:75], v[68:71]
    ds_read_b64_tr_b16 a[150:151], v50 offset:4608
    ds_read_b128 a[108:111], v25 offset:2048
    v_mfma_f32_16x16x32_bf16 v[72:75], a[128:131], a[80:83], v[72:75]
    ds_read_b128 a[112:115], v24 offset:4096
    ds_read_b128 a[116:119], v25 offset:4096
    v_mfma_f32_16x16x32_bf16 v[72:75], a[132:135], a[84:87], v[72:75]
    ds_read_b128 a[120:123], v24 offset:6144
    ds_read_b128 a[124:127], v25 offset:6144
    v_mfma_f32_16x16x32_bf16 v[76:79], a[132:135], a[92:95], v[76:79]
    buffer_load_dwordx4 v19, s[24:27], s80 offen offset:3072 lds
    v_mfma_f32_16x16x32_bf16 v[76:79], a[128:131], a[88:91], v[76:79]
    v_xor_b32 v24, 0x10000, v24
    v_xor_b32 v25, 0x10000, v25
    v_smfmac_f32_16x16x64_bf16 a[200:203], v[36:39], a[128:135], v35
    s_waitcnt lgkmcnt(12)
    v_mfma_f32_16x16x32_bf16 v[92:95], a[136:139], a[88:91], v[92:95]
    s_waitcnt vmcnt(8)
    ds_read_b64_tr_b16 a[152:153], v51 offset:0
    v_cmp_gt_u32 vcc, 32, v63
    v_mfma_f32_16x16x32_bf16 v[92:95], a[140:143], a[92:95], v[92:95]
    s_cbranch_vccnz M_ps_spin
M_ps_back:
    ds_read_b64_tr_b16 a[154:155], v51 offset:512
    s_lshl_b32 s5, s78, 2
    v_mfma_f32_16x16x32_bf16 v[88:91], a[140:143], a[84:87], v[88:91]
    s_add_u32 s5, s5, s76
    ds_read_b64_tr_b16 a[156:157], v51 offset:4096
    s_lshl_b32 s5, s5, 9
    v_mfma_f32_16x16x32_bf16 v[88:91], a[136:139], a[80:83], v[88:91]
    ds_read_b64_tr_b16 a[158:159], v51 offset:4608
    v_mfma_f32_16x16x32_bf16 v[84:87], a[136:139], a[72:75], v[84:87]
    v_mfma_f32_16x16x32_bf16 v[84:87], a[140:143], a[76:79], v[84:87]
    v_mfma_f32_16x16x32_bf16 v[80:83], a[140:143], a[68:71], v[80:83]
    v_mfma_f32_16x16x32_bf16 v[80:83], a[136:139], a[64:67], v[80:83]
    v_lshlrev_b32 v62, 3, v28
    v_smfmac_f32_16x16x64_bf16 a[204:207], v[36:39], a[136:143], v35
    s_waitcnt lgkmcnt(9)
    v_mfma_f32_16x16x32_bf16 v[96:99], a[144:147], a[64:67], v[96:99]
    s_waitcnt lgkmcnt(4)
    s_waitcnt vmcnt(9)
    s_barrier
    v_mfma_f32_16x16x32_bf16 v[96:99], a[148:151], a[68:71], v[96:99]
    ds_read_b64_tr_b16 a[128:129], v40 offset:32768
    v_mfma_f32_16x16x32_bf16 v[100:103], a[148:151], a[76:79], v[100:103]
    ds_read_b64_tr_b16 a[130:131], v40 offset:33792
    v_mfma_f32_16x16x32_bf16 v[100:103], a[144:147], a[72:75], v[100:103]
    ds_read_b64_tr_b16 a[132:133], v40 offset:40960
    v_mfma_f32_16x16x32_bf16 v[104:107], a[144:147], a[80:83], v[104:107]
    ds_read_b64_tr_b16 a[134:135], v40 offset:41984
    v_mfma_f32_16x16x32_bf16 v[104:107], a[148:151], a[84:87], v[104:107]
    buffer_load_dwordx2 v[52:53], v62, s[40:43], s5 offen offset:0 sc1
    v_mfma_f32_16x16x32_bf16 v[108:111], a[148:151], a[92:95], v[108:111]
    buffer_load_dwordx2 v[54:55], v62, s[40:43], s5 offen offset:128 sc1
    v_mfma_f32_16x16x32_bf16 v[108:111], a[144:147], a[88:91], v[108:111]
    s_waitcnt lgkmcnt(4)
    buffer_load_dwordx2 v[56:57], v62, s[40:43], s5 offen offset:256 sc1
    v_mfma_f32_16x16x32_bf16 v[124:127], a[152:155], a[88:91], v[124:127]
    ds_read_b64_tr_b16 a[136:137], v40 offset:32776
    v_mfma_f32_16x16x32_bf16 v[124:127], a[156:159], a[92:95], v[124:127]
    ds_read_b64_tr_b16 a[138:139], v40 offset:33800
    v_mfma_f32_16x16x32_bf16 v[120:123], a[156:159], a[84:87], v[120:123]
    ds_read_b64_tr_b16 a[140:141], v40 offset:40968
    v_mfma_f32_16x16x32_bf16 v[120:123], a[152:155], a[80:83], v[120:123]
    ds_read_b64_tr_b16 a[142:143], v40 offset:41992
    v_mfma_f32_16x16x32_bf16 v[116:119], a[152:155], a[72:75], v[116:119]
    buffer_load_dwordx2 v[58:59], v62, s[40:43], s5 offen offset:384 sc1
    v_mfma_f32_16x16x32_bf16 v[116:119], a[156:159], a[76:79], v[116:119]
    s_mov_b32 m0, s68
    s_mov_b32 s80, 0
    v_mfma_f32_16x16x32_bf16 v[112:115], a[156:159], a[68:71], v[112:115]
    buffer_load_dwordx4 v14, s[20:23], s80 offen offset:0 lds
    v_mfma_f32_16x16x32_bf16 v[112:115], a[152:155], a[64:67], v[112:115]
    s_waitcnt lgkmcnt(4)
    buffer_load_dwordx4 v15, s[20:23], s80 offen offset:1024 lds
    v_mfma_f32_16x16x32_bf16 v[128:131], a[128:131], a[96:99], v[128:131]
    s_lshl_b32 s5, s76, 7
    ds_read_b64_tr_b16 a[144:145], v48 offset:8192
    s_add_u32 s5, s5, 155648
    v_mfma_f32_16x16x32_bf16 v[128:131], a[132:135], a[100:103], v[128:131]
    ds_read_b64_tr_b16 a[146:147], v48 offset:8704
    v_lshl_add_u32 v60, v28, 2, s5
    v_mfma_f32_16x16x32_bf16 v[132:135], a[132:135], a[108:111], v[132:135]
    s_and_b32 s6, s76, 2
    ds_read_b64_tr_b16 a[148:149], v48 offset:12288
    s_lshl_b32 s6, s6, 6
    v_mfma_f32_16x16x32_bf16 v[132:135], a[128:131], a[104:107], v[132:135]
    s_add_u32 s6, s6, 156160
    ds_read_b64_tr_b16 a[150:151], v48 offset:12800
    v_mfma_f32_16x16x32_bf16 v[136:139], a[128:131], a[112:115], v[136:139]
    buffer_load_dwordx4 v16, s[20:23], s80 offen offset:2048 lds
    v_mfma_f32_16x16x32_bf16 v[136:139], a[132:135], a[116:119], v[136:139]
    v_lshl_add_u32 v61, v28, 2, s6
    v_mfma_f32_16x16x32_bf16 v[140:143], a[132:135], a[124:127], v[140:143]
    v_mfma_f32_16x16x32_bf16 v[140:143], a[128:131], a[120:123], v[140:143]
    v_smfmac_f32_16x16x64_bf16 a[192:195], v[36:39], a[128:135], v35
    s_waitcnt lgkmcnt(4)
    v_mfma_f32_16x16x32_bf16 v[156:159], a[136:139], a[120:123], v[156:159]
    ds_read_b64_tr_b16 a[152:153], v49 offset:8192
    v_mfma_f32_16x16x32_bf16 v[156:159], a[140:143], a[124:127], v[156:159]
    ds_read_b64_tr_b16 a[154:155], v49 offset:8704
    v_mfma_f32_16x16x32_bf16 v[152:155], a[140:143], a[116:119], v[152:155]
    ds_read_b64_tr_b16 a[156:157], v49 offset:12288
    v_mfma_f32_16x16x32_bf16 v[152:155], a[136:139], a[112:115], v[152:155]
    ds_read_b64_tr_b16 a[158:159], v49 offset:12800
    v_mfma_f32_16x16x32_bf16 v[148:151], a[136:139], a[104:107], v[148:151]
    buffer_load_dwordx4 v17, s[20:23], s80 offen offset:3072 lds
    v_mfma_f32_16x16x32_bf16 v[148:151], a[140:143], a[108:111], v[148:151]
    s_mov_b32 m0, s69
    s_mov_b32 s80, 16384
    v_accvgpr_read_b32 v62, a192
    v_mfma_f32_16x16x32_bf16 v[144:147], a[140:143], a[100:103], v[144:147]
    v_accvgpr_read_b32 v63, a193
    v_add_f32 v24, v62, v63
    v_mfma_f32_16x16x32_bf16 v[144:147], a[136:139], a[96:99], v[144:147]
    ds_write_b32 v60, v24 offset:0
    v_smfmac_f32_16x16x64_bf16 a[196:199], v[36:39], a[136:143], v35
    s_waitcnt lgkmcnt(5)
    v_mfma_f32_16x16x32_bf16 v[64:67], a[144:147], a[96:99], v[64:67]
    ds_read_b64_tr_b16 a[128:129], v41 offset:32768
    v_mfma_f32_16x16x32_bf16 v[64:67], a[148:151], a[100:103], v[64:67]
    ds_read_b64_tr_b16 a[130:131], v41 offset:33792
    v_mfma_f32_16x16x32_bf16 v[68:71], a[148:151], a[108:111], v[68:71]
    ds_read_b64_tr_b16 a[132:133], v41 offset:40960
    v_mfma_f32_16x16x32_bf16 v[68:71], a[144:147], a[104:107], v[68:71]
    ds_read_b64_tr_b16 a[134:135], v41 offset:41984
    v_mfma_f32_16x16x32_bf16 v[72:75], a[144:147], a[112:115], v[72:75]
    buffer_load_dwordx4 v14, s[20:23], s80 offen offset:0 lds
    v_mfma_f32_16x16x32_bf16 v[72:75], a[148:151], a[116:119], v[72:75]
    v_accvgpr_read_b32 v62, a196
    v_accvgpr_read_b32 v63, a197
    v_mfma_f32_16x16x32_bf16 v[76:79], a[148:151], a[124:127], v[76:79]
    v_add_f32 v25, v62, v63
    v_mfma_f32_16x16x32_bf16 v[76:79], a[144:147], a[120:123], v[76:79]
    ds_write_b32 v60, v25 offset:64
    v_smfmac_f32_16x16x64_bf16 a[200:203], v[36:39], a[144:151], v35
    s_waitcnt lgkmcnt(6)
    v_mfma_f32_16x16x32_bf16 v[92:95], a[152:155], a[120:123], v[92:95]
    ds_read_b64_tr_b16 a[136:137], v41 offset:32776
    v_mfma_f32_16x16x32_bf16 v[92:95], a[156:159], a[124:127], v[92:95]
    ds_read_b64_tr_b16 a[138:139], v41 offset:33800
    v_mfma_f32_16x16x32_bf16 v[88:91], a[156:159], a[116:119], v[88:91]
    ds_read_b64_tr_b16 a[140:141], v41 offset:40968
    v_mfma_f32_16x16x32_bf16 v[88:91], a[152:155], a[112:115], v[88:91]
    ds_read_b64_tr_b16 a[142:143], v41 offset:41992
    v_mfma_f32_16x16x32_bf16 v[84:87], a[152:155], a[104:107], v[84:87]
    buffer_load_dwordx4 v15, s[20:23], s80 offen offset:1024 lds
    v_mfma_f32_16x16x32_bf16 v[84:87], a[156:159], a[108:111], v[84:87]
    v_accvgpr_read_b32 v62, a200
    v_accvgpr_read_b32 v63, a201
    v_mfma_f32_16x16x32_bf16 v[80:83], a[156:159], a[100:103], v[80:83]
    v_add_f32 v26, v62, v63
    v_mfma_f32_16x16x32_bf16 v[80:83], a[152:155], a[96:99], v[80:83]
    ds_write_b32 v61, v26 offset:0
    v_smfmac_f32_16x16x64_bf16 a[204:207], v[36:39], a[152:159], v35
    s_waitcnt lgkmcnt(6)
    v_mfma_f32_16x16x32_bf16 v[160:163], a[128:131], a[96:99], v[160:163]
    ds_read_b64_tr_b16 a[144:145], v42 offset:32768
    v_mfma_f32_16x16x32_bf16 v[160:163], a[132:135], a[100:103], v[160:163]
    ds_read_b64_tr_b16 a[146:147], v42 offset:33792
    v_mfma_f32_16x16x32_bf16 v[164:167], a[132:135], a[108:111], v[164:167]
    ds_read_b64_tr_b16 a[148:149], v42 offset:40960
    v_mfma_f32_16x16x32_bf16 v[164:167], a[128:131], a[104:107], v[164:167]
    ds_read_b64_tr_b16 a[150:151], v42 offset:41984
    v_mfma_f32_16x16x32_bf16 v[168:171], a[128:131], a[112:115], v[168:171]
    buffer_load_dwordx4 v16, s[20:23], s80 offen offset:2048 lds
    v_mfma_f32_16x16x32_bf16 v[168:171], a[132:135], a[116:119], v[168:171]
    v_accvgpr_read_b32 v62, a204
    v_accvgpr_read_b32 v63, a205
    v_mfma_f32_16x16x32_bf16 v[172:175], a[132:135], a[124:127], v[172:175]
    v_add_f32 v27, v62, v63
    v_mfma_f32_16x16x32_bf16 v[172:175], a[128:131], a[120:123], v[172:175]
    s_waitcnt lgkmcnt(5)
    ds_write_b32 v61, v27 offset:64
    v_mfma_f32_16x16x32_bf16 v[188:191], a[136:139], a[120:123], v[188:191]
    s_waitcnt lgkmcnt(0)
    s_barrier
    v_lshl_add_u32 v60, v29, 4, s5
    v_mfma_f32_16x16x32_bf16 v[188:191], a[140:143], a[124:127], v[188:191]
    ds_read_b64_tr_b16 a[152:153], v42 offset:32776
    v_lshl_add_u32 v61, v29, 4, s6
    v_mfma_f32_16x16x32_bf16 v[184:187], a[140:143], a[116:119], v[184:187]
    ds_read_b64_tr_b16 a[154:155], v42 offset:33800
    ds_read_b128 v[44:47], v60 offset:0
    v_mfma_f32_16x16x32_bf16 v[184:187], a[136:139], a[112:115], v[184:187]
    ds_read_b64_tr_b16 a[156:157], v42 offset:40968
    ds_read_b128 v[24:27], v60 offset:64
    v_mfma_f32_16x16x32_bf16 v[180:183], a[136:139], a[104:107], v[180:183]
    ds_read_b64_tr_b16 a[158:159], v42 offset:41992
    v_mfma_f32_16x16x32_bf16 v[180:183], a[140:143], a[108:111], v[180:183]
    buffer_load_dwordx4 v17, s[20:23], s80 offen offset:3072 lds
    v_mfma_f32_16x16x32_bf16 v[176:179], a[140:143], a[100:103], v[176:179]
    s_mov_b32 m0, s70
    s_mov_b32 s80, 32768
    v_xor_b32 v60, 128, v60
    v_mfma_f32_16x16x32_bf16 v[176:179], a[136:139], a[96:99], v[176:179]
    s_waitcnt lgkmcnt(7)
    s_waitcnt vmcnt(8)
    s_mov_b32 s6, 0x3e0293ee
    v_mul_f32 v30, s6, v53
    v_mul_f32 v31, s6, v55
    v_mul_f32 v62, s6, v57
    v_mul_f32 v63, s6, v59
    s_waitcnt lgkmcnt(1)
    v_pk_fma_f32 v[128:129], v[44:45], v[52:53], v[128:129] op_sel_hi:[1,0,1]
    v_pk_fma_f32 v[130:131], v[46:47], v[52:53], v[130:131] op_sel_hi:[1,0,1]
    v_pk_fma_f32 v[144:145], v[24:25], v[52:53], v[144:145] op_sel_hi:[1,0,1]
    v_pk_fma_f32 v[146:147], v[26:27], v[52:53], v[146:147] op_sel_hi:[1,0,1]
    v_pk_fma_f32 v[132:133], v[44:45], v[54:55], v[132:133] op_sel_hi:[1,0,1]
    v_pk_fma_f32 v[134:135], v[46:47], v[54:55], v[134:135] op_sel_hi:[1,0,1]
    v_pk_fma_f32 v[148:149], v[24:25], v[54:55], v[148:149] op_sel_hi:[1,0,1]
    v_pk_fma_f32 v[150:151], v[26:27], v[54:55], v[150:151] op_sel_hi:[1,0,1]
    v_pk_fma_f32 v[136:137], v[44:45], v[56:57], v[136:137] op_sel_hi:[1,0,1]
    v_pk_fma_f32 v[138:139], v[46:47], v[56:57], v[138:139] op_sel_hi:[1,0,1]
    v_pk_fma_f32 v[152:153], v[24:25], v[56:57], v[152:153] op_sel_hi:[1,0,1]
    v_pk_fma_f32 v[154:155], v[26:27], v[56:57], v[154:155] op_sel_hi:[1,0,1]
    v_pk_fma_f32 v[140:141], v[44:45], v[58:59], v[140:141] op_sel_hi:[1,0,1]
    v_pk_fma_f32 v[142:143], v[46:47], v[58:59], v[142:143] op_sel_hi:[1,0,1]
    v_pk_fma_f32 v[156:157], v[24:25], v[58:59], v[156:157] op_sel_hi:[1,0,1]
    v_pk_fma_f32 v[158:159], v[26:27], v[58:59], v[158:159] op_sel_hi:[1,0,1]
    ds_read_b128 v[44:47], v60 offset:0
    ds_read_b128 v[24:27], v60 offset:64
    v_xor_b32 v60, 384, v60
    v_pk_mul_f32 v[128:129], v[128:129], v[30:31] op_sel_hi:[1,0]
    v_pk_mul_f32 v[130:131], v[130:131], v[30:31] op_sel_hi:[1,0]
    v_pk_mul_f32 v[144:145], v[144:145], v[30:31] op_sel_hi:[1,0]
    v_pk_mul_f32 v[146:147], v[146:147], v[30:31] op_sel_hi:[1,0]
    v_pk_mul_f32 v[132:133], v[132:133], v[30:31] op_sel:[0,1] op_sel_hi:[1,1]
    v_pk_mul_f32 v[134:135], v[134:135], v[30:31] op_sel:[0,1] op_sel_hi:[1,1]
    v_pk_mul_f32 v[148:149], v[148:149], v[30:31] op_sel:[0,1] op_sel_hi:[1,1]
    v_pk_mul_f32 v[150:151], v[150:151], v[30:31] op_sel:[0,1] op_sel_hi:[1,1]
    v_pk_mul_f32 v[136:137], v[136:137], v[62:63] op_sel_hi:[1,0]
    v_pk_mul_f32 v[138:139], v[138:139], v[62:63] op_sel_hi:[1,0]
    v_pk_mul_f32 v[152:153], v[152:153], v[62:63] op_sel_hi:[1,0]
    v_pk_mul_f32 v[154:155], v[154:155], v[62:63] op_sel_hi:[1,0]
    v_pk_mul_f32 v[140:141], v[140:141], v[62:63] op_sel:[0,1] op_sel_hi:[1,1]
    v_pk_mul_f32 v[142:143], v[142:143], v[62:63] op_sel:[0,1] op_sel_hi:[1,1]
    v_pk_mul_f32 v[156:157], v[156:157], v[62:63] op_sel:[0,1] op_sel_hi:[1,1]
    v_pk_mul_f32 v[158:159], v[158:159], v[62:63] op_sel:[0,1] op_sel_hi:[1,1]
    v_mfma_f32_16x16x32_bf16 v[192:195], a[144:147], a[96:99], v[192:195]
    ds_read_b64_tr_b16 a[128:129], v43 offset:32768
    v_cvt_pk_bf16_f32 v128, v128, v129
    v_mfma_f32_16x16x32_bf16 v[192:195], a[148:151], a[100:103], v[192:195]
    ds_read_b64_tr_b16 a[130:131], v43 offset:33792
    v_cvt_pk_bf16_f32 v130, v130, v131
    v_mfma_f32_16x16x32_bf16 v[196:199], a[148:151], a[108:111], v[196:199]
    ds_read_b64_tr_b16 a[132:133], v43 offset:40960
    v_cvt_pk_bf16_f32 v144, v144, v145
    v_mfma_f32_16x16x32_bf16 v[196:199], a[144:147], a[104:107], v[196:199]
    ds_read_b64_tr_b16 a[134:135], v43 offset:41984
    v_mfma_f32_16x16x32_bf16 v[200:203], a[144:147], a[112:115], v[200:203]
    buffer_load_dwordx4 v14, s[20:23], s80 offen offset:0 lds
    v_mfma_f32_16x16x32_bf16 v[200:203], a[148:151], a[116:119], v[200:203]
    v_cvt_pk_bf16_f32 v146, v146, v147
    v_accvgpr_write_b32 a0, v128
    v_mfma_f32_16x16x32_bf16 v[204:207], a[148:151], a[124:127], v[204:207]
    v_accvgpr_write_b32 a1, v130
    v_accvgpr_write_b32 a2, v144
    v_mfma_f32_16x16x32_bf16 v[204:207], a[144:147], a[120:123], v[204:207]
    s_waitcnt lgkmcnt(6)
    v_accvgpr_write_b32 a3, v146
    v_cvt_pk_bf16_f32 v132, v132, v133
    v_mfma_f32_16x16x32_bf16 v[220:223], a[152:155], a[120:123], v[220:223]
    ds_read_b64_tr_b16 a[136:137], v43 offset:32776
    v_cvt_pk_bf16_f32 v134, v134, v135
    v_mfma_f32_16x16x32_bf16 v[220:223], a[156:159], a[124:127], v[220:223]
    ds_read_b64_tr_b16 a[138:139], v43 offset:33800
    v_cvt_pk_bf16_f32 v148, v148, v149
    v_mfma_f32_16x16x32_bf16 v[216:219], a[156:159], a[116:119], v[216:219]
    ds_read_b64_tr_b16 a[140:141], v43 offset:40968
    v_cvt_pk_bf16_f32 v150, v150, v151
    v_mfma_f32_16x16x32_bf16 v[216:219], a[152:155], a[112:115], v[216:219]
    ds_read_b64_tr_b16 a[142:143], v43 offset:41992
    v_mfma_f32_16x16x32_bf16 v[212:215], a[152:155], a[104:107], v[212:215]
    buffer_load_dwordx4 v15, s[20:23], s80 offen offset:1024 lds
    v_mfma_f32_16x16x32_bf16 v[212:215], a[156:159], a[108:111], v[212:215]
    v_accvgpr_write_b32 a16, v132
    v_accvgpr_write_b32 a17, v134
    v_mfma_f32_16x16x32_bf16 v[208:211], a[156:159], a[100:103], v[208:211]
    v_accvgpr_write_b32 a18, v148
    v_accvgpr_write_b32 a19, v150
    v_mfma_f32_16x16x32_bf16 v[208:211], a[152:155], a[96:99], v[208:211]
    s_waitcnt lgkmcnt(4)
    v_cvt_pk_bf16_f32 v136, v136, v137
    v_cvt_pk_bf16_f32 v138, v138, v139
    s_waitcnt lgkmcnt(8)
    v_pk_fma_f32 v[160:161], v[44:45], v[52:53], v[160:161] op_sel_hi:[1,0,1]
    v_pk_fma_f32 v[162:163], v[46:47], v[52:53], v[162:163] op_sel_hi:[1,0,1]
    v_pk_fma_f32 v[176:177], v[24:25], v[52:53], v[176:177] op_sel_hi:[1,0,1]
    v_pk_fma_f32 v[178:179], v[26:27], v[52:53], v[178:179] op_sel_hi:[1,0,1]
    v_pk_fma_f32 v[164:165], v[44:45], v[54:55], v[164:165] op_sel_hi:[1,0,1]
    v_pk_fma_f32 v[166:167], v[46:47], v[54:55], v[166:167] op_sel_hi:[1,0,1]
    v_pk_fma_f32 v[180:181], v[24:25], v[54:55], v[180:181] op_sel_hi:[1,0,1]
    v_pk_fma_f32 v[182:183], v[26:27], v[54:55], v[182:183] op_sel_hi:[1,0,1]
    v_pk_fma_f32 v[168:169], v[44:45], v[56:57], v[168:169] op_sel_hi:[1,0,1]
    v_pk_fma_f32 v[170:171], v[46:47], v[56:57], v[170:171] op_sel_hi:[1,0,1]
    v_pk_fma_f32 v[184:185], v[24:25], v[56:57], v[184:185] op_sel_hi:[1,0,1]
    v_pk_fma_f32 v[186:187], v[26:27], v[56:57], v[186:187] op_sel_hi:[1,0,1]
    v_pk_fma_f32 v[172:173], v[44:45], v[58:59], v[172:173] op_sel_hi:[1,0,1]
    v_pk_fma_f32 v[174:175], v[46:47], v[58:59], v[174:175] op_sel_hi:[1,0,1]
    v_pk_fma_f32 v[188:189], v[24:25], v[58:59], v[188:189] op_sel_hi:[1,0,1]
    v_pk_fma_f32 v[190:191], v[26:27], v[58:59], v[190:191] op_sel_hi:[1,0,1]
    ds_read_b128 v[44:47], v60 offset:0
    ds_read_b128 v[24:27], v60 offset:64
    v_xor_b32 v60, 128, v60
    v_pk_mul_f32 v[160:161], v[160:161], v[30:31] op_sel_hi:[1,0]
    v_pk_mul_f32 v[162:163], v[162:163], v[30:31] op_sel_hi:[1,0]
    v_pk_mul_f32 v[176:177], v[176:177], v[30:31] op_sel_hi:[1,0]
    v_pk_mul_f32 v[178:179], v[178:179], v[30:31] op_sel_hi:[1,0]
    v_pk_mul_f32 v[164:165], v[164:165], v[30:31] op_sel:[0,1] op_sel_hi:[1,1]
    v_pk_mul_f32 v[166:167], v[166:167], v[30:31] op_sel:[0,1] op_sel_hi:[1,1]
    v_pk_mul_f32 v[180:181], v[180:181], v[30:31] op_sel:[0,1] op_sel_hi:[1,1]
    v_pk_mul_f32 v[182:183], v[182:183], v[30:31] op_sel:[0,1] op_sel_hi:[1,1]
    v_pk_mul_f32 v[168:169], v[168:169], v[62:63] op_sel_hi:[1,0]
    v_pk_mul_f32 v[170:171], v[170:171], v[62:63] op_sel_hi:[1,0]
    v_pk_mul_f32 v[184:185], v[184:185], v[62:63] op_sel_hi:[1,0]
    v_pk_mul_f32 v[186:187], v[186:187], v[62:63] op_sel_hi:[1,0]
    v_pk_mul_f32 v[172:173], v[172:173], v[62:63] op_sel:[0,1] op_sel_hi:[1,1]
    v_pk_mul_f32 v[174:175], v[174:175], v[62:63] op_sel:[0,1] op_sel_hi:[1,1]
    v_pk_mul_f32 v[188:189], v[188:189], v[62:63] op_sel:[0,1] op_sel_hi:[1,1]
    v_pk_mul_f32 v[190:191], v[190:191], v[62:63] op_sel:[0,1] op_sel_hi:[1,1]
    v_mfma_f32_16x16x32_bf16 v[224:227], a[128:131], a[96:99], v[224:227]
    ds_read_b64_tr_b16 a[144:145], v50 offset:8192
    v_cvt_pk_bf16_f32 v152, v152, v153
    v_mfma_f32_16x16x32_bf16 v[224:227], a[132:135], a[100:103], v[224:227]
    ds_read_b64_tr_b16 a[146:147], v50 offset:8704
    v_cvt_pk_bf16_f32 v154, v154, v155
    v_mfma_f32_16x16x32_bf16 v[228:231], a[132:135], a[108:111], v[228:231]
    ds_read_b64_tr_b16 a[148:149], v50 offset:12288
    v_accvgpr_write_b32 a32, v136
    v_mfma_f32_16x16x32_bf16 v[228:231], a[128:131], a[104:107], v[228:231]
    ds_read_b64_tr_b16 a[150:151], v50 offset:12800
    v_mfma_f32_16x16x32_bf16 v[232:235], a[128:131], a[112:115], v[232:235]
    buffer_load_dwordx4 v16, s[20:23], s80 offen offset:2048 lds
    v_mfma_f32_16x16x32_bf16 v[232:235], a[132:135], a[116:119], v[232:235]
    v_accvgpr_write_b32 a33, v138
    v_accvgpr_write_b32 a34, v152
    v_mfma_f32_16x16x32_bf16 v[236:239], a[132:135], a[124:127], v[236:239]
    v_accvgpr_write_b32 a35, v154
    v_cvt_pk_bf16_f32 v140, v140, v141
    v_mfma_f32_16x16x32_bf16 v[236:239], a[128:131], a[120:123], v[236:239]
    s_waitcnt lgkmcnt(6)
    v_cvt_pk_bf16_f32 v142, v142, v143
    v_cvt_pk_bf16_f32 v156, v156, v157
    v_mfma_f32_16x16x32_bf16 v[252:255], a[136:139], a[120:123], v[252:255]
    ds_read_b64_tr_b16 a[152:153], v51 offset:8192
    v_cvt_pk_bf16_f32 v158, v158, v159
    v_mfma_f32_16x16x32_bf16 v[252:255], a[140:143], a[124:127], v[252:255]
    ds_read_b64_tr_b16 a[154:155], v51 offset:8704
    v_accvgpr_write_b32 a48, v140
    v_mfma_f32_16x16x32_bf16 v[248:251], a[140:143], a[116:119], v[248:251]
    ds_read_b64_tr_b16 a[156:157], v51 offset:12288
    v_accvgpr_write_b32 a49, v142
    v_mfma_f32_16x16x32_bf16 v[248:251], a[136:139], a[112:115], v[248:251]
    ds_read_b64_tr_b16 a[158:159], v51 offset:12800
    v_mfma_f32_16x16x32_bf16 v[244:247], a[136:139], a[104:107], v[244:247]
    buffer_load_dwordx4 v17, s[20:23], s80 offen offset:3072 lds
    v_mfma_f32_16x16x32_bf16 v[244:247], a[140:143], a[108:111], v[244:247]
    v_accvgpr_write_b32 a50, v156
    v_accvgpr_write_b32 a51, v158
    v_mfma_f32_16x16x32_bf16 v[240:243], a[140:143], a[100:103], v[240:243]
    v_cvt_pk_bf16_f32 v160, v160, v161
    v_cvt_pk_bf16_f32 v162, v162, v163
    v_mfma_f32_16x16x32_bf16 v[240:243], a[136:139], a[96:99], v[240:243]
    s_waitcnt lgkmcnt(4)
    v_cvt_pk_bf16_f32 v176, v176, v177
    v_cvt_pk_bf16_f32 v178, v178, v179
    v_mfma_f32_16x16x32_bf16 v[96:99], a[144:147], a[96:99], v[96:99]
    v_accvgpr_write_b32 a4, v160
    v_accvgpr_write_b32 a5, v162
    v_mfma_f32_16x16x32_bf16 v[96:99], a[148:151], a[100:103], v[96:99]
    v_accvgpr_write_b32 a6, v176
    v_accvgpr_write_b32 a7, v178
    v_mfma_f32_16x16x32_bf16 v[100:103], a[148:151], a[108:111], v[100:103]
    v_cvt_pk_bf16_f32 v164, v164, v165
    v_cvt_pk_bf16_f32 v166, v166, v167
    v_mfma_f32_16x16x32_bf16 v[100:103], a[144:147], a[104:107], v[100:103]
    v_cvt_pk_bf16_f32 v180, v180, v181
    v_cvt_pk_bf16_f32 v182, v182, v183
    v_mfma_f32_16x16x32_bf16 v[104:107], a[144:147], a[112:115], v[104:107]
    v_accvgpr_write_b32 a20, v164
    v_accvgpr_write_b32 a21, v166
    v_mfma_f32_16x16x32_bf16 v[104:107], a[148:151], a[116:119], v[104:107]
    v_accvgpr_write_b32 a22, v180
    v_accvgpr_write_b32 a23, v182
    v_mfma_f32_16x16x32_bf16 v[108:111], a[148:151], a[124:127], v[108:111]
    v_cvt_pk_bf16_f32 v168, v168, v169
    v_cvt_pk_bf16_f32 v170, v170, v171
    v_mfma_f32_16x16x32_bf16 v[108:111], a[144:147], a[120:123], v[108:111]
    s_waitcnt lgkmcnt(0)
    v_cvt_pk_bf16_f32 v184, v184, v185
    v_cvt_pk_bf16_f32 v186, v186, v187
    s_waitcnt lgkmcnt(8)
    v_pk_fma_f32 v[192:193], v[44:45], v[52:53], v[192:193] op_sel_hi:[1,0,1]
    v_pk_fma_f32 v[194:195], v[46:47], v[52:53], v[194:195] op_sel_hi:[1,0,1]
    v_pk_fma_f32 v[208:209], v[24:25], v[52:53], v[208:209] op_sel_hi:[1,0,1]
    v_pk_fma_f32 v[210:211], v[26:27], v[52:53], v[210:211] op_sel_hi:[1,0,1]
    v_pk_fma_f32 v[196:197], v[44:45], v[54:55], v[196:197] op_sel_hi:[1,0,1]
    v_pk_fma_f32 v[198:199], v[46:47], v[54:55], v[198:199] op_sel_hi:[1,0,1]
    v_pk_fma_f32 v[212:213], v[24:25], v[54:55], v[212:213] op_sel_hi:[1,0,1]
    v_pk_fma_f32 v[214:215], v[26:27], v[54:55], v[214:215] op_sel_hi:[1,0,1]
    v_pk_fma_f32 v[200:201], v[44:45], v[56:57], v[200:201] op_sel_hi:[1,0,1]
    v_pk_fma_f32 v[202:203], v[46:47], v[56:57], v[202:203] op_sel_hi:[1,0,1]
    v_pk_fma_f32 v[216:217], v[24:25], v[56:57], v[216:217] op_sel_hi:[1,0,1]
    v_pk_fma_f32 v[218:219], v[26:27], v[56:57], v[218:219] op_sel_hi:[1,0,1]
    v_pk_fma_f32 v[204:205], v[44:45], v[58:59], v[204:205] op_sel_hi:[1,0,1]
    v_pk_fma_f32 v[206:207], v[46:47], v[58:59], v[206:207] op_sel_hi:[1,0,1]
    v_pk_fma_f32 v[220:221], v[24:25], v[58:59], v[220:221] op_sel_hi:[1,0,1]
    v_pk_fma_f32 v[222:223], v[26:27], v[58:59], v[222:223] op_sel_hi:[1,0,1]
    ds_read_b128 v[44:47], v60 offset:0
    ds_read_b128 v[24:27], v60 offset:64
    v_pk_mul_f32 v[192:193], v[192:193], v[30:31] op_sel_hi:[1,0]
    v_pk_mul_f32 v[194:195], v[194:195], v[30:31] op_sel_hi:[1,0]
    v_pk_mul_f32 v[208:209], v[208:209], v[30:31] op_sel_hi:[1,0]
    v_pk_mul_f32 v[210:211], v[210:211], v[30:31] op_sel_hi:[1,0]
    v_pk_mul_f32 v[196:197], v[196:197], v[30:31] op_sel:[0,1] op_sel_hi:[1,1]
    v_pk_mul_f32 v[198:199], v[198:199], v[30:31] op_sel:[0,1] op_sel_hi:[1,1]
    v_pk_mul_f32 v[212:213], v[212:213], v[30:31] op_sel:[0,1] op_sel_hi:[1,1]
    v_pk_mul_f32 v[214:215], v[214:215], v[30:31] op_sel:[0,1] op_sel_hi:[1,1]
    v_pk_mul_f32 v[200:201], v[200:201], v[62:63] op_sel_hi:[1,0]
    v_pk_mul_f32 v[202:203], v[202:203], v[62:63] op_sel_hi:[1,0]
    v_pk_mul_f32 v[216:217], v[216:217], v[62:63] op_sel_hi:[1,0]
    v_pk_mul_f32 v[218:219], v[218:219], v[62:63] op_sel_hi:[1,0]
    v_pk_mul_f32 v[204:205], v[204:205], v[62:63] op_sel:[0,1] op_sel_hi:[1,1]
    v_pk_mul_f32 v[206:207], v[206:207], v[62:63] op_sel:[0,1] op_sel_hi:[1,1]
    v_pk_mul_f32 v[220:221], v[220:221], v[62:63] op_sel:[0,1] op_sel_hi:[1,1]
    v_pk_mul_f32 v[222:223], v[222:223], v[62:63] op_sel:[0,1] op_sel_hi:[1,1]
    v_mfma_f32_16x16x32_bf16 v[124:127], a[152:155], a[120:123], v[124:127]
    v_accvgpr_write_b32 a36, v168
    v_accvgpr_write_b32 a37, v170
    v_mfma_f32_16x16x32_bf16 v[124:127], a[156:159], a[124:127], v[124:127]
    v_accvgpr_write_b32 a38, v184
    v_accvgpr_write_b32 a39, v186
    v_mfma_f32_16x16x32_bf16 v[120:123], a[156:159], a[116:119], v[120:123]
    v_cvt_pk_bf16_f32 v172, v172, v173
    v_cvt_pk_bf16_f32 v174, v174, v175
    v_mfma_f32_16x16x32_bf16 v[120:123], a[152:155], a[112:115], v[120:123]
    v_cvt_pk_bf16_f32 v188, v188, v189
    v_cvt_pk_bf16_f32 v190, v190, v191
    v_mfma_f32_16x16x32_bf16 v[116:119], a[152:155], a[104:107], v[116:119]
    v_accvgpr_write_b32 a52, v172
    v_accvgpr_write_b32 a53, v174
    v_mfma_f32_16x16x32_bf16 v[116:119], a[156:159], a[108:111], v[116:119]
    v_accvgpr_write_b32 a54, v188
    v_accvgpr_write_b32 a55, v190
    v_mfma_f32_16x16x32_bf16 v[112:115], a[156:159], a[100:103], v[112:115]
    v_cvt_pk_bf16_f32 v192, v192, v193
    v_cvt_pk_bf16_f32 v194, v194, v195
    v_mfma_f32_16x16x32_bf16 v[112:115], a[152:155], a[96:99], v[112:115]
    v_cvt_pk_bf16_f32 v208, v208, v209
    v_cvt_pk_bf16_f32 v210, v210, v211
    s_waitcnt vmcnt(8)
    s_barrier
    ds_read_b128 a[64:67], v2 offset:0
    ds_read_b128 a[68:71], v3 offset:0
    ds_read_b128 a[72:75], v4 offset:0
    ds_read_b128 a[76:79], v5 offset:0
    ds_read_b128 a[80:83], v2 offset:4096
    ds_read_b128 a[84:87], v3 offset:4096
    ds_read_b128 a[88:91], v4 offset:4096
    ds_read_b128 a[92:95], v5 offset:4096
    ds_read_b128 a[96:99], v2 offset:8192
    ds_read_b128 a[100:103], v3 offset:8192
    ds_read_b128 a[104:107], v4 offset:8192
    ds_read_b128 a[108:111], v5 offset:8192
    ds_read_b128 a[112:115], v2 offset:12288
    ds_read_b128 a[116:119], v3 offset:12288
    ds_read_b128 a[120:123], v4 offset:12288
    ds_read_b128 a[124:127], v5 offset:12288
    v_accvgpr_write_b32 a8, v192
    v_accvgpr_write_b32 a9, v194
    v_accvgpr_write_b32 a10, v208
    v_accvgpr_write_b32 a11, v210
    v_cvt_pk_bf16_f32 v196, v196, v197
    v_cvt_pk_bf16_f32 v198, v198, v199
    v_cvt_pk_bf16_f32 v212, v212, v213
    v_cvt_pk_bf16_f32 v214, v214, v215
    v_accvgpr_write_b32 a24, v196
    v_accvgpr_write_b32 a25, v198
    v_accvgpr_write_b32 a26, v212
    v_accvgpr_write_b32 a27, v214
    v_cvt_pk_bf16_f32 v200, v200, v201
    v_cvt_pk_bf16_f32 v202, v202, v203
    v_cvt_pk_bf16_f32 v216, v216, v217
    v_cvt_pk_bf16_f32 v218, v218, v219
    v_accvgpr_write_b32 a40, v200
    v_accvgpr_write_b32 a41, v202
    v_accvgpr_write_b32 a42, v216
    v_accvgpr_write_b32 a43, v218
    v_cvt_pk_bf16_f32 v204, v204, v205
    v_cvt_pk_bf16_f32 v206, v206, v207
    v_cvt_pk_bf16_f32 v220, v220, v221
    v_cvt_pk_bf16_f32 v222, v222, v223
    v_accvgpr_write_b32 a56, v204
    v_accvgpr_write_b32 a57, v206
    v_accvgpr_write_b32 a58, v220
    v_accvgpr_write_b32 a59, v222
    s_waitcnt lgkmcnt(15)
    v_pk_fma_f32 v[224:225], v[44:45], v[52:53], v[224:225] op_sel_hi:[1,0,1]
    v_pk_fma_f32 v[226:227], v[46:47], v[52:53], v[226:227] op_sel_hi:[1,0,1]
    v_pk_fma_f32 v[240:241], v[24:25], v[52:53], v[240:241] op_sel_hi:[1,0,1]
    v_pk_fma_f32 v[242:243], v[26:27], v[52:53], v[242:243] op_sel_hi:[1,0,1]
    v_pk_fma_f32 v[228:229], v[44:45], v[54:55], v[228:229] op_sel_hi:[1,0,1]
    v_pk_fma_f32 v[230:231], v[46:47], v[54:55], v[230:231] op_sel_hi:[1,0,1]
    v_pk_fma_f32 v[244:245], v[24:25], v[54:55], v[244:245] op_sel_hi:[1,0,1]
    v_pk_fma_f32 v[246:247], v[26:27], v[54:55], v[246:247] op_sel_hi:[1,0,1]
    v_pk_fma_f32 v[232:233], v[44:45], v[56:57], v[232:233] op_sel_hi:[1,0,1]
    v_pk_fma_f32 v[234:235], v[46:47], v[56:57], v[234:235] op_sel_hi:[1,0,1]
    v_pk_fma_f32 v[248:249], v[24:25], v[56:57], v[248:249] op_sel_hi:[1,0,1]
    v_pk_fma_f32 v[250:251], v[26:27], v[56:57], v[250:251] op_sel_hi:[1,0,1]
    v_pk_fma_f32 v[236:237], v[44:45], v[58:59], v[236:237] op_sel_hi:[1,0,1]
    v_pk_fma_f32 v[238:239], v[46:47], v[58:59], v[238:239] op_sel_hi:[1,0,1]
    v_pk_fma_f32 v[252:253], v[24:25], v[58:59], v[252:253] op_sel_hi:[1,0,1]
    v_pk_fma_f32 v[254:255], v[26:27], v[58:59], v[254:255] op_sel_hi:[1,0,1]
    ds_read_b128 v[44:47], v61 offset:0
    ds_read_b128 v[24:27], v61 offset:64
    v_xor_b32 v61, 128, v61
    v_pk_mul_f32 v[224:225], v[224:225], v[30:31] op_sel_hi:[1,0]
    v_pk_mul_f32 v[226:227], v[226:227], v[30:31] op_sel_hi:[1,0]
    v_pk_mul_f32 v[240:241], v[240:241], v[30:31] op_sel_hi:[1,0]
    v_pk_mul_f32 v[242:243], v[242:243], v[30:31] op_sel_hi:[1,0]
    v_pk_mul_f32 v[228:229], v[228:229], v[30:31] op_sel:[0,1] op_sel_hi:[1,1]
    v_pk_mul_f32 v[230:231], v[230:231], v[30:31] op_sel:[0,1] op_sel_hi:[1,1]
    v_pk_mul_f32 v[244:245], v[244:245], v[30:31] op_sel:[0,1] op_sel_hi:[1,1]
    v_pk_mul_f32 v[246:247], v[246:247], v[30:31] op_sel:[0,1] op_sel_hi:[1,1]
    v_pk_mul_f32 v[232:233], v[232:233], v[62:63] op_sel_hi:[1,0]
    v_pk_mul_f32 v[234:235], v[234:235], v[62:63] op_sel_hi:[1,0]
    v_pk_mul_f32 v[248:249], v[248:249], v[62:63] op_sel_hi:[1,0]
    v_pk_mul_f32 v[250:251], v[250:251], v[62:63] op_sel_hi:[1,0]
    v_pk_mul_f32 v[236:237], v[236:237], v[62:63] op_sel:[0,1] op_sel_hi:[1,1]
    v_pk_mul_f32 v[238:239], v[238:239], v[62:63] op_sel:[0,1] op_sel_hi:[1,1]
    v_pk_mul_f32 v[252:253], v[252:253], v[62:63] op_sel:[0,1] op_sel_hi:[1,1]
    v_pk_mul_f32 v[254:255], v[254:255], v[62:63] op_sel:[0,1] op_sel_hi:[1,1]
    v_cvt_pk_bf16_f32 v224, v224, v225
    v_cvt_pk_bf16_f32 v226, v226, v227
    v_cvt_pk_bf16_f32 v240, v240, v241
    v_cvt_pk_bf16_f32 v242, v242, v243
    v_accvgpr_write_b32 a12, v224
    v_accvgpr_write_b32 a13, v226
    v_accvgpr_write_b32 a14, v240
    v_accvgpr_write_b32 a15, v242
    v_cvt_pk_bf16_f32 v228, v228, v229
    v_cvt_pk_bf16_f32 v230, v230, v231
    v_cvt_pk_bf16_f32 v244, v244, v245
    v_cvt_pk_bf16_f32 v246, v246, v247
    v_accvgpr_write_b32 a28, v228
    v_accvgpr_write_b32 a29, v230
    v_accvgpr_write_b32 a30, v244
    v_accvgpr_write_b32 a31, v246
    v_cvt_pk_bf16_f32 v232, v232, v233
    v_cvt_pk_bf16_f32 v234, v234, v235
    v_cvt_pk_bf16_f32 v248, v248, v249
    v_cvt_pk_bf16_f32 v250, v250, v251
    v_accvgpr_write_b32 a44, v232
    v_accvgpr_write_b32 a45, v234
    v_accvgpr_write_b32 a46, v248
    v_accvgpr_write_b32 a47, v250
    v_cvt_pk_bf16_f32 v236, v236, v237
    v_cvt_pk_bf16_f32 v238, v238, v239
    v_cvt_pk_bf16_f32 v252, v252, v253
    v_cvt_pk_bf16_f32 v254, v254, v255
    v_accvgpr_write_b32 a60, v236
    v_accvgpr_write_b32 a61, v238
    v_accvgpr_write_b32 a62, v252
    v_accvgpr_write_b32 a63, v254
    s_mov_b32 s6, 0xbfb8aa3b
    v_mul_f32 v30, s6, v53
    v_rcp_f32 v53, v53
    v_mul_f32 v31, s6, v55
    v_rcp_f32 v55, v55
    v_mul_f32 v62, s6, v57
    v_rcp_f32 v57, v57
    v_mul_f32 v63, s6, v59
    v_rcp_f32 v59, v59
    s_waitcnt lgkmcnt(0)
    v_pk_fma_f32 v[64:65], v[44:45], v[52:53], v[64:65] op_sel_hi:[1,0,1]
    v_pk_fma_f32 v[66:67], v[46:47], v[52:53], v[66:67] op_sel_hi:[1,0,1]
    v_pk_fma_f32 v[80:81], v[24:25], v[52:53], v[80:81] op_sel_hi:[1,0,1]
    v_pk_fma_f32 v[82:83], v[26:27], v[52:53], v[82:83] op_sel_hi:[1,0,1]
    v_pk_fma_f32 v[68:69], v[44:45], v[54:55], v[68:69] op_sel_hi:[1,0,1]
    v_pk_fma_f32 v[70:71], v[46:47], v[54:55], v[70:71] op_sel_hi:[1,0,1]
    v_pk_fma_f32 v[84:85], v[24:25], v[54:55], v[84:85] op_sel_hi:[1,0,1]
    v_pk_fma_f32 v[86:87], v[26:27], v[54:55], v[86:87] op_sel_hi:[1,0,1]
    v_pk_fma_f32 v[72:73], v[44:45], v[56:57], v[72:73] op_sel_hi:[1,0,1]
    v_pk_fma_f32 v[74:75], v[46:47], v[56:57], v[74:75] op_sel_hi:[1,0,1]
    v_pk_fma_f32 v[88:89], v[24:25], v[56:57], v[88:89] op_sel_hi:[1,0,1]
    v_pk_fma_f32 v[90:91], v[26:27], v[56:57], v[90:91] op_sel_hi:[1,0,1]
    v_pk_fma_f32 v[76:77], v[44:45], v[58:59], v[76:77] op_sel_hi:[1,0,1]
    v_pk_fma_f32 v[78:79], v[46:47], v[58:59], v[78:79] op_sel_hi:[1,0,1]
    v_pk_fma_f32 v[92:93], v[24:25], v[58:59], v[92:93] op_sel_hi:[1,0,1]
    v_pk_fma_f32 v[94:95], v[26:27], v[58:59], v[94:95] op_sel_hi:[1,0,1]
    ds_read_b128 v[44:47], v61 offset:0
    ds_read_b128 v[24:27], v61 offset:64
    v_pk_mul_f32 v[128:129], v[64:65], v[30:31] op_sel_hi:[1,0]
    v_pk_mul_f32 v[130:131], v[66:67], v[30:31] op_sel_hi:[1,0]
    v_pk_mul_f32 v[144:145], v[80:81], v[30:31] op_sel_hi:[1,0]
    v_pk_mul_f32 v[146:147], v[82:83], v[30:31] op_sel_hi:[1,0]
    v_pk_mul_f32 v[132:133], v[68:69], v[30:31] op_sel:[0,1] op_sel_hi:[1,1]
    v_pk_mul_f32 v[134:135], v[70:71], v[30:31] op_sel:[0,1] op_sel_hi:[1,1]
    v_pk_mul_f32 v[148:149], v[84:85], v[30:31] op_sel:[0,1] op_sel_hi:[1,1]
    v_pk_mul_f32 v[150:151], v[86:87], v[30:31] op_sel:[0,1] op_sel_hi:[1,1]
    v_pk_mul_f32 v[136:137], v[72:73], v[62:63] op_sel_hi:[1,0]
    v_pk_mul_f32 v[138:139], v[74:75], v[62:63] op_sel_hi:[1,0]
    v_pk_mul_f32 v[152:153], v[88:89], v[62:63] op_sel_hi:[1,0]
    v_pk_mul_f32 v[154:155], v[90:91], v[62:63] op_sel_hi:[1,0]
    v_pk_mul_f32 v[140:141], v[76:77], v[62:63] op_sel:[0,1] op_sel_hi:[1,1]
    v_pk_mul_f32 v[142:143], v[78:79], v[62:63] op_sel:[0,1] op_sel_hi:[1,1]
    v_pk_mul_f32 v[156:157], v[92:93], v[62:63] op_sel:[0,1] op_sel_hi:[1,1]
    v_pk_mul_f32 v[158:159], v[94:95], v[62:63] op_sel:[0,1] op_sel_hi:[1,1]
    s_waitcnt lgkmcnt(0)
    v_pk_fma_f32 v[96:97], v[44:45], v[52:53], v[96:97] op_sel_hi:[1,0,1]
    v_pk_fma_f32 v[98:99], v[46:47], v[52:53], v[98:99] op_sel_hi:[1,0,1]
    v_pk_fma_f32 v[112:113], v[24:25], v[52:53], v[112:113] op_sel_hi:[1,0,1]
    v_pk_fma_f32 v[114:115], v[26:27], v[52:53], v[114:115] op_sel_hi:[1,0,1]
    v_pk_fma_f32 v[100:101], v[44:45], v[54:55], v[100:101] op_sel_hi:[1,0,1]
    v_pk_fma_f32 v[102:103], v[46:47], v[54:55], v[102:103] op_sel_hi:[1,0,1]
    v_pk_fma_f32 v[116:117], v[24:25], v[54:55], v[116:117] op_sel_hi:[1,0,1]
    v_pk_fma_f32 v[118:119], v[26:27], v[54:55], v[118:119] op_sel_hi:[1,0,1]
    v_pk_fma_f32 v[104:105], v[44:45], v[56:57], v[104:105] op_sel_hi:[1,0,1]
    v_pk_fma_f32 v[106:107], v[46:47], v[56:57], v[106:107] op_sel_hi:[1,0,1]
    v_pk_fma_f32 v[120:121], v[24:25], v[56:57], v[120:121] op_sel_hi:[1,0,1]
    v_pk_fma_f32 v[122:123], v[26:27], v[56:57], v[122:123] op_sel_hi:[1,0,1]
    v_pk_fma_f32 v[108:109], v[44:45], v[58:59], v[108:109] op_sel_hi:[1,0,1]
    v_pk_fma_f32 v[110:111], v[46:47], v[58:59], v[110:111] op_sel_hi:[1,0,1]
    v_pk_fma_f32 v[124:125], v[24:25], v[58:59], v[124:125] op_sel_hi:[1,0,1]
    v_pk_fma_f32 v[126:127], v[26:27], v[58:59], v[126:127] op_sel_hi:[1,0,1]
    v_pk_mul_f32 v[160:161], v[96:97], v[30:31] op_sel_hi:[1,0]
    v_pk_mul_f32 v[162:163], v[98:99], v[30:31] op_sel_hi:[1,0]
    v_pk_mul_f32 v[176:177], v[112:113], v[30:31] op_sel_hi:[1,0]
    v_pk_mul_f32 v[178:179], v[114:115], v[30:31] op_sel_hi:[1,0]
    v_pk_mul_f32 v[164:165], v[100:101], v[30:31] op_sel:[0,1] op_sel_hi:[1,1]
    v_pk_mul_f32 v[166:167], v[102:103], v[30:31] op_sel:[0,1] op_sel_hi:[1,1]
    v_pk_mul_f32 v[180:181], v[116:117], v[30:31] op_sel:[0,1] op_sel_hi:[1,1]
    v_pk_mul_f32 v[182:183], v[118:119], v[30:31] op_sel:[0,1] op_sel_hi:[1,1]
    v_pk_mul_f32 v[168:169], v[104:105], v[62:63] op_sel_hi:[1,0]
    v_pk_mul_f32 v[170:171], v[106:107], v[62:63] op_sel_hi:[1,0]
    v_pk_mul_f32 v[184:185], v[120:121], v[62:63] op_sel_hi:[1,0]
    v_pk_mul_f32 v[186:187], v[122:123], v[62:63] op_sel_hi:[1,0]
    v_pk_mul_f32 v[172:173], v[108:109], v[62:63] op_sel:[0,1] op_sel_hi:[1,1]
    v_pk_mul_f32 v[174:175], v[110:111], v[62:63] op_sel:[0,1] op_sel_hi:[1,1]
    v_pk_mul_f32 v[188:189], v[124:125], v[62:63] op_sel:[0,1] op_sel_hi:[1,1]
    v_pk_mul_f32 v[190:191], v[126:127], v[62:63] op_sel:[0,1] op_sel_hi:[1,1]
    v_mfma_f32_16x16x32_bf16 v[192:195], a[64:67], a[0:3], 0
    s_lshl_b32 s36, s2, 2
    v_exp_f32 v128, v128
    v_mfma_f32_16x16x32_bf16 v[192:195], a[68:71], a[4:7], v[192:195]
    s_mul_i32 s3, s36, 52429
    v_exp_f32 v129, v129
    v_mfma_f32_16x16x32_bf16 v[192:195], a[72:75], a[8:11], v[192:195]
    s_lshr_b32 s3, s3, 18
    v_exp_f32 v130, v130
    v_mfma_f32_16x16x32_bf16 v[192:195], a[76:79], a[12:15], v[192:195]
    s_mul_i32 s83, s3, 39680
    v_exp_f32 v131, v131
    v_mfma_f32_16x16x32_bf16 v[208:211], a[76:79], a[28:31], 0
    s_lshl_b32 s4, s36, 8
    v_exp_f32 v132, v132
    v_mfma_f32_16x16x32_bf16 v[208:211], a[72:75], a[24:27], v[208:211]
    s_add_u32 s83, s83, s4
    v_exp_f32 v133, v133
    v_mfma_f32_16x16x32_bf16 v[208:211], a[68:71], a[20:23], v[208:211]
    s_add_u32 s84, s83, 4096
    v_exp_f32 v134, v134
    v_mfma_f32_16x16x32_bf16 v[208:211], a[64:67], a[16:19], v[208:211]
    s_lshl_b32 s85, s36, 14
    v_exp_f32 v135, v135
    v_mfma_f32_16x16x32_bf16 v[224:227], a[64:67], a[32:35], 0
    s_mul_i32 s4, s3, 40960
    v_exp_f32 v136, v136
    v_mfma_f32_16x16x32_bf16 v[224:227], a[68:71], a[36:39], v[224:227]
    s_sub_u32 s85, s85, s4
    v_exp_f32 v137, v137
    v_mfma_f32_16x16x32_bf16 v[224:227], a[72:75], a[40:43], v[224:227]
    s_and_b32 s3, s3, 1
    v_exp_f32 v138, v138
    v_mfma_f32_16x16x32_bf16 v[224:227], a[76:79], a[44:47], v[224:227]
    s_mul_i32 s3, s3, 39936
    v_exp_f32 v139, v139
    v_mfma_f32_16x16x32_bf16 v[240:243], a[76:79], a[60:63], 0
    s_sub_u32 s85, s85, s3
    v_exp_f32 v140, v140
    v_mfma_f32_16x16x32_bf16 v[240:243], a[72:75], a[56:59], v[240:243]
    s_add_u32 s85, s85, s79
    v_exp_f32 v141, v141
    v_mfma_f32_16x16x32_bf16 v[240:243], a[68:71], a[52:55], v[240:243]
    s_and_b32 s6, s76, 2
    v_exp_f32 v142, v142
    v_mfma_f32_16x16x32_bf16 v[240:243], a[64:67], a[48:51], v[240:243]
    s_lshl_b32 s6, s6, 9
    v_exp_f32 v143, v143
    v_mfma_f32_16x16x32_bf16 v[244:247], a[80:83], a[48:51], 0
    s_mov_b32 s5, 4096
    v_exp_f32 v144, v144
    v_mfma_f32_16x16x32_bf16 v[244:247], a[84:87], a[52:55], v[244:247]
    v_exp_f32 v145, v145
    v_mfma_f32_16x16x32_bf16 v[244:247], a[88:91], a[56:59], v[244:247]
    v_exp_f32 v146, v146
    v_mfma_f32_16x16x32_bf16 v[244:247], a[92:95], a[60:63], v[244:247]
    v_exp_f32 v147, v147
    v_mfma_f32_16x16x32_bf16 v[228:231], a[92:95], a[44:47], 0
    v_exp_f32 v148, v148
    v_mfma_f32_16x16x32_bf16 v[228:231], a[88:91], a[40:43], v[228:231]
    v_exp_f32 v149, v149
    v_mfma_f32_16x16x32_bf16 v[228:231], a[84:87], a[36:39], v[228:231]
    v_exp_f32 v150, v150
    v_mfma_f32_16x16x32_bf16 v[228:231], a[80:83], a[32:35], v[228:231]
    v_exp_f32 v151, v151
    v_mfma_f32_16x16x32_bf16 v[212:215], a[80:83], a[16:19], 0
    v_exp_f32 v152, v152
    v_mfma_f32_16x16x32_bf16 v[212:215], a[84:87], a[20:23], v[212:215]
    v_exp_f32 v153, v153
    v_mfma_f32_16x16x32_bf16 v[212:215], a[88:91], a[24:27], v[212:215]
    v_exp_f32 v154, v154
    v_mfma_f32_16x16x32_bf16 v[212:215], a[92:95], a[28:31], v[212:215]
    v_exp_f32 v155, v155
    v_mfma_f32_16x16x32_bf16 v[196:199], a[92:95], a[12:15], 0
    v_exp_f32 v156, v156
    v_mfma_f32_16x16x32_bf16 v[196:199], a[88:91], a[8:11], v[196:199]
    v_exp_f32 v157, v157
    v_mfma_f32_16x16x32_bf16 v[196:199], a[84:87], a[4:7], v[196:199]
    v_exp_f32 v158, v158
    v_mfma_f32_16x16x32_bf16 v[196:199], a[80:83], a[0:3], v[196:199]
    v_exp_f32 v159, v159
    v_mfma_f32_16x16x32_bf16 v[200:203], a[96:99], a[0:3], 0
    v_exp_f32 v160, v160
    v_mfma_f32_16x16x32_bf16 v[200:203], a[100:103], a[4:7], v[200:203]
    v_exp_f32 v161, v161
    v_mfma_f32_16x16x32_bf16 v[200:203], a[104:107], a[8:11], v[200:203]
    v_exp_f32 v162, v162
    v_mfma_f32_16x16x32_bf16 v[200:203], a[108:111], a[12:15], v[200:203]
    v_exp_f32 v163, v163
    v_mfma_f32_16x16x32_bf16 v[216:219], a[108:111], a[28:31], 0
    v_exp_f32 v164, v164
    v_mfma_f32_16x16x32_bf16 v[216:219], a[104:107], a[24:27], v[216:219]
    v_exp_f32 v165, v165
    v_mfma_f32_16x16x32_bf16 v[216:219], a[100:103], a[20:23], v[216:219]
    v_exp_f32 v166, v166
    v_mfma_f32_16x16x32_bf16 v[216:219], a[96:99], a[16:19], v[216:219]
    v_exp_f32 v167, v167
    v_mfma_f32_16x16x32_bf16 v[232:235], a[96:99], a[32:35], 0
    v_exp_f32 v168, v168
    v_mfma_f32_16x16x32_bf16 v[232:235], a[100:103], a[36:39], v[232:235]
    v_exp_f32 v169, v169
    v_mfma_f32_16x16x32_bf16 v[232:235], a[104:107], a[40:43], v[232:235]
    v_exp_f32 v170, v170
    v_mfma_f32_16x16x32_bf16 v[232:235], a[108:111], a[44:47], v[232:235]
    v_exp_f32 v171, v171
    v_mfma_f32_16x16x32_bf16 v[248:251], a[108:111], a[60:63], 0
    v_exp_f32 v172, v172
    v_mfma_f32_16x16x32_bf16 v[248:251], a[104:107], a[56:59], v[248:251]
    v_exp_f32 v173, v173
    v_mfma_f32_16x16x32_bf16 v[248:251], a[100:103], a[52:55], v[248:251]
    v_exp_f32 v174, v174
    v_mfma_f32_16x16x32_bf16 v[248:251], a[96:99], a[48:51], v[248:251]
    v_exp_f32 v175, v175
    v_mfma_f32_16x16x32_bf16 v[252:255], a[112:115], a[48:51], 0
    v_exp_f32 v176, v176
    v_mfma_f32_16x16x32_bf16 v[252:255], a[116:119], a[52:55], v[252:255]
    v_exp_f32 v177, v177
    v_mfma_f32_16x16x32_bf16 v[252:255], a[120:123], a[56:59], v[252:255]
    v_exp_f32 v178, v178
    v_mfma_f32_16x16x32_bf16 v[252:255], a[124:127], a[60:63], v[252:255]
    v_exp_f32 v179, v179
    v_mfma_f32_16x16x32_bf16 v[236:239], a[124:127], a[44:47], 0
    v_exp_f32 v180, v180
    v_mfma_f32_16x16x32_bf16 v[236:239], a[120:123], a[40:43], v[236:239]
    v_exp_f32 v181, v181
    v_mfma_f32_16x16x32_bf16 v[236:239], a[116:119], a[36:39], v[236:239]
    v_exp_f32 v182, v182
    v_mfma_f32_16x16x32_bf16 v[236:239], a[112:115], a[32:35], v[236:239]
    v_exp_f32 v183, v183
    v_mfma_f32_16x16x32_bf16 v[220:223], a[112:115], a[16:19], 0
    v_exp_f32 v184, v184
    v_mfma_f32_16x16x32_bf16 v[220:223], a[116:119], a[20:23], v[220:223]
    v_exp_f32 v185, v185
    v_mfma_f32_16x16x32_bf16 v[220:223], a[120:123], a[24:27], v[220:223]
    v_exp_f32 v186, v186
    v_mfma_f32_16x16x32_bf16 v[220:223], a[124:127], a[28:31], v[220:223]
    v_exp_f32 v187, v187
    v_mfma_f32_16x16x32_bf16 v[204:207], a[124:127], a[12:15], 0
    v_exp_f32 v188, v188
    v_mfma_f32_16x16x32_bf16 v[204:207], a[120:123], a[8:11], v[204:207]
    v_exp_f32 v189, v189
    v_mfma_f32_16x16x32_bf16 v[204:207], a[116:119], a[4:7], v[204:207]
    v_exp_f32 v190, v190
    v_mfma_f32_16x16x32_bf16 v[204:207], a[112:115], a[0:3], v[204:207]
    v_exp_f32 v191, v191
    v_xor_b32 v62, s6, v1
    v_xor_b32 v63, 1024, v62
    v_pk_fma_f32 v[128:129], v[128:129], v[52:53], v[52:53] op_sel:[0,1,1] op_sel_hi:[1,1,1]
    v_pk_fma_f32 v[130:131], v[130:131], v[52:53], v[52:53] op_sel:[0,1,1] op_sel_hi:[1,1,1]
    v_pk_fma_f32 v[144:145], v[144:145], v[52:53], v[52:53] op_sel:[0,1,1] op_sel_hi:[1,1,1]
    v_pk_fma_f32 v[146:147], v[146:147], v[52:53], v[52:53] op_sel:[0,1,1] op_sel_hi:[1,1,1]
    v_rcp_f32 v128, v128
    v_rcp_f32 v129, v129
    v_rcp_f32 v130, v130
    v_rcp_f32 v131, v131
    v_rcp_f32 v144, v144
    v_rcp_f32 v145, v145
    v_rcp_f32 v146, v146
    v_rcp_f32 v147, v147
    v_pk_mul_f32 v[64:65], v[64:65], v[128:129]
    v_pk_mul_f32 v[66:67], v[66:67], v[130:131]
    v_pk_mul_f32 v[80:81], v[80:81], v[144:145]
    v_pk_mul_f32 v[82:83], v[82:83], v[146:147]
    v_cvt_pk_bf16_f32 v128, v64, v65
    v_cvt_pk_bf16_f32 v129, v66, v67
    v_cvt_pk_bf16_f32 v130, v80, v81
    v_cvt_pk_bf16_f32 v131, v82, v83
    buffer_store_dwordx4 v[128:131], v62, s[32:35], 0 offen offset:0 sc1
    v_pk_fma_f32 v[132:133], v[132:133], v[54:55], v[54:55] op_sel:[0,1,1] op_sel_hi:[1,1,1]
    v_pk_fma_f32 v[134:135], v[134:135], v[54:55], v[54:55] op_sel:[0,1,1] op_sel_hi:[1,1,1]
    v_pk_fma_f32 v[148:149], v[148:149], v[54:55], v[54:55] op_sel:[0,1,1] op_sel_hi:[1,1,1]
    v_pk_fma_f32 v[150:151], v[150:151], v[54:55], v[54:55] op_sel:[0,1,1] op_sel_hi:[1,1,1]
    v_rcp_f32 v132, v132
    v_rcp_f32 v133, v133
    v_rcp_f32 v134, v134
    v_rcp_f32 v135, v135
    v_rcp_f32 v148, v148
    v_rcp_f32 v149, v149
    v_rcp_f32 v150, v150
    v_rcp_f32 v151, v151
    v_pk_mul_f32 v[68:69], v[68:69], v[132:133]
    v_pk_mul_f32 v[70:71], v[70:71], v[134:135]
    v_pk_mul_f32 v[84:85], v[84:85], v[148:149]
    v_pk_mul_f32 v[86:87], v[86:87], v[150:151]
    v_cvt_pk_bf16_f32 v132, v68, v69
    v_cvt_pk_bf16_f32 v133, v70, v71
    v_cvt_pk_bf16_f32 v134, v84, v85
    v_cvt_pk_bf16_f32 v135, v86, v87
    buffer_store_dwordx4 v[132:135], v62, s[32:35], 0 offen offset:2048 sc1
    v_pk_fma_f32 v[136:137], v[136:137], v[56:57], v[56:57] op_sel:[0,1,1] op_sel_hi:[1,1,1]
    v_pk_fma_f32 v[138:139], v[138:139], v[56:57], v[56:57] op_sel:[0,1,1] op_sel_hi:[1,1,1]
    v_pk_fma_f32 v[152:153], v[152:153], v[56:57], v[56:57] op_sel:[0,1,1] op_sel_hi:[1,1,1]
    v_pk_fma_f32 v[154:155], v[154:155], v[56:57], v[56:57] op_sel:[0,1,1] op_sel_hi:[1,1,1]
    v_rcp_f32 v136, v136
    v_rcp_f32 v137, v137
    v_rcp_f32 v138, v138
    v_rcp_f32 v139, v139
    v_rcp_f32 v152, v152
    v_rcp_f32 v153, v153
    v_rcp_f32 v154, v154
    v_rcp_f32 v155, v155
    v_pk_mul_f32 v[72:73], v[72:73], v[136:137]
    v_pk_mul_f32 v[74:75], v[74:75], v[138:139]
    v_pk_mul_f32 v[88:89], v[88:89], v[152:153]
    v_pk_mul_f32 v[90:91], v[90:91], v[154:155]
    v_cvt_pk_bf16_f32 v136, v72, v73
    v_cvt_pk_bf16_f32 v137, v74, v75
    v_cvt_pk_bf16_f32 v138, v88, v89
    v_cvt_pk_bf16_f32 v139, v90, v91
    buffer_store_dwordx4 v[136:139], v62, s[32:35], s5 offen offset:0 sc1
    v_pk_fma_f32 v[140:141], v[140:141], v[58:59], v[58:59] op_sel:[0,1,1] op_sel_hi:[1,1,1]
    v_pk_fma_f32 v[142:143], v[142:143], v[58:59], v[58:59] op_sel:[0,1,1] op_sel_hi:[1,1,1]
    v_pk_fma_f32 v[156:157], v[156:157], v[58:59], v[58:59] op_sel:[0,1,1] op_sel_hi:[1,1,1]
    v_pk_fma_f32 v[158:159], v[158:159], v[58:59], v[58:59] op_sel:[0,1,1] op_sel_hi:[1,1,1]
    v_rcp_f32 v140, v140
    v_rcp_f32 v141, v141
    v_rcp_f32 v142, v142
    v_rcp_f32 v143, v143
    v_rcp_f32 v156, v156
    v_rcp_f32 v157, v157
    v_rcp_f32 v158, v158
    v_rcp_f32 v159, v159
    v_pk_mul_f32 v[76:77], v[76:77], v[140:141]
    v_pk_mul_f32 v[78:79], v[78:79], v[142:143]
    v_pk_mul_f32 v[92:93], v[92:93], v[156:157]
    v_pk_mul_f32 v[94:95], v[94:95], v[158:159]
    v_cvt_pk_bf16_f32 v140, v76, v77
    v_cvt_pk_bf16_f32 v141, v78, v79
    v_cvt_pk_bf16_f32 v142, v92, v93
    v_cvt_pk_bf16_f32 v143, v94, v95
    buffer_store_dwordx4 v[140:143], v62, s[32:35], s5 offen offset:2048 sc1
    v_pk_fma_f32 v[160:161], v[160:161], v[52:53], v[52:53] op_sel:[0,1,1] op_sel_hi:[1,1,1]
    v_pk_fma_f32 v[162:163], v[162:163], v[52:53], v[52:53] op_sel:[0,1,1] op_sel_hi:[1,1,1]
    v_pk_fma_f32 v[176:177], v[176:177], v[52:53], v[52:53] op_sel:[0,1,1] op_sel_hi:[1,1,1]
    v_pk_fma_f32 v[178:179], v[178:179], v[52:53], v[52:53] op_sel:[0,1,1] op_sel_hi:[1,1,1]
    v_rcp_f32 v160, v160
    v_rcp_f32 v161, v161
    v_rcp_f32 v162, v162
    v_rcp_f32 v163, v163
    v_rcp_f32 v176, v176
    v_rcp_f32 v177, v177
    v_rcp_f32 v178, v178
    v_rcp_f32 v179, v179
    v_pk_mul_f32 v[96:97], v[96:97], v[160:161]
    v_pk_mul_f32 v[98:99], v[98:99], v[162:163]
    v_pk_mul_f32 v[112:113], v[112:113], v[176:177]
    v_pk_mul_f32 v[114:115], v[114:115], v[178:179]
    v_cvt_pk_bf16_f32 v160, v96, v97
    v_cvt_pk_bf16_f32 v161, v98, v99
    v_cvt_pk_bf16_f32 v162, v112, v113
    v_cvt_pk_bf16_f32 v163, v114, v115
    buffer_store_dwordx4 v[160:163], v63, s[32:35], 0 offen offset:0 sc1
    v_pk_fma_f32 v[164:165], v[164:165], v[54:55], v[54:55] op_sel:[0,1,1] op_sel_hi:[1,1,1]
    v_pk_fma_f32 v[166:167], v[166:167], v[54:55], v[54:55] op_sel:[0,1,1] op_sel_hi:[1,1,1]
    v_pk_fma_f32 v[180:181], v[180:181], v[54:55], v[54:55] op_sel:[0,1,1] op_sel_hi:[1,1,1]
    v_pk_fma_f32 v[182:183], v[182:183], v[54:55], v[54:55] op_sel:[0,1,1] op_sel_hi:[1,1,1]
    v_rcp_f32 v164, v164
    v_rcp_f32 v165, v165
    v_rcp_f32 v166, v166
    v_rcp_f32 v167, v167
    v_rcp_f32 v180, v180
    v_rcp_f32 v181, v181
    v_rcp_f32 v182, v182
    v_rcp_f32 v183, v183
    v_pk_mul_f32 v[100:101], v[100:101], v[164:165]
    v_pk_mul_f32 v[102:103], v[102:103], v[166:167]
    v_pk_mul_f32 v[116:117], v[116:117], v[180:181]
    v_pk_mul_f32 v[118:119], v[118:119], v[182:183]
    v_cvt_pk_bf16_f32 v164, v100, v101
    v_cvt_pk_bf16_f32 v165, v102, v103
    v_cvt_pk_bf16_f32 v166, v116, v117
    v_cvt_pk_bf16_f32 v167, v118, v119
    buffer_store_dwordx4 v[164:167], v63, s[32:35], 0 offen offset:2048 sc1
    v_pk_fma_f32 v[168:169], v[168:169], v[56:57], v[56:57] op_sel:[0,1,1] op_sel_hi:[1,1,1]
    v_pk_fma_f32 v[170:171], v[170:171], v[56:57], v[56:57] op_sel:[0,1,1] op_sel_hi:[1,1,1]
    v_pk_fma_f32 v[184:185], v[184:185], v[56:57], v[56:57] op_sel:[0,1,1] op_sel_hi:[1,1,1]
    v_pk_fma_f32 v[186:187], v[186:187], v[56:57], v[56:57] op_sel:[0,1,1] op_sel_hi:[1,1,1]
    v_rcp_f32 v168, v168
    v_rcp_f32 v169, v169
    v_rcp_f32 v170, v170
    v_rcp_f32 v171, v171
    v_rcp_f32 v184, v184
    v_rcp_f32 v185, v185
    v_rcp_f32 v186, v186
    v_rcp_f32 v187, v187
    v_pk_mul_f32 v[104:105], v[104:105], v[168:169]
    v_pk_mul_f32 v[106:107], v[106:107], v[170:171]
    v_pk_mul_f32 v[120:121], v[120:121], v[184:185]
    v_pk_mul_f32 v[122:123], v[122:123], v[186:187]
    v_cvt_pk_bf16_f32 v168, v104, v105
    v_cvt_pk_bf16_f32 v169, v106, v107
    v_cvt_pk_bf16_f32 v170, v120, v121
    v_cvt_pk_bf16_f32 v171, v122, v123
    buffer_store_dwordx4 v[168:171], v63, s[32:35], s5 offen offset:0 sc1
    v_pk_fma_f32 v[172:173], v[172:173], v[58:59], v[58:59] op_sel:[0,1,1] op_sel_hi:[1,1,1]
    v_pk_fma_f32 v[174:175], v[174:175], v[58:59], v[58:59] op_sel:[0,1,1] op_sel_hi:[1,1,1]
    v_pk_fma_f32 v[188:189], v[188:189], v[58:59], v[58:59] op_sel:[0,1,1] op_sel_hi:[1,1,1]
    v_pk_fma_f32 v[190:191], v[190:191], v[58:59], v[58:59] op_sel:[0,1,1] op_sel_hi:[1,1,1]
    v_rcp_f32 v172, v172
    v_rcp_f32 v173, v173
    v_rcp_f32 v174, v174
    v_rcp_f32 v175, v175
    v_rcp_f32 v188, v188
    v_rcp_f32 v189, v189
    v_rcp_f32 v190, v190
    v_rcp_f32 v191, v191
    v_pk_mul_f32 v[108:109], v[108:109], v[172:173]
    v_pk_mul_f32 v[110:111], v[110:111], v[174:175]
    v_pk_mul_f32 v[124:125], v[124:125], v[188:189]
    v_pk_mul_f32 v[126:127], v[126:127], v[190:191]
    v_cvt_pk_bf16_f32 v172, v108, v109
    v_cvt_pk_bf16_f32 v173, v110, v111
    v_cvt_pk_bf16_f32 v174, v124, v125
    v_cvt_pk_bf16_f32 v175, v126, v127
    buffer_store_dwordx4 v[172:175], v63, s[32:35], s5 offen offset:2048 sc1
    v_max_f32 v24, v192, v193
    v_max_f32 v25, v208, v209
    v_max_f32 v26, v224, v225
    v_max_f32 v27, v240, v241
    v_max3_f32 v24, v24, v194, v195
    v_max3_f32 v25, v25, v210, v211
    v_max3_f32 v26, v26, v226, v227
    v_max3_f32 v27, v27, v242, v243
    v_max3_f32 v24, v24, v196, v197
    v_max3_f32 v25, v25, v212, v213
    v_max3_f32 v26, v26, v228, v229
    v_max3_f32 v27, v27, v244, v245
    v_max3_f32 v24, v24, v198, v199
    v_max3_f32 v25, v25, v214, v215
    v_max3_f32 v26, v26, v230, v231
    v_max3_f32 v27, v27, v246, v247
    v_max3_f32 v24, v24, v200, v201
    v_max3_f32 v25, v25, v216, v217
    v_max3_f32 v26, v26, v232, v233
    v_max3_f32 v27, v27, v248, v249
    v_max3_f32 v24, v24, v202, v203
    v_max3_f32 v25, v25, v218, v219
    v_max3_f32 v26, v26, v234, v235
    v_max3_f32 v27, v27, v250, v251
    v_max3_f32 v24, v24, v204, v205
    v_max3_f32 v25, v25, v220, v221
    v_max3_f32 v26, v26, v236, v237
    v_max3_f32 v27, v27, v252, v253
    v_max3_f32 v24, v24, v206, v207
    v_max3_f32 v25, v25, v222, v223
    v_max3_f32 v26, v26, v238, v239
    v_max3_f32 v27, v27, v254, v255
    s_mov_b32 s6, 0xc2cc0000
    s_waitcnt vmcnt(12)
M_restart:
    s_barrier
    ds_read_b128 a[64:67], v2 offset:16384
    ds_read_b128 a[68:71], v3 offset:16384
    ds_read_b128 a[72:75], v4 offset:16384
    ds_read_b128 a[76:79], v5 offset:16384
    ds_read_b128 a[80:83], v2 offset:20480
    ds_read_b64_tr_b16 a[128:129], v6 offset:0
    ds_read_b64_tr_b16 a[130:131], v6 offset:4096
    ds_read_b64_tr_b16 a[132:133], v6 offset:8192
    ds_read_b64_tr_b16 a[134:135], v6 offset:12288
    ds_read_b64_tr_b16 a[136:137], v7 offset:0
    ds_read_b64_tr_b16 a[138:139], v7 offset:4096
    ds_read_b64_tr_b16 a[140:141], v7 offset:8192
    ds_read_b64_tr_b16 a[142:143], v7 offset:12288
    ds_read_b64_tr_b16 a[144:145], v8 offset:0
    ds_read_b64_tr_b16 a[146:147], v8 offset:4096
    s_mov_b32 m0, s71
    s_mov_b32 s80, 49152
    buffer_load_dwordx4 v14, s[20:23], s80 offen offset:0 lds
    buffer_load_dwordx4 v15, s[20:23], s80 offen offset:1024 lds
    buffer_load_dwordx4 v16, s[20:23], s80 offen offset:2048 lds
    v_mov_b32 v28, v24
    v_mov_b32 v29, v25
    v_mov_b32 v30, v26
    v_mov_b32 v31, v27
    v_permlane32_swap_b32 v24, v28
    v_permlane32_swap_b32 v25, v29
    v_permlane32_swap_b32 v26, v30
    v_permlane32_swap_b32 v27, v31
    v_max_f32 v24, v24, v28
    v_max_f32 v25, v25, v29
    v_max_f32 v26, v26, v30
    v_max_f32 v27, v27, v31
    v_mov_b32 v28, v24
    v_mov_b32 v29, v25
    v_mov_b32 v30, v26
    v_mov_b32 v31, v27
    v_permlane16_swap_b32 v24, v28
    v_permlane16_swap_b32 v25, v29
    v_permlane16_swap_b32 v26, v30
    v_permlane16_swap_b32 v27, v31
    v_max_f32 v24, v24, v28
    v_max_f32 v25, v25, v29
    v_max_f32 v26, v26, v30
    v_max_f32 v27, v27, v31
    v_pk_add_f32 v[40:41], s[6:7], v[24:25] op_sel_hi:[0,0] neg_lo:[0,1] neg_hi:[0,1]
    v_pk_add_f32 v[42:43], s[6:7], v[24:25] op_sel_hi:[0,0] neg_lo:[0,1] neg_hi:[0,1]
    v_pk_add_f32 v[44:45], s[6:7], v[24:25] op_sel:[0,1] op_sel_hi:[0,1] neg_lo:[0,1] neg_hi:[0,1]
    v_pk_add_f32 v[46:47], s[6:7], v[24:25] op_sel:[0,1] op_sel_hi:[0,1] neg_lo:[0,1] neg_hi:[0,1]
    v_pk_add_f32 v[48:49], s[6:7], v[26:27] op_sel_hi:[0,0] neg_lo:[0,1] neg_hi:[0,1]
    v_pk_add_f32 v[50:51], s[6:7], v[26:27] op_sel_hi:[0,0] neg_lo:[0,1] neg_hi:[0,1]
    v_pk_add_f32 v[52:53], s[6:7], v[26:27] op_sel:[0,1] op_sel_hi:[0,1] neg_lo:[0,1] neg_hi:[0,1]
    v_pk_add_f32 v[54:55], s[6:7], v[26:27] op_sel:[0,1] op_sel_hi:[0,1] neg_lo:[0,1] neg_hi:[0,1]
    s_mov_b32 s81, 8
    v_pk_add_f32 v[192:193], v[192:193], v[40:41]
    v_pk_add_f32 v[194:195], v[194:195], v[40:41]
    v_pk_add_f32 v[196:197], v[196:197], v[40:41]
    v_pk_add_f32 v[198:199], v[198:199], v[40:41]
    v_pk_add_f32 v[200:201], v[200:201], v[40:41]
    v_pk_add_f32 v[202:203], v[202:203], v[40:41]
    v_pk_add_f32 v[204:205], v[204:205], v[40:41]
    v_pk_add_f32 v[206:207], v[206:207], v[40:41]
    v_exp_f32 v192, v192
    v_exp_f32 v193, v193
    v_exp_f32 v194, v194
    v_exp_f32 v195, v195
    v_exp_f32 v196, v196
    v_exp_f32 v197, v197
    v_exp_f32 v198, v198
    v_exp_f32 v199, v199
    v_exp_f32 v200, v200
    v_exp_f32 v201, v201
    v_exp_f32 v202, v202
    v_exp_f32 v203, v203
    v_exp_f32 v204, v204
    v_exp_f32 v205, v205
    v_exp_f32 v206, v206
    v_exp_f32 v207, v207
    v_cvt_pk_bf16_f32 v64, v192, v193
    v_cvt_pk_bf16_f32 v65, v194, v195
    v_cvt_pk_bf16_f32 v66, v196, v197
    v_cvt_pk_bf16_f32 v67, v198, v199
    v_cvt_pk_bf16_f32 v68, v200, v201
    v_cvt_pk_bf16_f32 v69, v202, v203
    v_cvt_pk_bf16_f32 v70, v204, v205
    v_cvt_pk_bf16_f32 v71, v206, v207
    v_pk_add_f32 v[208:209], v[208:209], v[44:45]
    v_pk_add_f32 v[210:211], v[210:211], v[44:45]
    v_pk_add_f32 v[212:213], v[212:213], v[44:45]
    v_pk_add_f32 v[214:215], v[214:215], v[44:45]
    v_pk_add_f32 v[216:217], v[216:217], v[44:45]
    v_pk_add_f32 v[218:219], v[218:219], v[44:45]
    v_pk_add_f32 v[220:221], v[220:221], v[44:45]
    v_pk_add_f32 v[222:223], v[222:223], v[44:45]
    v_exp_f32 v208, v208
    v_exp_f32 v209, v209
    v_exp_f32 v210, v210
    v_exp_f32 v211, v211
    v_exp_f32 v212, v212
    v_exp_f32 v213, v213
    v_exp_f32 v214, v214
    v_exp_f32 v215, v215
    v_exp_f32 v216, v216
    v_exp_f32 v217, v217
    v_exp_f32 v218, v218
    v_exp_f32 v219, v219
    v_exp_f32 v220, v220
    v_exp_f32 v221, v221
    v_exp_f32 v222, v222
    v_exp_f32 v223, v223
    v_cvt_pk_bf16_f32 v72, v208, v209
    v_cvt_pk_bf16_f32 v73, v210, v211
    v_cvt_pk_bf16_f32 v74, v212, v213
    v_cvt_pk_bf16_f32 v75, v214, v215
    v_cvt_pk_bf16_f32 v76, v216, v217
    v_cvt_pk_bf16_f32 v77, v218, v219
    v_cvt_pk_bf16_f32 v78, v220, v221
    v_cvt_pk_bf16_f32 v79, v222, v223
    v_pk_add_f32 v[224:225], v[224:225], v[48:49]
    v_pk_add_f32 v[226:227], v[226:227], v[48:49]
    v_pk_add_f32 v[228:229], v[228:229], v[48:49]
    v_pk_add_f32 v[230:231], v[230:231], v[48:49]
    v_pk_add_f32 v[232:233], v[232:233], v[48:49]
    v_pk_add_f32 v[234:235], v[234:235], v[48:49]
    v_pk_add_f32 v[236:237], v[236:237], v[48:49]
    v_pk_add_f32 v[238:239], v[238:239], v[48:49]
    v_exp_f32 v224, v224
    v_exp_f32 v225, v225
    v_exp_f32 v226, v226
    v_exp_f32 v227, v227
    v_exp_f32 v228, v228
    v_exp_f32 v229, v229
    v_exp_f32 v230, v230
    v_exp_f32 v231, v231
    v_exp_f32 v232, v232
    v_exp_f32 v233, v233
    v_exp_f32 v234, v234
    v_exp_f32 v235, v235
    v_exp_f32 v236, v236
    v_exp_f32 v237, v237
    v_exp_f32 v238, v238
    v_exp_f32 v239, v239
    v_cvt_pk_bf16_f32 v80, v224, v225
    v_cvt_pk_bf16_f32 v81, v226, v227
    v_cvt_pk_bf16_f32 v82, v228, v229
    v_cvt_pk_bf16_f32 v83, v230, v231
    v_cvt_pk_bf16_f32 v84, v232, v233
    v_cvt_pk_bf16_f32 v85, v234, v235
    v_cvt_pk_bf16_f32 v86, v236, v237
    v_cvt_pk_bf16_f32 v87, v238, v239
    v_pk_add_f32 v[240:241], v[240:241], v[52:53]
    v_pk_add_f32 v[242:243], v[242:243], v[52:53]
    v_pk_add_f32 v[244:245], v[244:245], v[52:53]
    v_pk_add_f32 v[246:247], v[246:247], v[52:53]
    v_pk_add_f32 v[248:249], v[248:249], v[52:53]
    v_pk_add_f32 v[250:251], v[250:251], v[52:53]
    v_pk_add_f32 v[252:253], v[252:253], v[52:53]
    v_pk_add_f32 v[254:255], v[254:255], v[52:53]
    v_exp_f32 v240, v240
    v_exp_f32 v241, v241
    v_exp_f32 v242, v242
    v_exp_f32 v243, v243
    v_exp_f32 v244, v244
    v_exp_f32 v245, v245
    v_exp_f32 v246, v246
    v_exp_f32 v247, v247
    v_exp_f32 v248, v248
    v_exp_f32 v249, v249
    v_exp_f32 v250, v250
    v_exp_f32 v251, v251
    v_exp_f32 v252, v252
    v_exp_f32 v253, v253
    v_exp_f32 v254, v254
    v_exp_f32 v255, v255
    v_cvt_pk_bf16_f32 v88, v240, v241
    v_cvt_pk_bf16_f32 v89, v242, v243
    v_cvt_pk_bf16_f32 v90, v244, v245
    v_cvt_pk_bf16_f32 v91, v246, v247
    v_cvt_pk_bf16_f32 v92, v248, v249
    v_cvt_pk_bf16_f32 v93, v250, v251
    v_cvt_pk_bf16_f32 v94, v252, v253
    v_cvt_pk_bf16_f32 v95, v254, v255
    s_waitcnt lgkmcnt(0)
    v_mfma_f32_16x16x32_bf16 v[56:59], a[64:67], a[0:3], v[40:43]
    v_mfma_f32_16x16x32_bf16 v[56:59], a[68:71], a[4:7], v[56:59]
    v_mfma_f32_16x16x32_bf16 v[56:59], a[72:75], a[8:11], v[56:59]
    ds_read_b128 a[84:87], v3 offset:20480
    v_mfma_f32_16x16x32_bf16 v[56:59], a[76:79], a[12:15], v[56:59]
    v_mfma_f32_16x16x32_bf16 v[60:63], a[76:79], a[28:31], v[44:47]
    v_mfma_f32_16x16x32_bf16 v[60:63], a[72:75], a[24:27], v[60:63]
    ds_read_b64_tr_b16 a[148:149], v8 offset:8192
    v_mfma_f32_16x16x32_bf16 v[60:63], a[68:71], a[20:23], v[60:63]
    ds_read_b64_tr_b16 a[150:151], v8 offset:12288
    v_mfma_f32_16x16x32_bf16 v[60:63], a[64:67], a[16:19], v[60:63]
    buffer_load_dwordx4 v17, s[20:23], s80 offen offset:3072 lds
    v_mfma_f32_16x16x32_bf16 v[24:27], a[64:67], a[32:35], v[48:51]
    s_mov_b32 m0, s86
    v_exp_f32 v56, v56
    v_mfma_f32_16x16x32_bf16 v[24:27], a[68:71], a[36:39], v[24:27]
    v_exp_f32 v57, v57
    v_mfma_f32_16x16x32_bf16 v[24:27], a[72:75], a[40:43], v[24:27]
    ds_read_b128 a[88:91], v4 offset:20480
    v_mfma_f32_16x16x32_bf16 v[24:27], a[76:79], a[44:47], v[24:27]
    v_exp_f32 v58, v58
    v_mfma_f32_16x16x32_bf16 v[28:31], a[76:79], a[60:63], v[52:55]
    v_exp_f32 v59, v59
    v_mfma_f32_16x16x32_bf16 v[28:31], a[72:75], a[56:59], v[28:31]
    ds_read_b64_tr_b16 a[152:153], v9 offset:0
    v_cvt_pk_bf16_f32 v96, v56, v57
    v_mfma_f32_16x16x32_bf16 v[28:31], a[68:71], a[52:55], v[28:31]
    ds_read_b64_tr_b16 a[154:155], v9 offset:4096
    v_mfma_f32_16x16x32_bf16 v[28:31], a[64:67], a[48:51], v[28:31]
    s_waitcnt lgkmcnt(3)
    buffer_load_dwordx4 v22, s[44:47], s83 offen lds
    v_smfmac_f32_16x16x64_bf16 a[160:163], v[36:39], v[64:71], v35
    v_mfma_f32_16x16x32_bf16 v[128:131], a[128:131], v[64:67], 0
    s_sub_u32 s80, s80, 16384
    v_exp_f32 v60, v60
    v_mfma_f32_16x16x32_bf16 v[128:131], a[132:135], v[68:71], v[128:131]
    s_mov_b32 m0, s74
    v_exp_f32 v61, v61
    v_mfma_f32_16x16x32_bf16 v[132:135], a[132:135], v[76:79], 0
    ds_read_b128 a[92:95], v5 offset:20480
    v_cvt_pk_bf16_f32 v97, v58, v59
    v_mfma_f32_16x16x32_bf16 v[132:135], a[128:131], v[72:75], v[132:135]
    v_exp_f32 v62, v62
    v_mfma_f32_16x16x32_bf16 v[136:139], a[128:131], v[80:83], 0
    v_exp_f32 v63, v63
    v_mfma_f32_16x16x32_bf16 v[136:139], a[132:135], v[84:87], v[136:139]
    ds_read_b64_tr_b16 a[156:157], v9 offset:8192
    v_cvt_pk_bf16_f32 v104, v60, v61
    v_mfma_f32_16x16x32_bf16 v[140:143], a[132:135], v[92:95], 0
    ds_read_b64_tr_b16 a[158:159], v9 offset:12288
    v_mfma_f32_16x16x32_bf16 v[140:143], a[128:131], v[88:91], v[140:143]
    buffer_load_dwordx4 v18, s[24:27], s80 offen offset:0 lds
    v_mfma_f32_16x16x32_bf16 v[156:159], a[136:139], v[88:91], 0
    v_exp_f32 v24, v24
    v_mfma_f32_16x16x32_bf16 v[156:159], a[140:143], v[92:95], v[156:159]
    v_exp_f32 v25, v25
    v_mfma_f32_16x16x32_bf16 v[152:155], a[140:143], v[84:87], 0
    ds_read_b128 a[96:99], v2 offset:24576
    v_cvt_pk_bf16_f32 v105, v62, v63
    v_mfma_f32_16x16x32_bf16 v[152:155], a[136:139], v[80:83], v[152:155]
    v_exp_f32 v26, v26
    v_mfma_f32_16x16x32_bf16 v[148:151], a[136:139], v[72:75], 0
    v_exp_f32 v27, v27
    v_mfma_f32_16x16x32_bf16 v[148:151], a[140:143], v[76:79], v[148:151]
    ds_read_b64_tr_b16 a[128:129], v10 offset:0
    v_cvt_pk_bf16_f32 v112, v24, v25
    v_mfma_f32_16x16x32_bf16 v[144:147], a[140:143], v[68:71], 0
    ds_read_b64_tr_b16 a[130:131], v10 offset:4096
    v_mfma_f32_16x16x32_bf16 v[144:147], a[136:139], v[64:67], v[144:147]
    s_waitcnt lgkmcnt(3)
    v_mfma_f32_16x16x32_bf16 v[56:59], a[80:83], a[0:3], v[40:43]
    v_exp_f32 v28, v28
    v_mfma_f32_16x16x32_bf16 v[56:59], a[84:87], a[4:7], v[56:59]
    v_exp_f32 v29, v29
    v_mfma_f32_16x16x32_bf16 v[56:59], a[88:91], a[8:11], v[56:59]
    ds_read_b128 a[100:103], v3 offset:24576
    v_cvt_pk_bf16_f32 v113, v26, v27
    v_mfma_f32_16x16x32_bf16 v[56:59], a[92:95], a[12:15], v[56:59]
    v_exp_f32 v30, v30
    v_mfma_f32_16x16x32_bf16 v[60:63], a[92:95], a[28:31], v[44:47]
    v_exp_f32 v31, v31
    v_mfma_f32_16x16x32_bf16 v[60:63], a[88:91], a[24:27], v[60:63]
    ds_read_b64_tr_b16 a[132:133], v10 offset:8192
    v_cvt_pk_bf16_f32 v120, v28, v29
    v_mfma_f32_16x16x32_bf16 v[60:63], a[84:87], a[20:23], v[60:63]
    ds_read_b64_tr_b16 a[134:135], v10 offset:12288
    v_mfma_f32_16x16x32_bf16 v[60:63], a[80:83], a[16:19], v[60:63]
    buffer_load_dwordx4 v19, s[24:27], s80 offen offset:1024 lds
    v_mfma_f32_16x16x32_bf16 v[24:27], a[80:83], a[32:35], v[48:51]
    v_exp_f32 v56, v56
    v_mfma_f32_16x16x32_bf16 v[24:27], a[84:87], a[36:39], v[24:27]
    v_exp_f32 v57, v57
    v_mfma_f32_16x16x32_bf16 v[24:27], a[88:91], a[40:43], v[24:27]
    ds_read_b128 a[104:107], v4 offset:24576
    v_cvt_pk_bf16_f32 v121, v30, v31
    v_mfma_f32_16x16x32_bf16 v[24:27], a[92:95], a[44:47], v[24:27]
    v_exp_f32 v58, v58
    v_mfma_f32_16x16x32_bf16 v[28:31], a[92:95], a[60:63], v[52:55]
    v_exp_f32 v59, v59
    v_mfma_f32_16x16x32_bf16 v[28:31], a[88:91], a[56:59], v[28:31]
    ds_read_b64_tr_b16 a[136:137], v11 offset:0
    v_cvt_pk_bf16_f32 v98, v56, v57
    v_mfma_f32_16x16x32_bf16 v[28:31], a[84:87], a[52:55], v[28:31]
    ds_read_b64_tr_b16 a[138:139], v11 offset:4096
    v_mfma_f32_16x16x32_bf16 v[28:31], a[80:83], a[48:51], v[28:31]
    s_waitcnt lgkmcnt(3)
    v_smfmac_f32_16x16x64_bf16 a[164:167], v[36:39], v[72:79], v35
    v_mfma_f32_16x16x32_bf16 v[160:163], a[144:147], v[64:67], 0
    v_exp_f32 v60, v60
    v_mfma_f32_16x16x32_bf16 v[160:163], a[148:151], v[68:71], v[160:163]
    v_exp_f32 v61, v61
    v_mfma_f32_16x16x32_bf16 v[164:167], a[148:151], v[76:79], 0
    ds_read_b128 a[108:111], v5 offset:24576
    v_cvt_pk_bf16_f32 v99, v58, v59
    v_mfma_f32_16x16x32_bf16 v[164:167], a[144:147], v[72:75], v[164:167]
    v_exp_f32 v62, v62
    v_mfma_f32_16x16x32_bf16 v[168:171], a[144:147], v[80:83], 0
    v_exp_f32 v63, v63
    v_mfma_f32_16x16x32_bf16 v[168:171], a[148:151], v[84:87], v[168:171]
    ds_read_b64_tr_b16 a[140:141], v11 offset:8192
    v_cvt_pk_bf16_f32 v106, v60, v61
    v_mfma_f32_16x16x32_bf16 v[172:175], a[148:151], v[92:95], 0
    ds_read_b64_tr_b16 a[142:143], v11 offset:12288
    v_mfma_f32_16x16x32_bf16 v[172:175], a[144:147], v[88:91], v[172:175]
    buffer_load_dwordx4 v18, s[24:27], s80 offen offset:2048 lds
    v_mfma_f32_16x16x32_bf16 v[188:191], a[152:155], v[88:91], 0
    v_exp_f32 v24, v24
    v_mfma_f32_16x16x32_bf16 v[188:191], a[156:159], v[92:95], v[188:191]
    v_exp_f32 v25, v25
    v_mfma_f32_16x16x32_bf16 v[184:187], a[156:159], v[84:87], 0
    ds_read_b128 a[112:115], v2 offset:28672
    v_cvt_pk_bf16_f32 v107, v62, v63
    v_mfma_f32_16x16x32_bf16 v[184:187], a[152:155], v[80:83], v[184:187]
    v_exp_f32 v26, v26
    v_mfma_f32_16x16x32_bf16 v[180:183], a[152:155], v[72:75], 0
    v_exp_f32 v27, v27
    v_mfma_f32_16x16x32_bf16 v[180:183], a[156:159], v[76:79], v[180:183]
    ds_read_b64_tr_b16 a[144:145], v12 offset:0
    v_cvt_pk_bf16_f32 v114, v24, v25
    v_mfma_f32_16x16x32_bf16 v[176:179], a[156:159], v[68:71], 0
    ds_read_b64_tr_b16 a[146:147], v12 offset:4096
    v_mfma_f32_16x16x32_bf16 v[176:179], a[152:155], v[64:67], v[176:179]
    s_waitcnt lgkmcnt(3)
    v_mfma_f32_16x16x32_bf16 v[56:59], a[96:99], a[0:3], v[40:43]
    v_exp_f32 v28, v28
    v_mfma_f32_16x16x32_bf16 v[56:59], a[100:103], a[4:7], v[56:59]
    v_exp_f32 v29, v29
    v_mfma_f32_16x16x32_bf16 v[56:59], a[104:107], a[8:11], v[56:59]
    ds_read_b128 a[116:119], v3 offset:28672
    v_cvt_pk_bf16_f32 v115, v26, v27
    v_mfma_f32_16x16x32_bf16 v[56:59], a[108:111], a[12:15], v[56:59]
    v_exp_f32 v30, v30
    v_mfma_f32_16x16x32_bf16 v[60:63], a[108:111], a[28:31], v[44:47]
    v_exp_f32 v31, v31
    v_mfma_f32_16x16x32_bf16 v[60:63], a[104:107], a[24:27], v[60:63]
    ds_read_b64_tr_b16 a[148:149], v12 offset:8192
    v_cvt_pk_bf16_f32 v122, v28, v29
    v_mfma_f32_16x16x32_bf16 v[60:63], a[100:103], a[20:23], v[60:63]
    ds_read_b64_tr_b16 a[150:151], v12 offset:12288
    v_mfma_f32_16x16x32_bf16 v[60:63], a[96:99], a[16:19], v[60:63]
    buffer_load_dwordx4 v19, s[24:27], s80 offen offset:3072 lds
    v_mfma_f32_16x16x32_bf16 v[24:27], a[96:99], a[32:35], v[48:51]
    s_mov_b32 m0, s86
    v_exp_f32 v56, v56
    v_mfma_f32_16x16x32_bf16 v[24:27], a[100:103], a[36:39], v[24:27]
    v_exp_f32 v57, v57
    v_mfma_f32_16x16x32_bf16 v[24:27], a[104:107], a[40:43], v[24:27]
    ds_read_b128 a[120:123], v4 offset:28672
    v_cvt_pk_bf16_f32 v123, v30, v31
    v_mfma_f32_16x16x32_bf16 v[24:27], a[108:111], a[44:47], v[24:27]
    v_exp_f32 v58, v58
    v_mfma_f32_16x16x32_bf16 v[28:31], a[108:111], a[60:63], v[52:55]
    v_exp_f32 v59, v59
    v_mfma_f32_16x16x32_bf16 v[28:31], a[104:107], a[56:59], v[28:31]
    ds_read_b64_tr_b16 a[152:153], v13 offset:0
    v_cvt_pk_bf16_f32 v100, v56, v57
    v_mfma_f32_16x16x32_bf16 v[28:31], a[100:103], a[52:55], v[28:31]
    ds_read_b64_tr_b16 a[154:155], v13 offset:4096
    v_mfma_f32_16x16x32_bf16 v[28:31], a[96:99], a[48:51], v[28:31]
    s_waitcnt lgkmcnt(3)
    buffer_load_dwordx4 v22, s[44:47], s84 offen offset:1024 lds
    v_smfmac_f32_16x16x64_bf16 a[168:171], v[36:39], v[80:87], v35
    s_waitcnt vmcnt(18)
    s_barrier
    v_mfma_f32_16x16x32_bf16 v[192:195], a[128:131], v[64:67], 0
    s_add_u32 s80, s80, 32768
    v_exp_f32 v60, v60
    v_mfma_f32_16x16x32_bf16 v[192:195], a[132:135], v[68:71], v[192:195]
    s_mov_b32 m0, s68
    v_exp_f32 v61, v61
    v_mfma_f32_16x16x32_bf16 v[196:199], a[132:135], v[76:79], 0
    ds_read_b128 a[124:127], v5 offset:28672
    v_cvt_pk_bf16_f32 v101, v58, v59
    v_mfma_f32_16x16x32_bf16 v[196:199], a[128:131], v[72:75], v[196:199]
    v_exp_f32 v62, v62
    v_mfma_f32_16x16x32_bf16 v[200:203], a[128:131], v[80:83], 0
    v_exp_f32 v63, v63
    v_mfma_f32_16x16x32_bf16 v[200:203], a[132:135], v[84:87], v[200:203]
    ds_read_b64_tr_b16 a[156:157], v13 offset:8192
    v_cvt_pk_bf16_f32 v108, v60, v61
    v_mfma_f32_16x16x32_bf16 v[204:207], a[132:135], v[92:95], 0
    ds_read_b64_tr_b16 a[158:159], v13 offset:12288
    v_mfma_f32_16x16x32_bf16 v[204:207], a[128:131], v[88:91], v[204:207]
    buffer_load_dwordx4 v14, s[20:23], s80 offen offset:0 lds
    v_mfma_f32_16x16x32_bf16 v[220:223], a[136:139], v[88:91], 0
    s_cmp_gt_u32 s81, 5
    v_exp_f32 v24, v24
    v_mfma_f32_16x16x32_bf16 v[220:223], a[140:143], v[92:95], v[220:223]
    s_cselect_b32 s46, s46, 0
    v_exp_f32 v25, v25
    v_mfma_f32_16x16x32_bf16 v[216:219], a[140:143], v[84:87], 0
    ds_read_b128 a[64:67], v2 offset:32768
    v_cvt_pk_bf16_f32 v109, v62, v63
    v_mfma_f32_16x16x32_bf16 v[216:219], a[136:139], v[80:83], v[216:219]
    v_exp_f32 v26, v26
    v_mfma_f32_16x16x32_bf16 v[212:215], a[136:139], v[72:75], 0
    v_exp_f32 v27, v27
    v_mfma_f32_16x16x32_bf16 v[212:215], a[140:143], v[76:79], v[212:215]
    ds_read_b64_tr_b16 a[128:129], v6 offset:16384
    v_cvt_pk_bf16_f32 v116, v24, v25
    v_mfma_f32_16x16x32_bf16 v[208:211], a[140:143], v[68:71], 0
    ds_read_b64_tr_b16 a[130:131], v6 offset:20480
    v_mfma_f32_16x16x32_bf16 v[208:211], a[136:139], v[64:67], v[208:211]
    s_waitcnt lgkmcnt(3)
    v_mfma_f32_16x16x32_bf16 v[56:59], a[112:115], a[0:3], v[40:43]
    v_exp_f32 v28, v28
    v_mfma_f32_16x16x32_bf16 v[56:59], a[116:119], a[4:7], v[56:59]
    v_exp_f32 v29, v29
    v_mfma_f32_16x16x32_bf16 v[56:59], a[120:123], a[8:11], v[56:59]
    ds_read_b128 a[68:71], v3 offset:32768
    v_cvt_pk_bf16_f32 v117, v26, v27
    v_mfma_f32_16x16x32_bf16 v[56:59], a[124:127], a[12:15], v[56:59]
    v_exp_f32 v30, v30
    v_mfma_f32_16x16x32_bf16 v[60:63], a[124:127], a[28:31], v[44:47]
    v_exp_f32 v31, v31
    v_mfma_f32_16x16x32_bf16 v[60:63], a[120:123], a[24:27], v[60:63]
    ds_read_b64_tr_b16 a[132:133], v6 offset:24576
    v_cvt_pk_bf16_f32 v124, v28, v29
    v_mfma_f32_16x16x32_bf16 v[60:63], a[116:119], a[20:23], v[60:63]
    ds_read_b64_tr_b16 a[134:135], v6 offset:28672
    v_mfma_f32_16x16x32_bf16 v[60:63], a[112:115], a[16:19], v[60:63]
    buffer_load_dwordx4 v15, s[20:23], s80 offen offset:1024 lds
    v_mfma_f32_16x16x32_bf16 v[24:27], a[112:115], a[32:35], v[48:51]
    s_cmp_eq_u32 s81, 4
    v_exp_f32 v56, v56
    v_mfma_f32_16x16x32_bf16 v[24:27], a[116:119], a[36:39], v[24:27]
    s_cselect_b32 s5, s93, 16777216
    v_exp_f32 v57, v57
    v_mfma_f32_16x16x32_bf16 v[24:27], a[120:123], a[40:43], v[24:27]
    ds_read_b128 a[72:75], v4 offset:32768
    v_cvt_pk_bf16_f32 v125, v30, v31
    v_mfma_f32_16x16x32_bf16 v[24:27], a[124:127], a[44:47], v[24:27]
    v_exp_f32 v58, v58
    v_mfma_f32_16x16x32_bf16 v[28:31], a[124:127], a[60:63], v[52:55]
    v_exp_f32 v59, v59
    v_mfma_f32_16x16x32_bf16 v[28:31], a[120:123], a[56:59], v[28:31]
    ds_read_b64_tr_b16 a[136:137], v7 offset:16384
    v_cvt_pk_bf16_f32 v102, v56, v57
    v_mfma_f32_16x16x32_bf16 v[28:31], a[116:119], a[52:55], v[28:31]
    ds_read_b64_tr_b16 a[138:139], v7 offset:20480
    v_mfma_f32_16x16x32_bf16 v[28:31], a[112:115], a[48:51], v[28:31]
    s_waitcnt lgkmcnt(3)
    v_smfmac_f32_16x16x64_bf16 a[172:175], v[36:39], v[88:95], v35
    buffer_atomic_add v32, v33, s[40:43], s5 offen
    v_mfma_f32_16x16x32_bf16 v[224:227], a[144:147], v[64:67], 0
    v_exp_f32 v60, v60
    v_mfma_f32_16x16x32_bf16 v[224:227], a[148:151], v[68:71], v[224:227]
    v_exp_f32 v61, v61
    v_mfma_f32_16x16x32_bf16 v[228:231], a[148:151], v[76:79], 0
    ds_read_b128 a[76:79], v5 offset:32768
    v_cvt_pk_bf16_f32 v103, v58, v59
    v_mfma_f32_16x16x32_bf16 v[228:231], a[144:147], v[72:75], v[228:231]
    v_exp_f32 v62, v62
    v_mfma_f32_16x16x32_bf16 v[232:235], a[144:147], v[80:83], 0
    v_exp_f32 v63, v63
    v_mfma_f32_16x16x32_bf16 v[232:235], a[148:151], v[84:87], v[232:235]
    ds_read_b64_tr_b16 a[140:141], v7 offset:24576
    v_cvt_pk_bf16_f32 v110, v60, v61
    v_mfma_f32_16x16x32_bf16 v[236:239], a[148:151], v[92:95], 0
    ds_read_b64_tr_b16 a[142:143], v7 offset:28672
    v_mfma_f32_16x16x32_bf16 v[236:239], a[144:147], v[88:91], v[236:239]
    buffer_load_dwordx4 v16, s[20:23], s80 offen offset:2048 lds
    v_mfma_f32_16x16x32_bf16 v[252:255], a[152:155], v[88:91], 0
    v_exp_f32 v24, v24
    v_mfma_f32_16x16x32_bf16 v[252:255], a[156:159], v[92:95], v[252:255]
    v_exp_f32 v25, v25
    v_mfma_f32_16x16x32_bf16 v[248:251], a[156:159], v[84:87], 0
    ds_read_b128 a[80:83], v2 offset:36864
    v_cvt_pk_bf16_f32 v111, v62, v63
    v_mfma_f32_16x16x32_bf16 v[248:251], a[152:155], v[80:83], v[248:251]
    v_exp_f32 v26, v26
    v_mfma_f32_16x16x32_bf16 v[244:247], a[152:155], v[72:75], 0
    v_exp_f32 v27, v27
    v_mfma_f32_16x16x32_bf16 v[244:247], a[156:159], v[76:79], v[244:247]
    ds_read_b64_tr_b16 a[144:145], v8 offset:16384
    v_cvt_pk_bf16_f32 v118, v24, v25
    v_mfma_f32_16x16x32_bf16 v[240:243], a[156:159], v[68:71], 0
    ds_read_b64_tr_b16 a[146:147], v8 offset:20480
    v_mfma_f32_16x16x32_bf16 v[240:243], a[152:155], v[64:67], v[240:243]
    s_waitcnt lgkmcnt(3)
.p2align 6
M_loop:
    v_mfma_f32_16x16x32_bf16 v[56:59], a[64:67], a[0:3], v[40:43]
    v_exp_f32 v28, v28
    v_mfma_f32_16x16x32_bf16 v[56:59], a[68:71], a[4:7], v[56:59]
    v_exp_f32 v29, v29
    v_mfma_f32_16x16x32_bf16 v[56:59], a[72:75], a[8:11], v[56:59]
    ds_read_b128 a[84:87], v3 offset:36864
    v_cvt_pk_bf16_f32 v119, v26, v27
    v_mfma_f32_16x16x32_bf16 v[56:59], a[76:79], a[12:15], v[56:59]
    v_exp_f32 v30, v30
    v_mfma_f32_16x16x32_bf16 v[60:63], a[76:79], a[28:31], v[44:47]
    v_exp_f32 v31, v31
    v_mfma_f32_16x16x32_bf16 v[60:63], a[72:75], a[24:27], v[60:63]
    ds_read_b64_tr_b16 a[148:149], v8 offset:24576
    v_cvt_pk_bf16_f32 v126, v28, v29
    v_mfma_f32_16x16x32_bf16 v[60:63], a[68:71], a[20:23], v[60:63]
    ds_read_b64_tr_b16 a[150:151], v8 offset:28672
    v_mfma_f32_16x16x32_bf16 v[60:63], a[64:67], a[16:19], v[60:63]
    buffer_load_dwordx4 v17, s[20:23], s80 offen offset:3072 lds
    v_mfma_f32_16x16x32_bf16 v[24:27], a[64:67], a[32:35], v[48:51]
    v_exp_f32 v56, v56
    v_mfma_f32_16x16x32_bf16 v[24:27], a[68:71], a[36:39], v[24:27]
    v_exp_f32 v57, v57
    v_mfma_f32_16x16x32_bf16 v[24:27], a[72:75], a[40:43], v[24:27]
    ds_read_b128 a[88:91], v4 offset:36864
    v_cvt_pk_bf16_f32 v127, v30, v31
    v_mfma_f32_16x16x32_bf16 v[24:27], a[76:79], a[44:47], v[24:27]
    v_exp_f32 v58, v58
    v_mfma_f32_16x16x32_bf16 v[28:31], a[76:79], a[60:63], v[52:55]
    v_exp_f32 v59, v59
    v_mfma_f32_16x16x32_bf16 v[28:31], a[72:75], a[56:59], v[28:31]
    ds_read_b64_tr_b16 a[152:153], v9 offset:16384
    v_cvt_pk_bf16_f32 v64, v56, v57
    v_mfma_f32_16x16x32_bf16 v[28:31], a[68:71], a[52:55], v[28:31]
    ds_read_b64_tr_b16 a[154:155], v9 offset:20480
    v_mfma_f32_16x16x32_bf16 v[28:31], a[64:67], a[48:51], v[28:31]
    s_waitcnt lgkmcnt(3)
    v_smfmac_f32_16x16x64_bf16 a[160:163], v[36:39], v[96:103], v35
    v_mfma_f32_16x16x32_bf16 v[128:131], a[128:131], v[96:99], v[128:131]
    s_sub_u32 s80, s80, 16384
    v_exp_f32 v60, v60
    v_mfma_f32_16x16x32_bf16 v[128:131], a[132:135], v[100:103], v[128:131]
    s_mov_b32 m0, s75
    v_exp_f32 v61, v61
    v_mfma_f32_16x16x32_bf16 v[132:135], a[132:135], v[108:111], v[132:135]
    ds_read_b128 a[92:95], v5 offset:36864
    v_cvt_pk_bf16_f32 v65, v58, v59
    v_mfma_f32_16x16x32_bf16 v[132:135], a[128:131], v[104:107], v[132:135]
    v_exp_f32 v62, v62
    v_mfma_f32_16x16x32_bf16 v[136:139], a[128:131], v[112:115], v[136:139]
    v_exp_f32 v63, v63
    v_mfma_f32_16x16x32_bf16 v[136:139], a[132:135], v[116:119], v[136:139]
    ds_read_b64_tr_b16 a[156:157], v9 offset:24576
    v_cvt_pk_bf16_f32 v72, v60, v61
    v_mfma_f32_16x16x32_bf16 v[140:143], a[132:135], v[124:127], v[140:143]
    ds_read_b64_tr_b16 a[158:159], v9 offset:28672
    v_mfma_f32_16x16x32_bf16 v[140:143], a[128:131], v[120:123], v[140:143]
    buffer_load_dwordx4 v18, s[24:27], s80 offen offset:0 lds
    v_mfma_f32_16x16x32_bf16 v[156:159], a[136:139], v[120:123], v[156:159]
    v_exp_f32 v24, v24
    v_mfma_f32_16x16x32_bf16 v[156:159], a[140:143], v[124:127], v[156:159]
    v_exp_f32 v25, v25
    v_mfma_f32_16x16x32_bf16 v[152:155], a[140:143], v[116:119], v[152:155]
    ds_read_b128 a[96:99], v2 offset:40960
    v_cvt_pk_bf16_f32 v73, v62, v63
    v_mfma_f32_16x16x32_bf16 v[152:155], a[136:139], v[112:115], v[152:155]
    v_exp_f32 v26, v26
    v_mfma_f32_16x16x32_bf16 v[148:151], a[136:139], v[104:107], v[148:151]
    v_exp_f32 v27, v27
    v_mfma_f32_16x16x32_bf16 v[148:151], a[140:143], v[108:111], v[148:151]
    ds_read_b64_tr_b16 a[128:129], v10 offset:16384
    v_cvt_pk_bf16_f32 v80, v24, v25
    v_mfma_f32_16x16x32_bf16 v[144:147], a[140:143], v[100:103], v[144:147]
    ds_read_b64_tr_b16 a[130:131], v10 offset:20480
    v_mfma_f32_16x16x32_bf16 v[144:147], a[136:139], v[96:99], v[144:147]
    s_waitcnt lgkmcnt(3)
    v_mfma_f32_16x16x32_bf16 v[56:59], a[80:83], a[0:3], v[40:43]
    v_exp_f32 v28, v28
    v_mfma_f32_16x16x32_bf16 v[56:59], a[84:87], a[4:7], v[56:59]
    v_exp_f32 v29, v29
    v_mfma_f32_16x16x32_bf16 v[56:59], a[88:91], a[8:11], v[56:59]
    ds_read_b128 a[100:103], v3 offset:40960
    v_cvt_pk_bf16_f32 v81, v26, v27
    v_mfma_f32_16x16x32_bf16 v[56:59], a[92:95], a[12:15], v[56:59]
    v_exp_f32 v30, v30
    v_mfma_f32_16x16x32_bf16 v[60:63], a[92:95], a[28:31], v[44:47]
    v_exp_f32 v31, v31
    v_mfma_f32_16x16x32_bf16 v[60:63], a[88:91], a[24:27], v[60:63]
    ds_read_b64_tr_b16 a[132:133], v10 offset:24576
    v_cvt_pk_bf16_f32 v88, v28, v29
    v_mfma_f32_16x16x32_bf16 v[60:63], a[84:87], a[20:23], v[60:63]
    ds_read_b64_tr_b16 a[134:135], v10 offset:28672
    v_mfma_f32_16x16x32_bf16 v[60:63], a[80:83], a[16:19], v[60:63]
    buffer_load_dwordx4 v19, s[24:27], s80 offen offset:1024 lds
    v_mfma_f32_16x16x32_bf16 v[24:27], a[80:83], a[32:35], v[48:51]
    v_exp_f32 v56, v56
    v_mfma_f32_16x16x32_bf16 v[24:27], a[84:87], a[36:39], v[24:27]
    v_exp_f32 v57, v57
    v_mfma_f32_16x16x32_bf16 v[24:27], a[88:91], a[40:43], v[24:27]
    ds_read_b128 a[104:107], v4 offset:40960
    v_cvt_pk_bf16_f32 v89, v30, v31
    v_mfma_f32_16x16x32_bf16 v[24:27], a[92:95], a[44:47], v[24:27]
    v_exp_f32 v58, v58
    v_mfma_f32_16x16x32_bf16 v[28:31], a[92:95], a[60:63], v[52:55]
    v_exp_f32 v59, v59
    v_mfma_f32_16x16x32_bf16 v[28:31], a[88:91], a[56:59], v[28:31]
    ds_read_b64_tr_b16 a[136:137], v11 offset:16384
    v_cvt_pk_bf16_f32 v66, v56, v57
    v_mfma_f32_16x16x32_bf16 v[28:31], a[84:87], a[52:55], v[28:31]
    ds_read_b64_tr_b16 a[138:139], v11 offset:20480
    v_mfma_f32_16x16x32_bf16 v[28:31], a[80:83], a[48:51], v[28:31]
    s_waitcnt lgkmcnt(3)
    v_smfmac_f32_16x16x64_bf16 a[164:167], v[36:39], v[104:111], v35
    v_mfma_f32_16x16x32_bf16 v[160:163], a[144:147], v[96:99], v[160:163]
    v_exp_f32 v60, v60
    v_mfma_f32_16x16x32_bf16 v[160:163], a[148:151], v[100:103], v[160:163]
    v_exp_f32 v61, v61
    v_mfma_f32_16x16x32_bf16 v[164:167], a[148:151], v[108:111], v[164:167]
    ds_read_b128 a[108:111], v5 offset:40960
    v_cvt_pk_bf16_f32 v67, v58, v59
    v_mfma_f32_16x16x32_bf16 v[164:167], a[144:147], v[104:107], v[164:167]
    v_exp_f32 v62, v62
    v_mfma_f32_16x16x32_bf16 v[168:171], a[144:147], v[112:115], v[168:171]
    v_exp_f32 v63, v63
    v_mfma_f32_16x16x32_bf16 v[168:171], a[148:151], v[116:119], v[168:171]
    ds_read_b64_tr_b16 a[140:141], v11 offset:24576
    v_cvt_pk_bf16_f32 v74, v60, v61
    v_mfma_f32_16x16x32_bf16 v[172:175], a[148:151], v[124:127], v[172:175]
    ds_read_b64_tr_b16 a[142:143], v11 offset:28672
    v_mfma_f32_16x16x32_bf16 v[172:175], a[144:147], v[120:123], v[172:175]
    buffer_load_dwordx4 v18, s[24:27], s80 offen offset:2048 lds
    v_mfma_f32_16x16x32_bf16 v[188:191], a[152:155], v[120:123], v[188:191]
    v_exp_f32 v24, v24
    v_mfma_f32_16x16x32_bf16 v[188:191], a[156:159], v[124:127], v[188:191]
    v_exp_f32 v25, v25
    v_mfma_f32_16x16x32_bf16 v[184:187], a[156:159], v[116:119], v[184:187]
    ds_read_b128 a[112:115], v2 offset:45056
    v_cvt_pk_bf16_f32 v75, v62, v63
    v_mfma_f32_16x16x32_bf16 v[184:187], a[152:155], v[112:115], v[184:187]
    v_exp_f32 v26, v26
    v_mfma_f32_16x16x32_bf16 v[180:183], a[152:155], v[104:107], v[180:183]
    v_exp_f32 v27, v27
    v_mfma_f32_16x16x32_bf16 v[180:183], a[156:159], v[108:111], v[180:183]
    ds_read_b64_tr_b16 a[144:145], v12 offset:16384
    v_cvt_pk_bf16_f32 v82, v24, v25
    v_mfma_f32_16x16x32_bf16 v[176:179], a[156:159], v[100:103], v[176:179]
    ds_read_b64_tr_b16 a[146:147], v12 offset:20480
    v_mfma_f32_16x16x32_bf16 v[176:179], a[152:155], v[96:99], v[176:179]
    s_waitcnt lgkmcnt(3)
    v_mfma_f32_16x16x32_bf16 v[56:59], a[96:99], a[0:3], v[40:43]
    v_exp_f32 v28, v28
    v_mfma_f32_16x16x32_bf16 v[56:59], a[100:103], a[4:7], v[56:59]
    v_exp_f32 v29, v29
    v_mfma_f32_16x16x32_bf16 v[56:59], a[104:107], a[8:11], v[56:59]
    ds_read_b128 a[116:119], v3 offset:45056
    v_cvt_pk_bf16_f32 v83, v26, v27
    v_mfma_f32_16x16x32_bf16 v[56:59], a[108:111], a[12:15], v[56:59]
    v_exp_f32 v30, v30
    v_mfma_f32_16x16x32_bf16 v[60:63], a[108:111], a[28:31], v[44:47]
    v_exp_f32 v31, v31
    v_mfma_f32_16x16x32_bf16 v[60:63], a[104:107], a[24:27], v[60:63]
    ds_read_b64_tr_b16 a[148:149], v12 offset:24576
    v_cvt_pk_bf16_f32 v90, v28, v29
    v_mfma_f32_16x16x32_bf16 v[60:63], a[100:103], a[20:23], v[60:63]
    ds_read_b64_tr_b16 a[150:151], v12 offset:28672
    v_mfma_f32_16x16x32_bf16 v[60:63], a[96:99], a[16:19], v[60:63]
    buffer_load_dwordx4 v19, s[24:27], s80 offen offset:3072 lds
    v_mfma_f32_16x16x32_bf16 v[24:27], a[96:99], a[32:35], v[48:51]
    v_exp_f32 v56, v56
    v_mfma_f32_16x16x32_bf16 v[24:27], a[100:103], a[36:39], v[24:27]
    v_exp_f32 v57, v57
    v_mfma_f32_16x16x32_bf16 v[24:27], a[104:107], a[40:43], v[24:27]
    ds_read_b128 a[120:123], v4 offset:45056
    v_cvt_pk_bf16_f32 v91, v30, v31
    v_mfma_f32_16x16x32_bf16 v[24:27], a[108:111], a[44:47], v[24:27]
    v_exp_f32 v58, v58
    v_mfma_f32_16x16x32_bf16 v[28:31], a[108:111], a[60:63], v[52:55]
    v_exp_f32 v59, v59
    v_mfma_f32_16x16x32_bf16 v[28:31], a[104:107], a[56:59], v[28:31]
    ds_read_b64_tr_b16 a[152:153], v13 offset:16384
    v_cvt_pk_bf16_f32 v68, v56, v57
    v_mfma_f32_16x16x32_bf16 v[28:31], a[100:103], a[52:55], v[28:31]
    ds_read_b64_tr_b16 a[154:155], v13 offset:20480
    v_mfma_f32_16x16x32_bf16 v[28:31], a[96:99], a[48:51], v[28:31]
    s_waitcnt lgkmcnt(3)
    v_smfmac_f32_16x16x64_bf16 a[168:171], v[36:39], v[112:119], v35
    s_waitcnt vmcnt(9)
    s_barrier
    v_mfma_f32_16x16x32_bf16 v[192:195], a[128:131], v[96:99], v[192:195]
    s_add_u32 s80, s80, 32768
    v_exp_f32 v60, v60
    v_mfma_f32_16x16x32_bf16 v[192:195], a[132:135], v[100:103], v[192:195]
    s_mov_b32 m0, s69
    v_exp_f32 v61, v61
    v_mfma_f32_16x16x32_bf16 v[196:199], a[132:135], v[108:111], v[196:199]
    ds_read_b128 a[124:127], v5 offset:45056
    v_cvt_pk_bf16_f32 v69, v58, v59
    v_mfma_f32_16x16x32_bf16 v[196:199], a[128:131], v[104:107], v[196:199]
    v_exp_f32 v62, v62
    v_mfma_f32_16x16x32_bf16 v[200:203], a[128:131], v[112:115], v[200:203]
    v_exp_f32 v63, v63
    v_mfma_f32_16x16x32_bf16 v[200:203], a[132:135], v[116:119], v[200:203]
    ds_read_b64_tr_b16 a[156:157], v13 offset:24576
    v_cvt_pk_bf16_f32 v76, v60, v61
    v_mfma_f32_16x16x32_bf16 v[204:207], a[132:135], v[124:127], v[204:207]
    ds_read_b64_tr_b16 a[158:159], v13 offset:28672
    v_mfma_f32_16x16x32_bf16 v[204:207], a[128:131], v[120:123], v[204:207]
    buffer_load_dwordx4 v14, s[20:23], s80 offen offset:0 lds
    v_mfma_f32_16x16x32_bf16 v[220:223], a[136:139], v[120:123], v[220:223]
    v_exp_f32 v24, v24
    v_mfma_f32_16x16x32_bf16 v[220:223], a[140:143], v[124:127], v[220:223]
    v_exp_f32 v25, v25
    v_mfma_f32_16x16x32_bf16 v[216:219], a[140:143], v[116:119], v[216:219]
    ds_read_b128 a[64:67], v2 offset:49152
    v_cvt_pk_bf16_f32 v77, v62, v63
    v_mfma_f32_16x16x32_bf16 v[216:219], a[136:139], v[112:115], v[216:219]
    v_exp_f32 v26, v26
    v_mfma_f32_16x16x32_bf16 v[212:215], a[136:139], v[104:107], v[212:215]
    v_exp_f32 v27, v27
    v_mfma_f32_16x16x32_bf16 v[212:215], a[140:143], v[108:111], v[212:215]
    ds_read_b64_tr_b16 a[128:129], v6 offset:32768
    v_cvt_pk_bf16_f32 v84, v24, v25
    v_mfma_f32_16x16x32_bf16 v[208:211], a[140:143], v[100:103], v[208:211]
    ds_read_b64_tr_b16 a[130:131], v6 offset:36864
    v_mfma_f32_16x16x32_bf16 v[208:211], a[136:139], v[96:99], v[208:211]
    s_waitcnt lgkmcnt(3)
    v_mfma_f32_16x16x32_bf16 v[56:59], a[112:115], a[0:3], v[40:43]
    v_exp_f32 v28, v28
    v_mfma_f32_16x16x32_bf16 v[56:59], a[116:119], a[4:7], v[56:59]
    v_exp_f32 v29, v29
    v_mfma_f32_16x16x32_bf16 v[56:59], a[120:123], a[8:11], v[56:59]
    ds_read_b128 a[68:71], v3 offset:49152
    v_cvt_pk_bf16_f32 v85, v26, v27
    v_mfma_f32_16x16x32_bf16 v[56:59], a[124:127], a[12:15], v[56:59]
    v_exp_f32 v30, v30
    v_mfma_f32_16x16x32_bf16 v[60:63], a[124:127], a[28:31], v[44:47]
    v_exp_f32 v31, v31
    v_mfma_f32_16x16x32_bf16 v[60:63], a[120:123], a[24:27], v[60:63]
    ds_read_b64_tr_b16 a[132:133], v6 offset:40960
    v_cvt_pk_bf16_f32 v92, v28, v29
    v_mfma_f32_16x16x32_bf16 v[60:63], a[116:119], a[20:23], v[60:63]
    ds_read_b64_tr_b16 a[134:135], v6 offset:45056
    v_mfma_f32_16x16x32_bf16 v[60:63], a[112:115], a[16:19], v[60:63]
    buffer_load_dwordx4 v15, s[20:23], s80 offen offset:1024 lds
    v_mfma_f32_16x16x32_bf16 v[24:27], a[112:115], a[32:35], v[48:51]
    v_exp_f32 v56, v56
    v_mfma_f32_16x16x32_bf16 v[24:27], a[116:119], a[36:39], v[24:27]
    v_exp_f32 v57, v57
    v_mfma_f32_16x16x32_bf16 v[24:27], a[120:123], a[40:43], v[24:27]
    ds_read_b128 a[72:75], v4 offset:49152
    v_cvt_pk_bf16_f32 v93, v30, v31
    v_mfma_f32_16x16x32_bf16 v[24:27], a[124:127], a[44:47], v[24:27]
    v_exp_f32 v58, v58
    v_mfma_f32_16x16x32_bf16 v[28:31], a[124:127], a[60:63], v[52:55]
    v_exp_f32 v59, v59
    v_mfma_f32_16x16x32_bf16 v[28:31], a[120:123], a[56:59], v[28:31]
    ds_read_b64_tr_b16 a[136:137], v7 offset:32768
    v_cvt_pk_bf16_f32 v70, v56, v57
    v_mfma_f32_16x16x32_bf16 v[28:31], a[116:119], a[52:55], v[28:31]
    ds_read_b64_tr_b16 a[138:139], v7 offset:36864
    v_mfma_f32_16x16x32_bf16 v[28:31], a[112:115], a[48:51], v[28:31]
    s_waitcnt lgkmcnt(3)
    v_smfmac_f32_16x16x64_bf16 a[172:175], v[36:39], v[120:127], v35
    v_mfma_f32_16x16x32_bf16 v[224:227], a[144:147], v[96:99], v[224:227]
    v_exp_f32 v60, v60
    v_mfma_f32_16x16x32_bf16 v[224:227], a[148:151], v[100:103], v[224:227]
    v_exp_f32 v61, v61
    v_mfma_f32_16x16x32_bf16 v[228:231], a[148:151], v[108:111], v[228:231]
    ds_read_b128 a[76:79], v5 offset:49152
    v_cvt_pk_bf16_f32 v71, v58, v59
    v_mfma_f32_16x16x32_bf16 v[228:231], a[144:147], v[104:107], v[228:231]
    v_exp_f32 v62, v62
    v_mfma_f32_16x16x32_bf16 v[232:235], a[144:147], v[112:115], v[232:235]
    v_exp_f32 v63, v63
    v_mfma_f32_16x16x32_bf16 v[232:235], a[148:151], v[116:119], v[232:235]
    ds_read_b64_tr_b16 a[140:141], v7 offset:40960
    v_cvt_pk_bf16_f32 v78, v60, v61
    v_mfma_f32_16x16x32_bf16 v[236:239], a[148:151], v[124:127], v[236:239]
    ds_read_b64_tr_b16 a[142:143], v7 offset:45056
    v_mfma_f32_16x16x32_bf16 v[236:239], a[144:147], v[120:123], v[236:239]
    buffer_load_dwordx4 v16, s[20:23], s80 offen offset:2048 lds
    v_mfma_f32_16x16x32_bf16 v[252:255], a[152:155], v[120:123], v[252:255]
    v_exp_f32 v24, v24
    v_mfma_f32_16x16x32_bf16 v[252:255], a[156:159], v[124:127], v[252:255]
    v_exp_f32 v25, v25
    v_mfma_f32_16x16x32_bf16 v[248:251], a[156:159], v[116:119], v[248:251]
    ds_read_b128 a[80:83], v2 offset:53248
    v_cvt_pk_bf16_f32 v79, v62, v63
    v_mfma_f32_16x16x32_bf16 v[248:251], a[152:155], v[112:115], v[248:251]
    v_exp_f32 v26, v26
    v_mfma_f32_16x16x32_bf16 v[244:247], a[152:155], v[104:107], v[244:247]
    v_exp_f32 v27, v27
    v_mfma_f32_16x16x32_bf16 v[244:247], a[156:159], v[108:111], v[244:247]
    ds_read_b64_tr_b16 a[144:145], v8 offset:32768
    v_cvt_pk_bf16_f32 v86, v24, v25
    v_mfma_f32_16x16x32_bf16 v[240:243], a[156:159], v[100:103], v[240:243]
    ds_read_b64_tr_b16 a[146:147], v8 offset:36864
    v_mfma_f32_16x16x32_bf16 v[240:243], a[152:155], v[96:99], v[240:243]
    s_waitcnt lgkmcnt(3)
    v_mfma_f32_16x16x32_bf16 v[56:59], a[64:67], a[0:3], v[40:43]
    v_exp_f32 v28, v28
    v_mfma_f32_16x16x32_bf16 v[56:59], a[68:71], a[4:7], v[56:59]
    v_exp_f32 v29, v29
    v_mfma_f32_16x16x32_bf16 v[56:59], a[72:75], a[8:11], v[56:59]
    ds_read_b128 a[84:87], v3 offset:53248
    v_cvt_pk_bf16_f32 v87, v26, v27
    v_mfma_f32_16x16x32_bf16 v[56:59], a[76:79], a[12:15], v[56:59]
    v_exp_f32 v30, v30
    v_mfma_f32_16x16x32_bf16 v[60:63], a[76:79], a[28:31], v[44:47]
    v_exp_f32 v31, v31
    v_mfma_f32_16x16x32_bf16 v[60:63], a[72:75], a[24:27], v[60:63]
    ds_read_b64_tr_b16 a[148:149], v8 offset:40960
    v_cvt_pk_bf16_f32 v94, v28, v29
    v_mfma_f32_16x16x32_bf16 v[60:63], a[68:71], a[20:23], v[60:63]
    ds_read_b64_tr_b16 a[150:151], v8 offset:45056
    v_mfma_f32_16x16x32_bf16 v[60:63], a[64:67], a[16:19], v[60:63]
    buffer_load_dwordx4 v17, s[20:23], s80 offen offset:3072 lds
    v_mfma_f32_16x16x32_bf16 v[24:27], a[64:67], a[32:35], v[48:51]
    v_exp_f32 v56, v56
    v_mfma_f32_16x16x32_bf16 v[24:27], a[68:71], a[36:39], v[24:27]
    v_exp_f32 v57, v57
    v_mfma_f32_16x16x32_bf16 v[24:27], a[72:75], a[40:43], v[24:27]
    ds_read_b128 a[88:91], v4 offset:53248
    v_cvt_pk_bf16_f32 v95, v30, v31
    v_mfma_f32_16x16x32_bf16 v[24:27], a[76:79], a[44:47], v[24:27]
    v_exp_f32 v58, v58
    v_mfma_f32_16x16x32_bf16 v[28:31], a[76:79], a[60:63], v[52:55]
    v_exp_f32 v59, v59
    v_mfma_f32_16x16x32_bf16 v[28:31], a[72:75], a[56:59], v[28:31]
    ds_read_b64_tr_b16 a[152:153], v9 offset:32768
    v_cvt_pk_bf16_f32 v96, v56, v57
    v_mfma_f32_16x16x32_bf16 v[28:31], a[68:71], a[52:55], v[28:31]
    ds_read_b64_tr_b16 a[154:155], v9 offset:36864
    v_mfma_f32_16x16x32_bf16 v[28:31], a[64:67], a[48:51], v[28:31]
    s_waitcnt lgkmcnt(3)
    v_smfmac_f32_16x16x64_bf16 a[160:163], v[36:39], v[64:71], v35
    v_mfma_f32_16x16x32_bf16 v[128:131], a[128:131], v[64:67], v[128:131]
    s_sub_u32 s80, s80, 16384
    v_exp_f32 v60, v60
    v_mfma_f32_16x16x32_bf16 v[128:131], a[132:135], v[68:71], v[128:131]
    s_mov_b32 m0, s72
    v_exp_f32 v61, v61
    v_mfma_f32_16x16x32_bf16 v[132:135], a[132:135], v[76:79], v[132:135]
    ds_read_b128 a[92:95], v5 offset:53248
    v_cvt_pk_bf16_f32 v97, v58, v59
    v_mfma_f32_16x16x32_bf16 v[132:135], a[128:131], v[72:75], v[132:135]
    v_exp_f32 v62, v62
    v_mfma_f32_16x16x32_bf16 v[136:139], a[128:131], v[80:83], v[136:139]
    v_exp_f32 v63, v63
    v_mfma_f32_16x16x32_bf16 v[136:139], a[132:135], v[84:87], v[136:139]
    ds_read_b64_tr_b16 a[156:157], v9 offset:40960
    v_cvt_pk_bf16_f32 v104, v60, v61
    v_mfma_f32_16x16x32_bf16 v[140:143], a[132:135], v[92:95], v[140:143]
    ds_read_b64_tr_b16 a[158:159], v9 offset:45056
    v_mfma_f32_16x16x32_bf16 v[140:143], a[128:131], v[88:91], v[140:143]
    buffer_load_dwordx4 v18, s[24:27], s80 offen offset:0 lds
    v_mfma_f32_16x16x32_bf16 v[156:159], a[136:139], v[88:91], v[156:159]
    v_exp_f32 v24, v24
    v_mfma_f32_16x16x32_bf16 v[156:159], a[140:143], v[92:95], v[156:159]
    v_exp_f32 v25, v25
    v_mfma_f32_16x16x32_bf16 v[152:155], a[140:143], v[84:87], v[152:155]
    ds_read_b128 a[96:99], v2 offset:57344
    v_cvt_pk_bf16_f32 v105, v62, v63
    v_mfma_f32_16x16x32_bf16 v[152:155], a[136:139], v[80:83], v[152:155]
    v_exp_f32 v26, v26
    v_mfma_f32_16x16x32_bf16 v[148:151], a[136:139], v[72:75], v[148:151]
    v_exp_f32 v27, v27
    v_mfma_f32_16x16x32_bf16 v[148:151], a[140:143], v[76:79], v[148:151]
    ds_read_b64_tr_b16 a[128:129], v10 offset:32768
    v_cvt_pk_bf16_f32 v112, v24, v25
    v_mfma_f32_16x16x32_bf16 v[144:147], a[140:143], v[68:71], v[144:147]
    ds_read_b64_tr_b16 a[130:131], v10 offset:36864
    v_mfma_f32_16x16x32_bf16 v[144:147], a[136:139], v[64:67], v[144:147]
    s_waitcnt lgkmcnt(3)
    v_mfma_f32_16x16x32_bf16 v[56:59], a[80:83], a[0:3], v[40:43]
    v_exp_f32 v28, v28
    v_mfma_f32_16x16x32_bf16 v[56:59], a[84:87], a[4:7], v[56:59]
    v_exp_f32 v29, v29
    v_mfma_f32_16x16x32_bf16 v[56:59], a[88:91], a[8:11], v[56:59]
    ds_read_b128 a[100:103], v3 offset:57344
    v_cvt_pk_bf16_f32 v113, v26, v27
    v_mfma_f32_16x16x32_bf16 v[56:59], a[92:95], a[12:15], v[56:59]
    v_exp_f32 v30, v30
    v_mfma_f32_16x16x32_bf16 v[60:63], a[92:95], a[28:31], v[44:47]
    v_exp_f32 v31, v31
    v_mfma_f32_16x16x32_bf16 v[60:63], a[88:91], a[24:27], v[60:63]
    ds_read_b64_tr_b16 a[132:133], v10 offset:40960
    v_cvt_pk_bf16_f32 v120, v28, v29
    v_mfma_f32_16x16x32_bf16 v[60:63], a[84:87], a[20:23], v[60:63]
    ds_read_b64_tr_b16 a[134:135], v10 offset:45056
    v_mfma_f32_16x16x32_bf16 v[60:63], a[80:83], a[16:19], v[60:63]
    buffer_load_dwordx4 v19, s[24:27], s80 offen offset:1024 lds
    v_mfma_f32_16x16x32_bf16 v[24:27], a[80:83], a[32:35], v[48:51]
    v_exp_f32 v56, v56
    v_mfma_f32_16x16x32_bf16 v[24:27], a[84:87], a[36:39], v[24:27]
    v_exp_f32 v57, v57
    v_mfma_f32_16x16x32_bf16 v[24:27], a[88:91], a[40:43], v[24:27]
    ds_read_b128 a[104:107], v4 offset:57344
    v_cvt_pk_bf16_f32 v121, v30, v31
    v_mfma_f32_16x16x32_bf16 v[24:27], a[92:95], a[44:47], v[24:27]
    v_exp_f32 v58, v58
    v_mfma_f32_16x16x32_bf16 v[28:31], a[92:95], a[60:63], v[52:55]
    v_exp_f32 v59, v59
    v_mfma_f32_16x16x32_bf16 v[28:31], a[88:91], a[56:59], v[28:31]
    ds_read_b64_tr_b16 a[136:137], v11 offset:32768
    v_cvt_pk_bf16_f32 v98, v56, v57
    v_mfma_f32_16x16x32_bf16 v[28:31], a[84:87], a[52:55], v[28:31]
    ds_read_b64_tr_b16 a[138:139], v11 offset:36864
    v_mfma_f32_16x16x32_bf16 v[28:31], a[80:83], a[48:51], v[28:31]
    s_waitcnt lgkmcnt(3)
    v_smfmac_f32_16x16x64_bf16 a[164:167], v[36:39], v[72:79], v35
    buffer_load_dword v21, v20, s[40:43], 0 offen sc1
    v_mfma_f32_16x16x32_bf16 v[160:163], a[144:147], v[64:67], v[160:163]
    v_exp_f32 v60, v60
    v_mfma_f32_16x16x32_bf16 v[160:163], a[148:151], v[68:71], v[160:163]
    v_exp_f32 v61, v61
    v_mfma_f32_16x16x32_bf16 v[164:167], a[148:151], v[76:79], v[164:167]
    ds_read_b128 a[108:111], v5 offset:57344
    v_cvt_pk_bf16_f32 v99, v58, v59
    v_mfma_f32_16x16x32_bf16 v[164:167], a[144:147], v[72:75], v[164:167]
    v_exp_f32 v62, v62
    v_mfma_f32_16x16x32_bf16 v[168:171], a[144:147], v[80:83], v[168:171]
    v_exp_f32 v63, v63
    v_mfma_f32_16x16x32_bf16 v[168:171], a[148:151], v[84:87], v[168:171]
    ds_read_b64_tr_b16 a[140:141], v11 offset:40960
    v_cvt_pk_bf16_f32 v106, v60, v61
    v_mfma_f32_16x16x32_bf16 v[172:175], a[148:151], v[92:95], v[172:175]
    ds_read_b64_tr_b16 a[142:143], v11 offset:45056
    v_mfma_f32_16x16x32_bf16 v[172:175], a[144:147], v[88:91], v[172:175]
    buffer_load_dwordx4 v18, s[24:27], s80 offen offset:2048 lds
    v_mfma_f32_16x16x32_bf16 v[188:191], a[152:155], v[88:91], v[188:191]
    v_exp_f32 v24, v24
    v_mfma_f32_16x16x32_bf16 v[188:191], a[156:159], v[92:95], v[188:191]
    v_exp_f32 v25, v25
    v_mfma_f32_16x16x32_bf16 v[184:187], a[156:159], v[84:87], v[184:187]
    ds_read_b128 a[112:115], v2 offset:61440
    v_cvt_pk_bf16_f32 v107, v62, v63
    v_mfma_f32_16x16x32_bf16 v[184:187], a[152:155], v[80:83], v[184:187]
    v_exp_f32 v26, v26
    v_mfma_f32_16x16x32_bf16 v[180:183], a[152:155], v[72:75], v[180:183]
    v_exp_f32 v27, v27
    v_mfma_f32_16x16x32_bf16 v[180:183], a[156:159], v[76:79], v[180:183]
    ds_read_b64_tr_b16 a[144:145], v12 offset:32768
    v_cvt_pk_bf16_f32 v114, v24, v25
    v_mfma_f32_16x16x32_bf16 v[176:179], a[156:159], v[68:71], v[176:179]
    ds_read_b64_tr_b16 a[146:147], v12 offset:36864
    v_mfma_f32_16x16x32_bf16 v[176:179], a[152:155], v[64:67], v[176:179]
    s_waitcnt lgkmcnt(3)
    v_mfma_f32_16x16x32_bf16 v[56:59], a[96:99], a[0:3], v[40:43]
    v_exp_f32 v28, v28
    v_mfma_f32_16x16x32_bf16 v[56:59], a[100:103], a[4:7], v[56:59]
    v_exp_f32 v29, v29
    v_mfma_f32_16x16x32_bf16 v[56:59], a[104:107], a[8:11], v[56:59]
    ds_read_b128 a[116:119], v3 offset:61440
    v_cvt_pk_bf16_f32 v115, v26, v27
    v_mfma_f32_16x16x32_bf16 v[56:59], a[108:111], a[12:15], v[56:59]
    v_exp_f32 v30, v30
    v_mfma_f32_16x16x32_bf16 v[60:63], a[108:111], a[28:31], v[44:47]
    v_exp_f32 v31, v31
    v_mfma_f32_16x16x32_bf16 v[60:63], a[104:107], a[24:27], v[60:63]
    ds_read_b64_tr_b16 a[148:149], v12 offset:40960
    v_cvt_pk_bf16_f32 v122, v28, v29
    v_mfma_f32_16x16x32_bf16 v[60:63], a[100:103], a[20:23], v[60:63]
    ds_read_b64_tr_b16 a[150:151], v12 offset:45056
    v_mfma_f32_16x16x32_bf16 v[60:63], a[96:99], a[16:19], v[60:63]
    buffer_load_dwordx4 v19, s[24:27], s80 offen offset:3072 lds
    v_mfma_f32_16x16x32_bf16 v[24:27], a[96:99], a[32:35], v[48:51]
    v_exp_f32 v56, v56
    v_mfma_f32_16x16x32_bf16 v[24:27], a[100:103], a[36:39], v[24:27]
    v_exp_f32 v57, v57
    v_mfma_f32_16x16x32_bf16 v[24:27], a[104:107], a[40:43], v[24:27]
    ds_read_b128 a[120:123], v4 offset:61440
    v_cvt_pk_bf16_f32 v123, v30, v31
    v_mfma_f32_16x16x32_bf16 v[24:27], a[108:111], a[44:47], v[24:27]
    v_exp_f32 v58, v58
    v_mfma_f32_16x16x32_bf16 v[28:31], a[108:111], a[60:63], v[52:55]
    v_exp_f32 v59, v59
    v_mfma_f32_16x16x32_bf16 v[28:31], a[104:107], a[56:59], v[28:31]
    ds_read_b64_tr_b16 a[152:153], v13 offset:32768
    v_cvt_pk_bf16_f32 v100, v56, v57
    v_mfma_f32_16x16x32_bf16 v[28:31], a[100:103], a[52:55], v[28:31]
    ds_read_b64_tr_b16 a[154:155], v13 offset:36864
    v_mfma_f32_16x16x32_bf16 v[28:31], a[96:99], a[48:51], v[28:31]
    s_waitcnt lgkmcnt(3)
    v_smfmac_f32_16x16x64_bf16 a[168:171], v[36:39], v[80:87], v35
    s_waitcnt vmcnt(9)
    s_barrier
    v_mfma_f32_16x16x32_bf16 v[192:195], a[128:131], v[64:67], v[192:195]
    s_add_u32 s80, s80, 32768
    v_exp_f32 v60, v60
    v_mfma_f32_16x16x32_bf16 v[192:195], a[132:135], v[68:71], v[192:195]
    s_mov_b32 m0, s70
    v_exp_f32 v61, v61
    v_mfma_f32_16x16x32_bf16 v[196:199], a[132:135], v[76:79], v[196:199]
    ds_read_b128 a[124:127], v5 offset:61440
    v_cvt_pk_bf16_f32 v101, v58, v59
    v_mfma_f32_16x16x32_bf16 v[196:199], a[128:131], v[72:75], v[196:199]
    v_exp_f32 v62, v62
    v_mfma_f32_16x16x32_bf16 v[200:203], a[128:131], v[80:83], v[200:203]
    v_exp_f32 v63, v63
    v_mfma_f32_16x16x32_bf16 v[200:203], a[132:135], v[84:87], v[200:203]
    ds_read_b64_tr_b16 a[156:157], v13 offset:40960
    v_cvt_pk_bf16_f32 v108, v60, v61
    v_mfma_f32_16x16x32_bf16 v[204:207], a[132:135], v[92:95], v[204:207]
    ds_read_b64_tr_b16 a[158:159], v13 offset:45056
    v_mfma_f32_16x16x32_bf16 v[204:207], a[128:131], v[88:91], v[204:207]
    buffer_load_dwordx4 v14, s[20:23], s80 offen offset:0 lds
    v_mfma_f32_16x16x32_bf16 v[220:223], a[136:139], v[88:91], v[220:223]
    v_exp_f32 v24, v24
    v_mfma_f32_16x16x32_bf16 v[220:223], a[140:143], v[92:95], v[220:223]
    v_exp_f32 v25, v25
    v_mfma_f32_16x16x32_bf16 v[216:219], a[140:143], v[84:87], v[216:219]
    ds_read_b128 a[64:67], v2 offset:0
    v_cvt_pk_bf16_f32 v109, v62, v63
    v_mfma_f32_16x16x32_bf16 v[216:219], a[136:139], v[80:83], v[216:219]
    v_exp_f32 v26, v26
    v_mfma_f32_16x16x32_bf16 v[212:215], a[136:139], v[72:75], v[212:215]
    v_exp_f32 v27, v27
    v_mfma_f32_16x16x32_bf16 v[212:215], a[140:143], v[76:79], v[212:215]
    ds_read_b64_tr_b16 a[128:129], v6 offset:49152
    v_cvt_pk_bf16_f32 v116, v24, v25
    v_mfma_f32_16x16x32_bf16 v[208:211], a[140:143], v[68:71], v[208:211]
    ds_read_b64_tr_b16 a[130:131], v6 offset:53248
    ds_read_b64_tr_b16 a[176:177], v23 offset:0
    v_mfma_f32_16x16x32_bf16 v[208:211], a[136:139], v[64:67], v[208:211]
    s_waitcnt lgkmcnt(4)
    v_mfma_f32_16x16x32_bf16 v[56:59], a[112:115], a[0:3], v[40:43]
    v_exp_f32 v28, v28
    v_mfma_f32_16x16x32_bf16 v[56:59], a[116:119], a[4:7], v[56:59]
    v_exp_f32 v29, v29
    v_mfma_f32_16x16x32_bf16 v[56:59], a[120:123], a[8:11], v[56:59]
    ds_read_b128 a[68:71], v3 offset:0
    v_cvt_pk_bf16_f32 v117, v26, v27
    v_mfma_f32_16x16x32_bf16 v[56:59], a[124:127], a[12:15], v[56:59]
    v_exp_f32 v30, v30
    v_mfma_f32_16x16x32_bf16 v[60:63], a[124:127], a[28:31], v[44:47]
    v_exp_f32 v31, v31
    v_mfma_f32_16x16x32_bf16 v[60:63], a[120:123], a[24:27], v[60:63]
    ds_read_b64_tr_b16 a[132:133], v6 offset:57344
    v_cvt_pk_bf16_f32 v124, v28, v29
    v_mfma_f32_16x16x32_bf16 v[60:63], a[116:119], a[20:23], v[60:63]
    ds_read_b64_tr_b16 a[134:135], v6 offset:61440
    ds_read_b64_tr_b16 a[178:179], v23 offset:4096
    v_mfma_f32_16x16x32_bf16 v[60:63], a[112:115], a[16:19], v[60:63]
    buffer_load_dwordx4 v15, s[20:23], s80 offen offset:1024 lds
    v_mfma_f32_16x16x32_bf16 v[24:27], a[112:115], a[32:35], v[48:51]
    v_exp_f32 v56, v56
    v_mfma_f32_16x16x32_bf16 v[24:27], a[116:119], a[36:39], v[24:27]
    v_exp_f32 v57, v57
    v_mfma_f32_16x16x32_bf16 v[24:27], a[120:123], a[40:43], v[24:27]
    ds_read_b128 a[72:75], v4 offset:0
    v_cvt_pk_bf16_f32 v125, v30, v31
    v_mfma_f32_16x16x32_bf16 v[24:27], a[124:127], a[44:47], v[24:27]
    v_exp_f32 v58, v58
    v_mfma_f32_16x16x32_bf16 v[28:31], a[124:127], a[60:63], v[52:55]
    v_exp_f32 v59, v59
    v_mfma_f32_16x16x32_bf16 v[28:31], a[120:123], a[56:59], v[28:31]
    ds_read_b64_tr_b16 a[136:137], v7 offset:49152
    v_cvt_pk_bf16_f32 v102, v56, v57
    v_mfma_f32_16x16x32_bf16 v[28:31], a[116:119], a[52:55], v[28:31]
    ds_read_b64_tr_b16 a[138:139], v7 offset:53248
    ds_read_b64_tr_b16 a[180:181], v23 offset:32
    v_mfma_f32_16x16x32_bf16 v[28:31], a[112:115], a[48:51], v[28:31]
    s_waitcnt lgkmcnt(4)
    v_smfmac_f32_16x16x64_bf16 a[172:175], v[36:39], v[88:95], v35
    v_mfma_f32_16x16x32_bf16 v[224:227], a[144:147], v[64:67], v[224:227]
    v_exp_f32 v60, v60
    v_mfma_f32_16x16x32_bf16 v[224:227], a[148:151], v[68:71], v[224:227]
    v_exp_f32 v61, v61
    v_mfma_f32_16x16x32_bf16 v[228:231], a[148:151], v[76:79], v[228:231]
    ds_read_b128 a[76:79], v5 offset:0
    v_cvt_pk_bf16_f32 v103, v58, v59
    v_mfma_f32_16x16x32_bf16 v[228:231], a[144:147], v[72:75], v[228:231]
    v_exp_f32 v62, v62
    v_mfma_f32_16x16x32_bf16 v[232:235], a[144:147], v[80:83], v[232:235]
    v_exp_f32 v63, v63
    v_mfma_f32_16x16x32_bf16 v[232:235], a[148:151], v[84:87], v[232:235]
    ds_read_b64_tr_b16 a[140:141], v7 offset:57344
    v_cvt_pk_bf16_f32 v110, v60, v61
    v_mfma_f32_16x16x32_bf16 v[236:239], a[148:151], v[92:95], v[236:239]
    ds_read_b64_tr_b16 a[142:143], v7 offset:61440
    ds_read_b64_tr_b16 a[182:183], v23 offset:4128
    v_mfma_f32_16x16x32_bf16 v[236:239], a[144:147], v[88:91], v[236:239]
    buffer_load_dwordx4 v16, s[20:23], s80 offen offset:2048 lds
    v_mfma_f32_16x16x32_bf16 v[252:255], a[152:155], v[88:91], v[252:255]
    v_exp_f32 v24, v24
    v_mfma_f32_16x16x32_bf16 v[252:255], a[156:159], v[92:95], v[252:255]
    v_exp_f32 v25, v25
    v_mfma_f32_16x16x32_bf16 v[248:251], a[156:159], v[84:87], v[248:251]
    ds_read_b128 a[80:83], v2 offset:4096
    v_cvt_pk_bf16_f32 v111, v62, v63
    v_mfma_f32_16x16x32_bf16 v[248:251], a[152:155], v[80:83], v[248:251]
    v_exp_f32 v26, v26
    v_mfma_f32_16x16x32_bf16 v[244:247], a[152:155], v[72:75], v[244:247]
    v_exp_f32 v27, v27
    v_mfma_f32_16x16x32_bf16 v[244:247], a[156:159], v[76:79], v[244:247]
    ds_read_b64_tr_b16 a[144:145], v8 offset:49152
    v_cvt_pk_bf16_f32 v118, v24, v25
    v_mfma_f32_16x16x32_bf16 v[240:243], a[156:159], v[68:71], v[240:243]
    ds_read_b64_tr_b16 a[146:147], v8 offset:53248
    v_mfma_f32_16x16x32_bf16 v[240:243], a[152:155], v[64:67], v[240:243]
    s_waitcnt lgkmcnt(3)
    v_mfma_f32_16x16x32_bf16 v[56:59], a[64:67], a[0:3], v[40:43]
    s_sub_u32 s81, s81, 1
    v_exp_f32 v28, v28
    v_mfma_f32_16x16x32_bf16 v[56:59], a[68:71], a[4:7], v[56:59]
    v_exp_f32 v29, v29
    v_mfma_f32_16x16x32_bf16 v[56:59], a[72:75], a[8:11], v[56:59]
    ds_read_b128 a[84:87], v3 offset:4096
    v_cvt_pk_bf16_f32 v119, v26, v27
    v_mfma_f32_16x16x32_bf16 v[56:59], a[76:79], a[12:15], v[56:59]
    v_exp_f32 v30, v30
    v_mfma_f32_16x16x32_bf16 v[60:63], a[76:79], a[28:31], v[44:47]
    v_exp_f32 v31, v31
    v_mfma_f32_16x16x32_bf16 v[60:63], a[72:75], a[24:27], v[60:63]
    ds_read_b64_tr_b16 a[148:149], v8 offset:57344
    v_cvt_pk_bf16_f32 v126, v28, v29
    v_mfma_f32_16x16x32_bf16 v[60:63], a[68:71], a[20:23], v[60:63]
    ds_read_b64_tr_b16 a[150:151], v8 offset:61440
    v_mfma_f32_16x16x32_bf16 v[60:63], a[64:67], a[16:19], v[60:63]
    buffer_load_dwordx4 v17, s[20:23], s80 offen offset:3072 lds
    v_mfma_f32_16x16x32_bf16 v[24:27], a[64:67], a[32:35], v[48:51]
    s_cmp_eq_u32 s54, 0
    v_exp_f32 v56, v56
    v_mfma_f32_16x16x32_bf16 v[24:27], a[68:71], a[36:39], v[24:27]
    v_exp_f32 v57, v57
    v_mfma_f32_16x16x32_bf16 v[24:27], a[72:75], a[40:43], v[24:27]
    ds_read_b128 a[88:91], v4 offset:4096
    v_cvt_pk_bf16_f32 v127, v30, v31
    v_mfma_f32_16x16x32_bf16 v[24:27], a[76:79], a[44:47], v[24:27]
    v_exp_f32 v58, v58
    v_mfma_f32_16x16x32_bf16 v[28:31], a[76:79], a[60:63], v[52:55]
    v_exp_f32 v59, v59
    v_mfma_f32_16x16x32_bf16 v[28:31], a[72:75], a[56:59], v[28:31]
    ds_read_b64_tr_b16 a[152:153], v9 offset:49152
    v_cvt_pk_bf16_f32 v64, v56, v57
    v_mfma_f32_16x16x32_bf16 v[28:31], a[68:71], a[52:55], v[28:31]
    ds_read_b64_tr_b16 a[154:155], v9 offset:53248
    v_mfma_f32_16x16x32_bf16 v[28:31], a[64:67], a[48:51], v[28:31]
    s_waitcnt lgkmcnt(3)
    v_smfmac_f32_16x16x64_bf16 a[160:163], v[36:39], v[96:103], v35
    s_cbranch_scc1 M_nost2
    buffer_store_dwordx4 a[176:179], v1, s[52:55], s85 offen offset:0 sc1
M_nost2:
    v_mfma_f32_16x16x32_bf16 v[128:131], a[128:131], v[96:99], v[128:131]
    s_sub_u32 s80, s80, 16384
    v_exp_f32 v60, v60
    v_mfma_f32_16x16x32_bf16 v[128:131], a[132:135], v[100:103], v[128:131]
    s_mov_b32 m0, s73
    v_exp_f32 v61, v61
    v_mfma_f32_16x16x32_bf16 v[132:135], a[132:135], v[108:111], v[132:135]
    ds_read_b128 a[92:95], v5 offset:4096
    v_cvt_pk_bf16_f32 v65, v58, v59
    v_mfma_f32_16x16x32_bf16 v[132:135], a[128:131], v[104:107], v[132:135]
    v_exp_f32 v62, v62
    v_mfma_f32_16x16x32_bf16 v[136:139], a[128:131], v[112:115], v[136:139]
    v_exp_f32 v63, v63
    v_mfma_f32_16x16x32_bf16 v[136:139], a[132:135], v[116:119], v[136:139]
    ds_read_b64_tr_b16 a[156:157], v9 offset:57344
    v_cvt_pk_bf16_f32 v72, v60, v61
    v_mfma_f32_16x16x32_bf16 v[140:143], a[132:135], v[124:127], v[140:143]
    ds_read_b64_tr_b16 a[158:159], v9 offset:61440
    v_mfma_f32_16x16x32_bf16 v[140:143], a[128:131], v[120:123], v[140:143]
    buffer_load_dwordx4 v18, s[24:27], s80 offen offset:0 lds
    v_mfma_f32_16x16x32_bf16 v[156:159], a[136:139], v[120:123], v[156:159]
    v_exp_f32 v24, v24
    v_mfma_f32_16x16x32_bf16 v[156:159], a[140:143], v[124:127], v[156:159]
    v_exp_f32 v25, v25
    v_mfma_f32_16x16x32_bf16 v[152:155], a[140:143], v[116:119], v[152:155]
    ds_read_b128 a[96:99], v2 offset:8192
    v_cvt_pk_bf16_f32 v73, v62, v63
    v_mfma_f32_16x16x32_bf16 v[152:155], a[136:139], v[112:115], v[152:155]
    v_exp_f32 v26, v26
    v_mfma_f32_16x16x32_bf16 v[148:151], a[136:139], v[104:107], v[148:151]
    v_exp_f32 v27, v27
    v_mfma_f32_16x16x32_bf16 v[148:151], a[140:143], v[108:111], v[148:151]
    ds_read_b64_tr_b16 a[128:129], v10 offset:49152
    v_cvt_pk_bf16_f32 v80, v24, v25
    v_mfma_f32_16x16x32_bf16 v[144:147], a[140:143], v[100:103], v[144:147]
    ds_read_b64_tr_b16 a[130:131], v10 offset:53248
    v_mfma_f32_16x16x32_bf16 v[144:147], a[136:139], v[96:99], v[144:147]
    s_waitcnt lgkmcnt(3)
    v_mfma_f32_16x16x32_bf16 v[56:59], a[80:83], a[0:3], v[40:43]
    v_exp_f32 v28, v28
    v_mfma_f32_16x16x32_bf16 v[56:59], a[84:87], a[4:7], v[56:59]
    v_exp_f32 v29, v29
    v_mfma_f32_16x16x32_bf16 v[56:59], a[88:91], a[8:11], v[56:59]
    ds_read_b128 a[100:103], v3 offset:8192
    v_cvt_pk_bf16_f32 v81, v26, v27
    v_mfma_f32_16x16x32_bf16 v[56:59], a[92:95], a[12:15], v[56:59]
    v_exp_f32 v30, v30
    v_mfma_f32_16x16x32_bf16 v[60:63], a[92:95], a[28:31], v[44:47]
    v_exp_f32 v31, v31
    v_mfma_f32_16x16x32_bf16 v[60:63], a[88:91], a[24:27], v[60:63]
    ds_read_b64_tr_b16 a[132:133], v10 offset:57344
    v_cvt_pk_bf16_f32 v88, v28, v29
    v_mfma_f32_16x16x32_bf16 v[60:63], a[84:87], a[20:23], v[60:63]
    ds_read_b64_tr_b16 a[134:135], v10 offset:61440
    v_mfma_f32_16x16x32_bf16 v[60:63], a[80:83], a[16:19], v[60:63]
    buffer_load_dwordx4 v19, s[24:27], s80 offen offset:1024 lds
    v_mfma_f32_16x16x32_bf16 v[24:27], a[80:83], a[32:35], v[48:51]
    s_cmp_eq_u32 s54, 0
    v_exp_f32 v56, v56
    v_mfma_f32_16x16x32_bf16 v[24:27], a[84:87], a[36:39], v[24:27]
    v_exp_f32 v57, v57
    v_mfma_f32_16x16x32_bf16 v[24:27], a[88:91], a[40:43], v[24:27]
    ds_read_b128 a[104:107], v4 offset:8192
    v_cvt_pk_bf16_f32 v89, v30, v31
    v_mfma_f32_16x16x32_bf16 v[24:27], a[92:95], a[44:47], v[24:27]
    v_exp_f32 v58, v58
    v_mfma_f32_16x16x32_bf16 v[28:31], a[92:95], a[60:63], v[52:55]
    v_exp_f32 v59, v59
    v_mfma_f32_16x16x32_bf16 v[28:31], a[88:91], a[56:59], v[28:31]
    ds_read_b64_tr_b16 a[136:137], v11 offset:49152
    v_cvt_pk_bf16_f32 v66, v56, v57
    v_mfma_f32_16x16x32_bf16 v[28:31], a[84:87], a[52:55], v[28:31]
    ds_read_b64_tr_b16 a[138:139], v11 offset:53248
    v_mfma_f32_16x16x32_bf16 v[28:31], a[80:83], a[48:51], v[28:31]
    s_waitcnt lgkmcnt(3)
    v_smfmac_f32_16x16x64_bf16 a[164:167], v[36:39], v[104:111], v35
    s_cbranch_scc1 M_nost6
    buffer_store_dwordx4 a[180:183], v1, s[52:55], s85 offen offset:2048 sc1
M_nost6:
    v_mfma_f32_16x16x32_bf16 v[160:163], a[144:147], v[96:99], v[160:163]
    v_exp_f32 v60, v60
    v_mfma_f32_16x16x32_bf16 v[160:163], a[148:151], v[100:103], v[160:163]
    v_exp_f32 v61, v61
    v_mfma_f32_16x16x32_bf16 v[164:167], a[148:151], v[108:111], v[164:167]
    ds_read_b128 a[108:111], v5 offset:8192
    v_cvt_pk_bf16_f32 v67, v58, v59
    v_mfma_f32_16x16x32_bf16 v[164:167], a[144:147], v[104:107], v[164:167]
    v_exp_f32 v62, v62
    v_mfma_f32_16x16x32_bf16 v[168:171], a[144:147], v[112:115], v[168:171]
    v_exp_f32 v63, v63
    v_mfma_f32_16x16x32_bf16 v[168:171], a[148:151], v[116:119], v[168:171]
    ds_read_b64_tr_b16 a[140:141], v11 offset:57344
    v_cvt_pk_bf16_f32 v74, v60, v61
    v_mfma_f32_16x16x32_bf16 v[172:175], a[148:151], v[124:127], v[172:175]
    ds_read_b64_tr_b16 a[142:143], v11 offset:61440
    v_mfma_f32_16x16x32_bf16 v[172:175], a[144:147], v[120:123], v[172:175]
    buffer_load_dwordx4 v18, s[24:27], s80 offen offset:2048 lds
    v_mfma_f32_16x16x32_bf16 v[188:191], a[152:155], v[120:123], v[188:191]
    s_cmp_gt_u32 s81, 4
    v_exp_f32 v24, v24
    v_mfma_f32_16x16x32_bf16 v[188:191], a[156:159], v[124:127], v[188:191]
    s_cselect_b32 s54, s54, 0
    v_exp_f32 v25, v25
    v_mfma_f32_16x16x32_bf16 v[184:187], a[156:159], v[116:119], v[184:187]
    s_add_u32 s36, s36, 1
    ds_read_b128 a[112:115], v2 offset:12288
    v_cvt_pk_bf16_f32 v75, v62, v63
    v_mfma_f32_16x16x32_bf16 v[184:187], a[152:155], v[112:115], v[184:187]
    v_exp_f32 v26, v26
    v_mfma_f32_16x16x32_bf16 v[180:183], a[152:155], v[104:107], v[180:183]
    v_exp_f32 v27, v27
    v_mfma_f32_16x16x32_bf16 v[180:183], a[156:159], v[108:111], v[180:183]
    ds_read_b64_tr_b16 a[144:145], v12 offset:49152
    v_cvt_pk_bf16_f32 v82, v24, v25
    v_mfma_f32_16x16x32_bf16 v[176:179], a[156:159], v[100:103], v[176:179]
    ds_read_b64_tr_b16 a[146:147], v12 offset:53248
    v_mfma_f32_16x16x32_bf16 v[176:179], a[152:155], v[96:99], v[176:179]
    s_waitcnt lgkmcnt(3)
    v_mfma_f32_16x16x32_bf16 v[56:59], a[96:99], a[0:3], v[40:43]
    v_exp_f32 v28, v28
    v_mfma_f32_16x16x32_bf16 v[56:59], a[100:103], a[4:7], v[56:59]
    v_exp_f32 v29, v29
    v_mfma_f32_16x16x32_bf16 v[56:59], a[104:107], a[8:11], v[56:59]
    ds_read_b128 a[116:119], v3 offset:12288
    v_cvt_pk_bf16_f32 v83, v26, v27
    v_mfma_f32_16x16x32_bf16 v[56:59], a[108:111], a[12:15], v[56:59]
    v_exp_f32 v30, v30
    v_mfma_f32_16x16x32_bf16 v[60:63], a[108:111], a[28:31], v[44:47]
    v_exp_f32 v31, v31
    v_mfma_f32_16x16x32_bf16 v[60:63], a[104:107], a[24:27], v[60:63]
    ds_read_b64_tr_b16 a[148:149], v12 offset:57344
    v_cvt_pk_bf16_f32 v90, v28, v29
    v_mfma_f32_16x16x32_bf16 v[60:63], a[100:103], a[20:23], v[60:63]
    ds_read_b64_tr_b16 a[150:151], v12 offset:61440
    v_mfma_f32_16x16x32_bf16 v[60:63], a[96:99], a[16:19], v[60:63]
    buffer_load_dwordx4 v19, s[24:27], s80 offen offset:3072 lds
    v_mfma_f32_16x16x32_bf16 v[24:27], a[96:99], a[32:35], v[48:51]
    v_exp_f32 v56, v56
    v_mfma_f32_16x16x32_bf16 v[24:27], a[100:103], a[36:39], v[24:27]
    v_exp_f32 v57, v57
    v_mfma_f32_16x16x32_bf16 v[24:27], a[104:107], a[40:43], v[24:27]
    ds_read_b128 a[120:123], v4 offset:12288
    v_cvt_pk_bf16_f32 v91, v30, v31
    v_mfma_f32_16x16x32_bf16 v[24:27], a[108:111], a[44:47], v[24:27]
    v_exp_f32 v58, v58
    v_mfma_f32_16x16x32_bf16 v[28:31], a[108:111], a[60:63], v[52:55]
    v_exp_f32 v59, v59
    v_mfma_f32_16x16x32_bf16 v[28:31], a[104:107], a[56:59], v[28:31]
    ds_read_b64_tr_b16 a[152:153], v13 offset:49152
    v_cvt_pk_bf16_f32 v68, v56, v57
    v_mfma_f32_16x16x32_bf16 v[28:31], a[100:103], a[52:55], v[28:31]
    ds_read_b64_tr_b16 a[154:155], v13 offset:53248
    v_mfma_f32_16x16x32_bf16 v[28:31], a[96:99], a[48:51], v[28:31]
    s_waitcnt lgkmcnt(3)
    v_smfmac_f32_16x16x64_bf16 a[168:171], v[36:39], v[112:119], v35
    s_waitcnt vmcnt(8)
    s_barrier
    v_mfma_f32_16x16x32_bf16 v[192:195], a[128:131], v[96:99], v[192:195]
    s_add_u32 s80, s80, 32768
    v_exp_f32 v60, v60
    v_mfma_f32_16x16x32_bf16 v[192:195], a[132:135], v[100:103], v[192:195]
    s_mov_b32 m0, s71
    v_exp_f32 v61, v61
    v_mfma_f32_16x16x32_bf16 v[196:199], a[132:135], v[108:111], v[196:199]
    ds_read_b128 a[124:127], v5 offset:12288
    v_cvt_pk_bf16_f32 v69, v58, v59
    v_mfma_f32_16x16x32_bf16 v[196:199], a[128:131], v[104:107], v[196:199]
    v_exp_f32 v62, v62
    v_mfma_f32_16x16x32_bf16 v[200:203], a[128:131], v[112:115], v[200:203]
    v_exp_f32 v63, v63
    v_mfma_f32_16x16x32_bf16 v[200:203], a[132:135], v[116:119], v[200:203]
    ds_read_b64_tr_b16 a[156:157], v13 offset:57344
    v_cvt_pk_bf16_f32 v76, v60, v61
    v_mfma_f32_16x16x32_bf16 v[204:207], a[132:135], v[124:127], v[204:207]
    ds_read_b64_tr_b16 a[158:159], v13 offset:61440
    v_mfma_f32_16x16x32_bf16 v[204:207], a[128:131], v[120:123], v[204:207]
    buffer_load_dwordx4 v14, s[20:23], s80 offen offset:0 lds
    v_mfma_f32_16x16x32_bf16 v[220:223], a[136:139], v[120:123], v[220:223]
    s_mul_i32 s3, s36, 52429
    v_exp_f32 v24, v24
    v_mfma_f32_16x16x32_bf16 v[220:223], a[140:143], v[124:127], v[220:223]
    s_lshr_b32 s3, s3, 18
    v_exp_f32 v25, v25
    v_mfma_f32_16x16x32_bf16 v[216:219], a[140:143], v[116:119], v[216:219]
    s_mul_i32 s83, s3, 39680
    ds_read_b128 a[64:67], v2 offset:16384
    v_cvt_pk_bf16_f32 v77, v62, v63
    v_mfma_f32_16x16x32_bf16 v[216:219], a[136:139], v[112:115], v[216:219]
    s_lshl_b32 s4, s36, 8
    v_exp_f32 v26, v26
    v_mfma_f32_16x16x32_bf16 v[212:215], a[136:139], v[104:107], v[212:215]
    s_add_u32 s83, s83, s4
    v_exp_f32 v27, v27
    v_mfma_f32_16x16x32_bf16 v[212:215], a[140:143], v[108:111], v[212:215]
    s_add_u32 s84, s83, 4096
    ds_read_b64_tr_b16 a[128:129], v6 offset:0
    v_cvt_pk_bf16_f32 v84, v24, v25
    v_mfma_f32_16x16x32_bf16 v[208:211], a[140:143], v[100:103], v[208:211]
    s_lshl_b32 s85, s36, 14
    ds_read_b64_tr_b16 a[130:131], v6 offset:4096
    v_mfma_f32_16x16x32_bf16 v[208:211], a[136:139], v[96:99], v[208:211]
    s_waitcnt lgkmcnt(3)
    v_mfma_f32_16x16x32_bf16 v[56:59], a[112:115], a[0:3], v[40:43]
    v_exp_f32 v28, v28
    v_mfma_f32_16x16x32_bf16 v[56:59], a[116:119], a[4:7], v[56:59]
    v_exp_f32 v29, v29
    v_mfma_f32_16x16x32_bf16 v[56:59], a[120:123], a[8:11], v[56:59]
    ds_read_b128 a[68:71], v3 offset:16384
    v_cvt_pk_bf16_f32 v85, v26, v27
    v_mfma_f32_16x16x32_bf16 v[56:59], a[124:127], a[12:15], v[56:59]
    v_exp_f32 v30, v30
    v_mfma_f32_16x16x32_bf16 v[60:63], a[124:127], a[28:31], v[44:47]
    v_exp_f32 v31, v31
    v_mfma_f32_16x16x32_bf16 v[60:63], a[120:123], a[24:27], v[60:63]
    ds_read_b64_tr_b16 a[132:133], v6 offset:8192
    v_cvt_pk_bf16_f32 v92, v28, v29
    v_mfma_f32_16x16x32_bf16 v[60:63], a[116:119], a[20:23], v[60:63]
    ds_read_b64_tr_b16 a[134:135], v6 offset:12288
    v_mfma_f32_16x16x32_bf16 v[60:63], a[112:115], a[16:19], v[60:63]
    buffer_load_dwordx4 v15, s[20:23], s80 offen offset:1024 lds
    v_mfma_f32_16x16x32_bf16 v[24:27], a[112:115], a[32:35], v[48:51]
    s_mul_i32 s4, s3, 40960
    v_exp_f32 v56, v56
    v_mfma_f32_16x16x32_bf16 v[24:27], a[116:119], a[36:39], v[24:27]
    s_sub_u32 s85, s85, s4
    v_exp_f32 v57, v57
    v_mfma_f32_16x16x32_bf16 v[24:27], a[120:123], a[40:43], v[24:27]
    s_and_b32 s3, s3, 1
    ds_read_b128 a[72:75], v4 offset:16384
    v_cvt_pk_bf16_f32 v93, v30, v31
    v_mfma_f32_16x16x32_bf16 v[24:27], a[124:127], a[44:47], v[24:27]
    s_mul_i32 s3, s3, 39936
    v_exp_f32 v58, v58
    v_mfma_f32_16x16x32_bf16 v[28:31], a[124:127], a[60:63], v[52:55]
    s_sub_u32 s85, s85, s3
    v_exp_f32 v59, v59
    v_mfma_f32_16x16x32_bf16 v[28:31], a[120:123], a[56:59], v[28:31]
    s_add_u32 s85, s85, s79
    ds_read_b64_tr_b16 a[136:137], v7 offset:0
    v_cvt_pk_bf16_f32 v70, v56, v57
    v_mfma_f32_16x16x32_bf16 v[28:31], a[116:119], a[52:55], v[28:31]
    ds_read_b64_tr_b16 a[138:139], v7 offset:4096
    v_mfma_f32_16x16x32_bf16 v[28:31], a[112:115], a[48:51], v[28:31]
    s_waitcnt lgkmcnt(3)
    v_smfmac_f32_16x16x64_bf16 a[172:175], v[36:39], v[120:127], v35
    v_mfma_f32_16x16x32_bf16 v[224:227], a[144:147], v[96:99], v[224:227]
    v_exp_f32 v60, v60
    v_mfma_f32_16x16x32_bf16 v[224:227], a[148:151], v[100:103], v[224:227]
    v_exp_f32 v61, v61
    v_mfma_f32_16x16x32_bf16 v[228:231], a[148:151], v[108:111], v[228:231]
    ds_read_b128 a[76:79], v5 offset:16384
    v_cvt_pk_bf16_f32 v71, v58, v59
    v_mfma_f32_16x16x32_bf16 v[228:231], a[144:147], v[104:107], v[228:231]
    v_exp_f32 v62, v62
    v_mfma_f32_16x16x32_bf16 v[232:235], a[144:147], v[112:115], v[232:235]
    v_exp_f32 v63, v63
    v_mfma_f32_16x16x32_bf16 v[232:235], a[148:151], v[116:119], v[232:235]
    ds_read_b64_tr_b16 a[140:141], v7 offset:8192
    v_cvt_pk_bf16_f32 v78, v60, v61
    v_mfma_f32_16x16x32_bf16 v[236:239], a[148:151], v[124:127], v[236:239]
    ds_read_b64_tr_b16 a[142:143], v7 offset:12288
    v_mfma_f32_16x16x32_bf16 v[236:239], a[144:147], v[120:123], v[236:239]
    buffer_load_dwordx4 v16, s[20:23], s80 offen offset:2048 lds
    v_mfma_f32_16x16x32_bf16 v[252:255], a[152:155], v[120:123], v[252:255]
    v_exp_f32 v24, v24
    v_mfma_f32_16x16x32_bf16 v[252:255], a[156:159], v[124:127], v[252:255]
    v_exp_f32 v25, v25
    v_mfma_f32_16x16x32_bf16 v[248:251], a[156:159], v[116:119], v[248:251]
    ds_read_b128 a[80:83], v2 offset:20480
    v_cvt_pk_bf16_f32 v79, v62, v63
    v_mfma_f32_16x16x32_bf16 v[248:251], a[152:155], v[112:115], v[248:251]
    v_exp_f32 v26, v26
    v_mfma_f32_16x16x32_bf16 v[244:247], a[152:155], v[104:107], v[244:247]
    v_exp_f32 v27, v27
    v_mfma_f32_16x16x32_bf16 v[244:247], a[156:159], v[108:111], v[244:247]
    ds_read_b64_tr_b16 a[144:145], v8 offset:0
    v_cvt_pk_bf16_f32 v86, v24, v25
    v_mfma_f32_16x16x32_bf16 v[240:243], a[156:159], v[100:103], v[240:243]
    ds_read_b64_tr_b16 a[146:147], v8 offset:4096
    v_mfma_f32_16x16x32_bf16 v[240:243], a[152:155], v[96:99], v[240:243]
    s_waitcnt lgkmcnt(3)
    v_mfma_f32_16x16x32_bf16 v[56:59], a[64:67], a[0:3], v[40:43]
    v_exp_f32 v28, v28
    v_mfma_f32_16x16x32_bf16 v[56:59], a[68:71], a[4:7], v[56:59]
    v_exp_f32 v29, v29
    v_mfma_f32_16x16x32_bf16 v[56:59], a[72:75], a[8:11], v[56:59]
    ds_read_b128 a[84:87], v3 offset:20480
    v_cvt_pk_bf16_f32 v87, v26, v27
    v_mfma_f32_16x16x32_bf16 v[56:59], a[76:79], a[12:15], v[56:59]
    v_exp_f32 v30, v30
    v_mfma_f32_16x16x32_bf16 v[60:63], a[76:79], a[28:31], v[44:47]
    v_exp_f32 v31, v31
    v_mfma_f32_16x16x32_bf16 v[60:63], a[72:75], a[24:27], v[60:63]
    ds_read_b64_tr_b16 a[148:149], v8 offset:8192
    v_cvt_pk_bf16_f32 v94, v28, v29
    v_mfma_f32_16x16x32_bf16 v[60:63], a[68:71], a[20:23], v[60:63]
    ds_read_b64_tr_b16 a[150:151], v8 offset:12288
    v_mfma_f32_16x16x32_bf16 v[60:63], a[64:67], a[16:19], v[60:63]
    buffer_load_dwordx4 v17, s[20:23], s80 offen offset:3072 lds
    v_mfma_f32_16x16x32_bf16 v[24:27], a[64:67], a[32:35], v[48:51]
    s_mov_b32 m0, s86
    v_exp_f32 v56, v56
    v_mfma_f32_16x16x32_bf16 v[24:27], a[68:71], a[36:39], v[24:27]
    v_exp_f32 v57, v57
    v_mfma_f32_16x16x32_bf16 v[24:27], a[72:75], a[40:43], v[24:27]
    ds_read_b128 a[88:91], v4 offset:20480
    v_cvt_pk_bf16_f32 v95, v30, v31
    v_mfma_f32_16x16x32_bf16 v[24:27], a[76:79], a[44:47], v[24:27]
    v_exp_f32 v58, v58
    v_mfma_f32_16x16x32_bf16 v[28:31], a[76:79], a[60:63], v[52:55]
    v_exp_f32 v59, v59
    v_mfma_f32_16x16x32_bf16 v[28:31], a[72:75], a[56:59], v[28:31]
    ds_read_b64_tr_b16 a[152:153], v9 offset:0
    v_cvt_pk_bf16_f32 v96, v56, v57
    v_mfma_f32_16x16x32_bf16 v[28:31], a[68:71], a[52:55], v[28:31]
    ds_read_b64_tr_b16 a[154:155], v9 offset:4096
    v_mfma_f32_16x16x32_bf16 v[28:31], a[64:67], a[48:51], v[28:31]
    s_waitcnt lgkmcnt(3)
    buffer_load_dwordx4 v22, s[44:47], s83 offen lds
    v_smfmac_f32_16x16x64_bf16 a[160:163], v[36:39], v[64:71], v35
    v_mfma_f32_16x16x32_bf16 v[128:131], a[128:131], v[64:67], v[128:131]
    s_sub_u32 s80, s80, 16384
    v_exp_f32 v60, v60
    v_mfma_f32_16x16x32_bf16 v[128:131], a[132:135], v[68:71], v[128:131]
    s_mov_b32 m0, s74
    v_exp_f32 v61, v61
    v_mfma_f32_16x16x32_bf16 v[132:135], a[132:135], v[76:79], v[132:135]
    ds_read_b128 a[92:95], v5 offset:20480
    v_cvt_pk_bf16_f32 v97, v58, v59
    v_mfma_f32_16x16x32_bf16 v[132:135], a[128:131], v[72:75], v[132:135]
    v_exp_f32 v62, v62
    v_mfma_f32_16x16x32_bf16 v[136:139], a[128:131], v[80:83], v[136:139]
    v_exp_f32 v63, v63
    v_mfma_f32_16x16x32_bf16 v[136:139], a[132:135], v[84:87], v[136:139]
    ds_read_b64_tr_b16 a[156:157], v9 offset:8192
    v_cvt_pk_bf16_f32 v104, v60, v61
    v_mfma_f32_16x16x32_bf16 v[140:143], a[132:135], v[92:95], v[140:143]
    ds_read_b64_tr_b16 a[158:159], v9 offset:12288
    v_mfma_f32_16x16x32_bf16 v[140:143], a[128:131], v[88:91], v[140:143]
    buffer_load_dwordx4 v18, s[24:27], s80 offen offset:0 lds
    v_mfma_f32_16x16x32_bf16 v[156:159], a[136:139], v[88:91], v[156:159]
    v_exp_f32 v24, v24
    v_mfma_f32_16x16x32_bf16 v[156:159], a[140:143], v[92:95], v[156:159]
    v_exp_f32 v25, v25
    v_mfma_f32_16x16x32_bf16 v[152:155], a[140:143], v[84:87], v[152:155]
    ds_read_b128 a[96:99], v2 offset:24576
    v_cvt_pk_bf16_f32 v105, v62, v63
    v_mfma_f32_16x16x32_bf16 v[152:155], a[136:139], v[80:83], v[152:155]
    v_exp_f32 v26, v26
    v_mfma_f32_16x16x32_bf16 v[148:151], a[136:139], v[72:75], v[148:151]
    v_exp_f32 v27, v27
    v_mfma_f32_16x16x32_bf16 v[148:151], a[140:143], v[76:79], v[148:151]
    ds_read_b64_tr_b16 a[128:129], v10 offset:0
    v_cvt_pk_bf16_f32 v112, v24, v25
    v_mfma_f32_16x16x32_bf16 v[144:147], a[140:143], v[68:71], v[144:147]
    ds_read_b64_tr_b16 a[130:131], v10 offset:4096
    v_mfma_f32_16x16x32_bf16 v[144:147], a[136:139], v[64:67], v[144:147]
    s_waitcnt lgkmcnt(3)
    v_mfma_f32_16x16x32_bf16 v[56:59], a[80:83], a[0:3], v[40:43]
    v_exp_f32 v28, v28
    v_mfma_f32_16x16x32_bf16 v[56:59], a[84:87], a[4:7], v[56:59]
    v_exp_f32 v29, v29
    v_mfma_f32_16x16x32_bf16 v[56:59], a[88:91], a[8:11], v[56:59]
    ds_read_b128 a[100:103], v3 offset:24576
    v_cvt_pk_bf16_f32 v113, v26, v27
    v_mfma_f32_16x16x32_bf16 v[56:59], a[92:95], a[12:15], v[56:59]
    v_exp_f32 v30, v30
    v_mfma_f32_16x16x32_bf16 v[60:63], a[92:95], a[28:31], v[44:47]
    v_exp_f32 v31, v31
    v_mfma_f32_16x16x32_bf16 v[60:63], a[88:91], a[24:27], v[60:63]
    ds_read_b64_tr_b16 a[132:133], v10 offset:8192
    v_cvt_pk_bf16_f32 v120, v28, v29
    v_mfma_f32_16x16x32_bf16 v[60:63], a[84:87], a[20:23], v[60:63]
    ds_read_b64_tr_b16 a[134:135], v10 offset:12288
    v_mfma_f32_16x16x32_bf16 v[60:63], a[80:83], a[16:19], v[60:63]
    buffer_load_dwordx4 v19, s[24:27], s80 offen offset:1024 lds
    v_mfma_f32_16x16x32_bf16 v[24:27], a[80:83], a[32:35], v[48:51]
    v_exp_f32 v56, v56
    v_mfma_f32_16x16x32_bf16 v[24:27], a[84:87], a[36:39], v[24:27]
    v_exp_f32 v57, v57
    v_mfma_f32_16x16x32_bf16 v[24:27], a[88:91], a[40:43], v[24:27]
    ds_read_b128 a[104:107], v4 offset:24576
    v_cvt_pk_bf16_f32 v121, v30, v31
    v_mfma_f32_16x16x32_bf16 v[24:27], a[92:95], a[44:47], v[24:27]
    v_exp_f32 v58, v58
    v_mfma_f32_16x16x32_bf16 v[28:31], a[92:95], a[60:63], v[52:55]
    v_exp_f32 v59, v59
    v_mfma_f32_16x16x32_bf16 v[28:31], a[88:91], a[56:59], v[28:31]
    ds_read_b64_tr_b16 a[136:137], v11 offset:0
    v_cvt_pk_bf16_f32 v98, v56, v57
    v_mfma_f32_16x16x32_bf16 v[28:31], a[84:87], a[52:55], v[28:31]
    ds_read_b64_tr_b16 a[138:139], v11 offset:4096
    v_mfma_f32_16x16x32_bf16 v[28:31], a[80:83], a[48:51], v[28:31]
    s_waitcnt lgkmcnt(3)
    v_smfmac_f32_16x16x64_bf16 a[164:167], v[36:39], v[72:79], v35
    v_mfma_f32_16x16x32_bf16 v[160:163], a[144:147], v[64:67], v[160:163]
    v_exp_f32 v60, v60
    v_mfma_f32_16x16x32_bf16 v[160:163], a[148:151], v[68:71], v[160:163]
    v_exp_f32 v61, v61
    v_mfma_f32_16x16x32_bf16 v[164:167], a[148:151], v[76:79], v[164:167]
    ds_read_b128 a[108:111], v5 offset:24576
    v_cvt_pk_bf16_f32 v99, v58, v59
    v_mfma_f32_16x16x32_bf16 v[164:167], a[144:147], v[72:75], v[164:167]
    v_exp_f32 v62, v62
    v_mfma_f32_16x16x32_bf16 v[168:171], a[144:147], v[80:83], v[168:171]
    v_exp_f32 v63, v63
    v_mfma_f32_16x16x32_bf16 v[168:171], a[148:151], v[84:87], v[168:171]
    ds_read_b64_tr_b16 a[140:141], v11 offset:8192
    v_cvt_pk_bf16_f32 v106, v60, v61
    v_mfma_f32_16x16x32_bf16 v[172:175], a[148:151], v[92:95], v[172:175]
    ds_read_b64_tr_b16 a[142:143], v11 offset:12288
    v_mfma_f32_16x16x32_bf16 v[172:175], a[144:147], v[88:91], v[172:175]
    buffer_load_dwordx4 v18, s[24:27], s80 offen offset:2048 lds
    v_mfma_f32_16x16x32_bf16 v[188:191], a[152:155], v[88:91], v[188:191]
    v_exp_f32 v24, v24
    v_mfma_f32_16x16x32_bf16 v[188:191], a[156:159], v[92:95], v[188:191]
    v_exp_f32 v25, v25
    v_mfma_f32_16x16x32_bf16 v[184:187], a[156:159], v[84:87], v[184:187]
    ds_read_b128 a[112:115], v2 offset:28672
    v_cvt_pk_bf16_f32 v107, v62, v63
    v_mfma_f32_16x16x32_bf16 v[184:187], a[152:155], v[80:83], v[184:187]
    v_exp_f32 v26, v26
    v_mfma_f32_16x16x32_bf16 v[180:183], a[152:155], v[72:75], v[180:183]
    v_exp_f32 v27, v27
    v_mfma_f32_16x16x32_bf16 v[180:183], a[156:159], v[76:79], v[180:183]
    ds_read_b64_tr_b16 a[144:145], v12 offset:0
    v_cvt_pk_bf16_f32 v114, v24, v25
    v_mfma_f32_16x16x32_bf16 v[176:179], a[156:159], v[68:71], v[176:179]
    ds_read_b64_tr_b16 a[146:147], v12 offset:4096
    v_mfma_f32_16x16x32_bf16 v[176:179], a[152:155], v[64:67], v[176:179]
    s_waitcnt lgkmcnt(3)
    v_mfma_f32_16x16x32_bf16 v[56:59], a[96:99], a[0:3], v[40:43]
    v_exp_f32 v28, v28
    v_mfma_f32_16x16x32_bf16 v[56:59], a[100:103], a[4:7], v[56:59]
    v_exp_f32 v29, v29
    v_mfma_f32_16x16x32_bf16 v[56:59], a[104:107], a[8:11], v[56:59]
    ds_read_b128 a[116:119], v3 offset:28672
    v_cvt_pk_bf16_f32 v115, v26, v27
    v_mfma_f32_16x16x32_bf16 v[56:59], a[108:111], a[12:15], v[56:59]
    v_exp_f32 v30, v30
    v_mfma_f32_16x16x32_bf16 v[60:63], a[108:111], a[28:31], v[44:47]
    v_exp_f32 v31, v31
    v_mfma_f32_16x16x32_bf16 v[60:63], a[104:107], a[24:27], v[60:63]
    ds_read_b64_tr_b16 a[148:149], v12 offset:8192
    v_cvt_pk_bf16_f32 v122, v28, v29
    v_mfma_f32_16x16x32_bf16 v[60:63], a[100:103], a[20:23], v[60:63]
    ds_read_b64_tr_b16 a[150:151], v12 offset:12288
    v_mfma_f32_16x16x32_bf16 v[60:63], a[96:99], a[16:19], v[60:63]
    buffer_load_dwordx4 v19, s[24:27], s80 offen offset:3072 lds
    v_mfma_f32_16x16x32_bf16 v[24:27], a[96:99], a[32:35], v[48:51]
    s_mov_b32 m0, s86
    v_exp_f32 v56, v56
    v_mfma_f32_16x16x32_bf16 v[24:27], a[100:103], a[36:39], v[24:27]
    v_exp_f32 v57, v57
    v_mfma_f32_16x16x32_bf16 v[24:27], a[104:107], a[40:43], v[24:27]
    ds_read_b128 a[120:123], v4 offset:28672
    v_cvt_pk_bf16_f32 v123, v30, v31
    v_mfma_f32_16x16x32_bf16 v[24:27], a[108:111], a[44:47], v[24:27]
    v_exp_f32 v58, v58
    v_mfma_f32_16x16x32_bf16 v[28:31], a[108:111], a[60:63], v[52:55]
    v_exp_f32 v59, v59
    v_mfma_f32_16x16x32_bf16 v[28:31], a[104:107], a[56:59], v[28:31]
    ds_read_b64_tr_b16 a[152:153], v13 offset:0
    v_cvt_pk_bf16_f32 v100, v56, v57
    v_mfma_f32_16x16x32_bf16 v[28:31], a[100:103], a[52:55], v[28:31]
    ds_read_b64_tr_b16 a[154:155], v13 offset:4096
    v_mfma_f32_16x16x32_bf16 v[28:31], a[96:99], a[48:51], v[28:31]
    s_waitcnt lgkmcnt(3)
    buffer_load_dwordx4 v22, s[44:47], s84 offen offset:1024 lds
    v_smfmac_f32_16x16x64_bf16 a[168:171], v[36:39], v[80:87], v35
    s_waitcnt vmcnt(10)
    s_barrier
    v_mfma_f32_16x16x32_bf16 v[192:195], a[128:131], v[64:67], v[192:195]
    s_add_u32 s80, s80, 32768
    v_exp_f32 v60, v60
    v_mfma_f32_16x16x32_bf16 v[192:195], a[132:135], v[68:71], v[192:195]
    s_mov_b32 m0, s68
    v_exp_f32 v61, v61
    v_mfma_f32_16x16x32_bf16 v[196:199], a[132:135], v[76:79], v[196:199]
    ds_read_b128 a[124:127], v5 offset:28672
    v_cvt_pk_bf16_f32 v101, v58, v59
    v_mfma_f32_16x16x32_bf16 v[196:199], a[128:131], v[72:75], v[196:199]
    v_exp_f32 v62, v62
    v_mfma_f32_16x16x32_bf16 v[200:203], a[128:131], v[80:83], v[200:203]
    v_exp_f32 v63, v63
    v_mfma_f32_16x16x32_bf16 v[200:203], a[132:135], v[84:87], v[200:203]
    ds_read_b64_tr_b16 a[156:157], v13 offset:8192
    v_cvt_pk_bf16_f32 v108, v60, v61
    v_mfma_f32_16x16x32_bf16 v[204:207], a[132:135], v[92:95], v[204:207]
    ds_read_b64_tr_b16 a[158:159], v13 offset:12288
    v_mfma_f32_16x16x32_bf16 v[204:207], a[128:131], v[88:91], v[204:207]
    buffer_load_dwordx4 v14, s[20:23], s80 offen offset:0 lds
    v_mfma_f32_16x16x32_bf16 v[220:223], a[136:139], v[88:91], v[220:223]
    s_cmp_gt_u32 s81, 5
    v_exp_f32 v24, v24
    v_mfma_f32_16x16x32_bf16 v[220:223], a[140:143], v[92:95], v[220:223]
    s_cselect_b32 s46, s46, 0
    v_exp_f32 v25, v25
    v_mfma_f32_16x16x32_bf16 v[216:219], a[140:143], v[84:87], v[216:219]
    ds_read_b128 a[64:67], v2 offset:32768
    v_cvt_pk_bf16_f32 v109, v62, v63
    v_mfma_f32_16x16x32_bf16 v[216:219], a[136:139], v[80:83], v[216:219]
    v_exp_f32 v26, v26
    v_mfma_f32_16x16x32_bf16 v[212:215], a[136:139], v[72:75], v[212:215]
    v_exp_f32 v27, v27
    v_mfma_f32_16x16x32_bf16 v[212:215], a[140:143], v[76:79], v[212:215]
    ds_read_b64_tr_b16 a[128:129], v6 offset:16384
    v_cvt_pk_bf16_f32 v116, v24, v25
    v_mfma_f32_16x16x32_bf16 v[208:211], a[140:143], v[68:71], v[208:211]
    ds_read_b64_tr_b16 a[130:131], v6 offset:20480
    v_mfma_f32_16x16x32_bf16 v[208:211], a[136:139], v[64:67], v[208:211]
    s_waitcnt lgkmcnt(3)
    v_mfma_f32_16x16x32_bf16 v[56:59], a[112:115], a[0:3], v[40:43]
    v_exp_f32 v28, v28
    v_mfma_f32_16x16x32_bf16 v[56:59], a[116:119], a[4:7], v[56:59]
    v_exp_f32 v29, v29
    v_mfma_f32_16x16x32_bf16 v[56:59], a[120:123], a[8:11], v[56:59]
    ds_read_b128 a[68:71], v3 offset:32768
    v_cvt_pk_bf16_f32 v117, v26, v27
    v_mfma_f32_16x16x32_bf16 v[56:59], a[124:127], a[12:15], v[56:59]
    v_exp_f32 v30, v30
    v_mfma_f32_16x16x32_bf16 v[60:63], a[124:127], a[28:31], v[44:47]
    v_exp_f32 v31, v31
    v_mfma_f32_16x16x32_bf16 v[60:63], a[120:123], a[24:27], v[60:63]
    ds_read_b64_tr_b16 a[132:133], v6 offset:24576
    v_cvt_pk_bf16_f32 v124, v28, v29
    v_mfma_f32_16x16x32_bf16 v[60:63], a[116:119], a[20:23], v[60:63]
    ds_read_b64_tr_b16 a[134:135], v6 offset:28672
    v_mfma_f32_16x16x32_bf16 v[60:63], a[112:115], a[16:19], v[60:63]
    buffer_load_dwordx4 v15, s[20:23], s80 offen offset:1024 lds
    v_mfma_f32_16x16x32_bf16 v[24:27], a[112:115], a[32:35], v[48:51]
    s_cmp_eq_u32 s81, 4
    v_exp_f32 v56, v56
    v_mfma_f32_16x16x32_bf16 v[24:27], a[116:119], a[36:39], v[24:27]
    s_cselect_b32 s5, s93, 16777216
    v_exp_f32 v57, v57
    v_mfma_f32_16x16x32_bf16 v[24:27], a[120:123], a[40:43], v[24:27]
    ds_read_b128 a[72:75], v4 offset:32768
    v_cvt_pk_bf16_f32 v125, v30, v31
    v_mfma_f32_16x16x32_bf16 v[24:27], a[124:127], a[44:47], v[24:27]
    v_exp_f32 v58, v58
    v_mfma_f32_16x16x32_bf16 v[28:31], a[124:127], a[60:63], v[52:55]
    v_exp_f32 v59, v59
    v_mfma_f32_16x16x32_bf16 v[28:31], a[120:123], a[56:59], v[28:31]
    ds_read_b64_tr_b16 a[136:137], v7 offset:16384
    v_cvt_pk_bf16_f32 v102, v56, v57
    v_mfma_f32_16x16x32_bf16 v[28:31], a[116:119], a[52:55], v[28:31]
    ds_read_b64_tr_b16 a[138:139], v7 offset:20480
    v_mfma_f32_16x16x32_bf16 v[28:31], a[112:115], a[48:51], v[28:31]
    s_waitcnt lgkmcnt(3)
    v_smfmac_f32_16x16x64_bf16 a[172:175], v[36:39], v[88:95], v35
    buffer_atomic_add v32, v33, s[40:43], s5 offen
    v_mfma_f32_16x16x32_bf16 v[224:227], a[144:147], v[64:67], v[224:227]
    v_exp_f32 v60, v60
    v_mfma_f32_16x16x32_bf16 v[224:227], a[148:151], v[68:71], v[224:227]
    v_exp_f32 v61, v61
    v_mfma_f32_16x16x32_bf16 v[228:231], a[148:151], v[76:79], v[228:231]
    ds_read_b128 a[76:79], v5 offset:32768
    v_cvt_pk_bf16_f32 v103, v58, v59
    v_mfma_f32_16x16x32_bf16 v[228:231], a[144:147], v[72:75], v[228:231]
    v_exp_f32 v62, v62
    v_mfma_f32_16x16x32_bf16 v[232:235], a[144:147], v[80:83], v[232:235]
    v_exp_f32 v63, v63
    v_mfma_f32_16x16x32_bf16 v[232:235], a[148:151], v[84:87], v[232:235]
    ds_read_b64_tr_b16 a[140:141], v7 offset:24576
    v_cvt_pk_bf16_f32 v110, v60, v61
    v_mfma_f32_16x16x32_bf16 v[236:239], a[148:151], v[92:95], v[236:239]
    ds_read_b64_tr_b16 a[142:143], v7 offset:28672
    v_mfma_f32_16x16x32_bf16 v[236:239], a[144:147], v[88:91], v[236:239]
    buffer_load_dwordx4 v16, s[20:23], s80 offen offset:2048 lds
    v_mfma_f32_16x16x32_bf16 v[252:255], a[152:155], v[88:91], v[252:255]
    s_cmp_gt_u32 s81, 1
    v_exp_f32 v24, v24
    v_mfma_f32_16x16x32_bf16 v[252:255], a[156:159], v[92:95], v[252:255]
    v_exp_f32 v25, v25
    v_mfma_f32_16x16x32_bf16 v[248:251], a[156:159], v[84:87], v[248:251]
    ds_read_b128 a[80:83], v2 offset:36864
    v_cvt_pk_bf16_f32 v111, v62, v63
    v_mfma_f32_16x16x32_bf16 v[248:251], a[152:155], v[80:83], v[248:251]
    v_exp_f32 v26, v26
    v_mfma_f32_16x16x32_bf16 v[244:247], a[152:155], v[72:75], v[244:247]
    v_exp_f32 v27, v27
    v_mfma_f32_16x16x32_bf16 v[244:247], a[156:159], v[76:79], v[244:247]
    ds_read_b64_tr_b16 a[144:145], v8 offset:16384
    v_cvt_pk_bf16_f32 v118, v24, v25
    v_mfma_f32_16x16x32_bf16 v[240:243], a[156:159], v[68:71], v[240:243]
    ds_read_b64_tr_b16 a[146:147], v8 offset:20480
    v_mfma_f32_16x16x32_bf16 v[240:243], a[152:155], v[64:67], v[240:243]
    s_waitcnt lgkmcnt(3)
    s_cbranch_scc1 M_loop
    v_cmp_gt_u32 vcc, 32, v21
    s_cbranch_vccnz M_pa_spin
M_pa_back:
    v_mfma_f32_16x16x32_bf16 v[56:59], a[64:67], a[0:3], v[40:43]
    s_mov_b32 m0, s75
    v_exp_f32 v28, v28
    v_mfma_f32_16x16x32_bf16 v[56:59], a[68:71], a[4:7], v[56:59]
    s_mov_b32 s80, 507904
    v_exp_f32 v29, v29
    v_mfma_f32_16x16x32_bf16 v[56:59], a[72:75], a[8:11], v[56:59]
    ds_read_b128 a[84:87], v3 offset:36864
    v_cvt_pk_bf16_f32 v119, v26, v27
    v_mfma_f32_16x16x32_bf16 v[56:59], a[76:79], a[12:15], v[56:59]
    v_exp_f32 v30, v30
    v_mfma_f32_16x16x32_bf16 v[60:63], a[76:79], a[28:31], v[44:47]
    v_exp_f32 v31, v31
    v_mfma_f32_16x16x32_bf16 v[60:63], a[72:75], a[24:27], v[60:63]
    ds_read_b64_tr_b16 a[148:149], v8 offset:24576
    v_cvt_pk_bf16_f32 v126, v28, v29
    v_mfma_f32_16x16x32_bf16 v[60:63], a[68:71], a[20:23], v[60:63]
    ds_read_b64_tr_b16 a[150:151], v8 offset:28672
    v_mfma_f32_16x16x32_bf16 v[60:63], a[64:67], a[16:19], v[60:63]
    buffer_load_dwordx4 v18, s[24:27], s80 offen offset:0 lds
    v_mfma_f32_16x16x32_bf16 v[24:27], a[64:67], a[32:35], v[48:51]
    v_exp_f32 v56, v56
    v_mfma_f32_16x16x32_bf16 v[24:27], a[68:71], a[36:39], v[24:27]
    v_exp_f32 v57, v57
    v_mfma_f32_16x16x32_bf16 v[24:27], a[72:75], a[40:43], v[24:27]
    ds_read_b128 a[88:91], v4 offset:36864
    v_cvt_pk_bf16_f32 v127, v30, v31
    v_mfma_f32_16x16x32_bf16 v[24:27], a[76:79], a[44:47], v[24:27]
    v_exp_f32 v58, v58
    v_mfma_f32_16x16x32_bf16 v[28:31], a[76:79], a[60:63], v[52:55]
    v_exp_f32 v59, v59
    v_mfma_f32_16x16x32_bf16 v[28:31], a[72:75], a[56:59], v[28:31]
    ds_read_b64_tr_b16 a[152:153], v9 offset:16384
    v_cvt_pk_bf16_f32 v64, v56, v57
    v_mfma_f32_16x16x32_bf16 v[28:31], a[68:71], a[52:55], v[28:31]
    ds_read_b64_tr_b16 a[154:155], v9 offset:20480
    v_mfma_f32_16x16x32_bf16 v[28:31], a[64:67], a[48:51], v[28:31]
    s_waitcnt lgkmcnt(3)
    buffer_load_dwordx4 v19, s[24:27], s80 offen offset:1024 lds
    v_smfmac_f32_16x16x64_bf16 a[160:163], v[36:39], v[96:103], v35
    buffer_load_dwordx4 v18, s[24:27], s80 offen offset:2048 lds
    v_mfma_f32_16x16x32_bf16 v[128:131], a[128:131], v[96:99], v[128:131]
    v_exp_f32 v60, v60
    v_mfma_f32_16x16x32_bf16 v[128:131], a[132:135], v[100:103], v[128:131]
    v_exp_f32 v61, v61
    v_mfma_f32_16x16x32_bf16 v[132:135], a[132:135], v[108:111], v[132:135]
    ds_read_b128 a[92:95], v5 offset:36864
    v_cvt_pk_bf16_f32 v65, v58, v59
    v_mfma_f32_16x16x32_bf16 v[132:135], a[128:131], v[104:107], v[132:135]
    v_exp_f32 v62, v62
    v_mfma_f32_16x16x32_bf16 v[136:139], a[128:131], v[112:115], v[136:139]
    v_exp_f32 v63, v63
    v_mfma_f32_16x16x32_bf16 v[136:139], a[132:135], v[116:119], v[136:139]
    ds_read_b64_tr_b16 a[156:157], v9 offset:24576
    v_cvt_pk_bf16_f32 v72, v60, v61
    v_mfma_f32_16x16x32_bf16 v[140:143], a[132:135], v[124:127], v[140:143]
    ds_read_b64_tr_b16 a[158:159], v9 offset:28672
    v_mfma_f32_16x16x32_bf16 v[140:143], a[128:131], v[120:123], v[140:143]
    buffer_load_dwordx4 v19, s[24:27], s80 offen offset:3072 lds
    v_mfma_f32_16x16x32_bf16 v[156:159], a[136:139], v[120:123], v[156:159]
    v_exp_f32 v24, v24
    v_mfma_f32_16x16x32_bf16 v[156:159], a[140:143], v[124:127], v[156:159]
    v_exp_f32 v25, v25
    v_mfma_f32_16x16x32_bf16 v[152:155], a[140:143], v[116:119], v[152:155]
    ds_read_b128 a[96:99], v2 offset:40960
    v_cvt_pk_bf16_f32 v73, v62, v63
    v_mfma_f32_16x16x32_bf16 v[152:155], a[136:139], v[112:115], v[152:155]
    v_exp_f32 v26, v26
    v_mfma_f32_16x16x32_bf16 v[148:151], a[136:139], v[104:107], v[148:151]
    v_exp_f32 v27, v27
    v_mfma_f32_16x16x32_bf16 v[148:151], a[140:143], v[108:111], v[148:151]
    ds_read_b64_tr_b16 a[128:129], v10 offset:16384
    v_cvt_pk_bf16_f32 v80, v24, v25
    v_mfma_f32_16x16x32_bf16 v[144:147], a[140:143], v[100:103], v[144:147]
    ds_read_b64_tr_b16 a[130:131], v10 offset:20480
    v_mfma_f32_16x16x32_bf16 v[144:147], a[136:139], v[96:99], v[144:147]
    s_waitcnt lgkmcnt(3)
    v_add_u32 v22, 4096, v1
    v_mfma_f32_16x16x32_bf16 v[56:59], a[80:83], a[0:3], v[40:43]
    s_add_u32 m0, s15, 139264
    v_exp_f32 v28, v28
    v_mfma_f32_16x16x32_bf16 v[56:59], a[84:87], a[4:7], v[56:59]
    v_exp_f32 v29, v29
    v_mfma_f32_16x16x32_bf16 v[56:59], a[88:91], a[8:11], v[56:59]
    ds_read_b128 a[100:103], v3 offset:40960
    v_cvt_pk_bf16_f32 v81, v26, v27
    v_mfma_f32_16x16x32_bf16 v[56:59], a[92:95], a[12:15], v[56:59]
    v_exp_f32 v30, v30
    v_mfma_f32_16x16x32_bf16 v[60:63], a[92:95], a[28:31], v[44:47]
    v_exp_f32 v31, v31
    v_mfma_f32_16x16x32_bf16 v[60:63], a[88:91], a[24:27], v[60:63]
    ds_read_b64_tr_b16 a[132:133], v10 offset:24576
    v_cvt_pk_bf16_f32 v88, v28, v29
    v_mfma_f32_16x16x32_bf16 v[60:63], a[84:87], a[20:23], v[60:63]
    ds_read_b64_tr_b16 a[134:135], v10 offset:28672
    v_mfma_f32_16x16x32_bf16 v[60:63], a[80:83], a[16:19], v[60:63]
    buffer_load_dwordx4 v1, s[60:63], s88 offen offset:0 sc1 lds
    v_mfma_f32_16x16x32_bf16 v[24:27], a[80:83], a[32:35], v[48:51]
    v_exp_f32 v56, v56
    v_mfma_f32_16x16x32_bf16 v[24:27], a[84:87], a[36:39], v[24:27]
    v_exp_f32 v57, v57
    v_mfma_f32_16x16x32_bf16 v[24:27], a[88:91], a[40:43], v[24:27]
    ds_read_b128 a[104:107], v4 offset:40960
    v_cvt_pk_bf16_f32 v89, v30, v31
    v_mfma_f32_16x16x32_bf16 v[24:27], a[92:95], a[44:47], v[24:27]
    v_exp_f32 v58, v58
    v_mfma_f32_16x16x32_bf16 v[28:31], a[92:95], a[60:63], v[52:55]
    v_exp_f32 v59, v59
    v_mfma_f32_16x16x32_bf16 v[28:31], a[88:91], a[56:59], v[28:31]
    ds_read_b64_tr_b16 a[136:137], v11 offset:16384
    v_cvt_pk_bf16_f32 v66, v56, v57
    v_mfma_f32_16x16x32_bf16 v[28:31], a[84:87], a[52:55], v[28:31]
    ds_read_b64_tr_b16 a[138:139], v11 offset:20480
    v_mfma_f32_16x16x32_bf16 v[28:31], a[80:83], a[48:51], v[28:31]
    s_waitcnt lgkmcnt(3)
    buffer_load_dwordx4 v1, s[60:63], s88 offen offset:1024 sc1 lds
    v_smfmac_f32_16x16x64_bf16 a[164:167], v[36:39], v[104:111], v35
    buffer_load_dwordx4 v1, s[60:63], s88 offen offset:2048 sc1 lds
    v_mfma_f32_16x16x32_bf16 v[160:163], a[144:147], v[96:99], v[160:163]
    v_exp_f32 v60, v60
    v_mfma_f32_16x16x32_bf16 v[160:163], a[148:151], v[100:103], v[160:163]
    v_exp_f32 v61, v61
    v_mfma_f32_16x16x32_bf16 v[164:167], a[148:151], v[108:111], v[164:167]
    ds_read_b128 a[108:111], v5 offset:40960
    v_cvt_pk_bf16_f32 v67, v58, v59
    v_mfma_f32_16x16x32_bf16 v[164:167], a[144:147], v[104:107], v[164:167]
    v_exp_f32 v62, v62
    v_mfma_f32_16x16x32_bf16 v[168:171], a[144:147], v[112:115], v[168:171]
    v_exp_f32 v63, v63
    v_mfma_f32_16x16x32_bf16 v[168:171], a[148:151], v[116:119], v[168:171]
    ds_read_b64_tr_b16 a[140:141], v11 offset:24576
    v_cvt_pk_bf16_f32 v74, v60, v61
    v_mfma_f32_16x16x32_bf16 v[172:175], a[148:151], v[124:127], v[172:175]
    ds_read_b64_tr_b16 a[142:143], v11 offset:28672
    v_mfma_f32_16x16x32_bf16 v[172:175], a[144:147], v[120:123], v[172:175]
    buffer_load_dwordx4 v1, s[60:63], s88 offen offset:3072 sc1 lds
    v_mfma_f32_16x16x32_bf16 v[188:191], a[152:155], v[120:123], v[188:191]
    s_add_u32 m0, s15, 143360
    v_exp_f32 v24, v24
    v_mfma_f32_16x16x32_bf16 v[188:191], a[156:159], v[124:127], v[188:191]
    v_exp_f32 v25, v25
    v_mfma_f32_16x16x32_bf16 v[184:187], a[156:159], v[116:119], v[184:187]
    ds_read_b128 a[112:115], v2 offset:45056
    v_cvt_pk_bf16_f32 v75, v62, v63
    v_mfma_f32_16x16x32_bf16 v[184:187], a[152:155], v[112:115], v[184:187]
    v_exp_f32 v26, v26
    v_mfma_f32_16x16x32_bf16 v[180:183], a[152:155], v[104:107], v[180:183]
    v_exp_f32 v27, v27
    v_mfma_f32_16x16x32_bf16 v[180:183], a[156:159], v[108:111], v[180:183]
    ds_read_b64_tr_b16 a[144:145], v12 offset:16384
    v_cvt_pk_bf16_f32 v82, v24, v25
    v_mfma_f32_16x16x32_bf16 v[176:179], a[156:159], v[100:103], v[176:179]
    ds_read_b64_tr_b16 a[146:147], v12 offset:20480
    v_mfma_f32_16x16x32_bf16 v[176:179], a[152:155], v[96:99], v[176:179]
    s_waitcnt lgkmcnt(3)
    buffer_load_dwordx4 v22, s[60:63], s88 offen sc1 lds
    v_mfma_f32_16x16x32_bf16 v[56:59], a[96:99], a[0:3], v[40:43]
    s_add_u32 s88, s88, 81920
    v_exp_f32 v28, v28
    v_mfma_f32_16x16x32_bf16 v[56:59], a[100:103], a[4:7], v[56:59]
    v_exp_f32 v29, v29
    v_mfma_f32_16x16x32_bf16 v[56:59], a[104:107], a[8:11], v[56:59]
    ds_read_b128 a[116:119], v3 offset:45056
    v_cvt_pk_bf16_f32 v83, v26, v27
    v_mfma_f32_16x16x32_bf16 v[56:59], a[108:111], a[12:15], v[56:59]
    v_exp_f32 v30, v30
    v_mfma_f32_16x16x32_bf16 v[60:63], a[108:111], a[28:31], v[44:47]
    v_exp_f32 v31, v31
    v_mfma_f32_16x16x32_bf16 v[60:63], a[104:107], a[24:27], v[60:63]
    ds_read_b64_tr_b16 a[148:149], v12 offset:24576
    v_cvt_pk_bf16_f32 v90, v28, v29
    v_mfma_f32_16x16x32_bf16 v[60:63], a[100:103], a[20:23], v[60:63]
    ds_read_b64_tr_b16 a[150:151], v12 offset:28672
    v_mfma_f32_16x16x32_bf16 v[60:63], a[96:99], a[16:19], v[60:63]
    v_mfma_f32_16x16x32_bf16 v[24:27], a[96:99], a[32:35], v[48:51]
    v_exp_f32 v56, v56
    v_mfma_f32_16x16x32_bf16 v[24:27], a[100:103], a[36:39], v[24:27]
    v_exp_f32 v57, v57
    v_mfma_f32_16x16x32_bf16 v[24:27], a[104:107], a[40:43], v[24:27]
    ds_read_b128 a[120:123], v4 offset:45056
    v_cvt_pk_bf16_f32 v91, v30, v31
    v_mfma_f32_16x16x32_bf16 v[24:27], a[108:111], a[44:47], v[24:27]
    v_exp_f32 v58, v58
    v_mfma_f32_16x16x32_bf16 v[28:31], a[108:111], a[60:63], v[52:55]
    v_exp_f32 v59, v59
    v_mfma_f32_16x16x32_bf16 v[28:31], a[104:107], a[56:59], v[28:31]
    ds_read_b64_tr_b16 a[152:153], v13 offset:16384
    v_cvt_pk_bf16_f32 v68, v56, v57
    v_mfma_f32_16x16x32_bf16 v[28:31], a[100:103], a[52:55], v[28:31]
    ds_read_b64_tr_b16 a[154:155], v13 offset:20480
    v_mfma_f32_16x16x32_bf16 v[28:31], a[96:99], a[48:51], v[28:31]
    s_waitcnt lgkmcnt(3)
    v_smfmac_f32_16x16x64_bf16 a[168:171], v[36:39], v[112:119], v35
    s_waitcnt vmcnt(9)
    s_barrier
    v_mfma_f32_16x16x32_bf16 v[192:195], a[128:131], v[96:99], v[192:195]
    s_mov_b32 m0, s72
    v_exp_f32 v60, v60
    v_mfma_f32_16x16x32_bf16 v[192:195], a[132:135], v[100:103], v[192:195]
    v_exp_f32 v61, v61
    v_mfma_f32_16x16x32_bf16 v[196:199], a[132:135], v[108:111], v[196:199]
    ds_read_b128 a[124:127], v5 offset:45056
    v_cvt_pk_bf16_f32 v69, v58, v59
    v_mfma_f32_16x16x32_bf16 v[196:199], a[128:131], v[104:107], v[196:199]
    v_exp_f32 v62, v62
    v_mfma_f32_16x16x32_bf16 v[200:203], a[128:131], v[112:115], v[200:203]
    v_exp_f32 v63, v63
    v_mfma_f32_16x16x32_bf16 v[200:203], a[132:135], v[116:119], v[200:203]
    ds_read_b64_tr_b16 a[156:157], v13 offset:24576
    v_cvt_pk_bf16_f32 v76, v60, v61
    v_mfma_f32_16x16x32_bf16 v[204:207], a[132:135], v[124:127], v[204:207]
    ds_read_b64_tr_b16 a[158:159], v13 offset:28672
    v_mfma_f32_16x16x32_bf16 v[204:207], a[128:131], v[120:123], v[204:207]
    buffer_load_dwordx4 v1, s[56:59], s87 offen offset:0 sc1 lds
    v_mfma_f32_16x16x32_bf16 v[220:223], a[136:139], v[120:123], v[220:223]
    v_exp_f32 v24, v24
    v_mfma_f32_16x16x32_bf16 v[220:223], a[140:143], v[124:127], v[220:223]
    v_exp_f32 v25, v25
    v_mfma_f32_16x16x32_bf16 v[216:219], a[140:143], v[116:119], v[216:219]
    ds_read_b128 a[64:67], v2 offset:49152
    v_cvt_pk_bf16_f32 v77, v62, v63
    v_mfma_f32_16x16x32_bf16 v[216:219], a[136:139], v[112:115], v[216:219]
    v_exp_f32 v26, v26
    v_mfma_f32_16x16x32_bf16 v[212:215], a[136:139], v[104:107], v[212:215]
    v_exp_f32 v27, v27
    v_mfma_f32_16x16x32_bf16 v[212:215], a[140:143], v[108:111], v[212:215]
    ds_read_b64_tr_b16 a[128:129], v6 offset:32768
    v_cvt_pk_bf16_f32 v84, v24, v25
    v_mfma_f32_16x16x32_bf16 v[208:211], a[140:143], v[100:103], v[208:211]
    ds_read_b64_tr_b16 a[130:131], v6 offset:36864
    v_mfma_f32_16x16x32_bf16 v[208:211], a[136:139], v[96:99], v[208:211]
    s_waitcnt lgkmcnt(3)
    buffer_load_dwordx4 v1, s[56:59], s87 offen offset:1024 sc1 lds
    v_mfma_f32_16x16x32_bf16 v[56:59], a[112:115], a[0:3], v[40:43]
    v_exp_f32 v28, v28
    v_mfma_f32_16x16x32_bf16 v[56:59], a[116:119], a[4:7], v[56:59]
    v_exp_f32 v29, v29
    v_mfma_f32_16x16x32_bf16 v[56:59], a[120:123], a[8:11], v[56:59]
    ds_read_b128 a[68:71], v3 offset:49152
    v_cvt_pk_bf16_f32 v85, v26, v27
    v_mfma_f32_16x16x32_bf16 v[56:59], a[124:127], a[12:15], v[56:59]
    v_exp_f32 v30, v30
    v_mfma_f32_16x16x32_bf16 v[60:63], a[124:127], a[28:31], v[44:47]
    v_exp_f32 v31, v31
    v_mfma_f32_16x16x32_bf16 v[60:63], a[120:123], a[24:27], v[60:63]
    ds_read_b64_tr_b16 a[132:133], v6 offset:40960
    v_cvt_pk_bf16_f32 v92, v28, v29
    v_mfma_f32_16x16x32_bf16 v[60:63], a[116:119], a[20:23], v[60:63]
    ds_read_b64_tr_b16 a[134:135], v6 offset:45056
    v_mfma_f32_16x16x32_bf16 v[60:63], a[112:115], a[16:19], v[60:63]
    buffer_load_dwordx4 v1, s[56:59], s87 offen offset:2048 sc1 lds
    v_mfma_f32_16x16x32_bf16 v[24:27], a[112:115], a[32:35], v[48:51]
    v_exp_f32 v56, v56
    v_mfma_f32_16x16x32_bf16 v[24:27], a[116:119], a[36:39], v[24:27]
    v_exp_f32 v57, v57
    v_mfma_f32_16x16x32_bf16 v[24:27], a[120:123], a[40:43], v[24:27]
    ds_read_b128 a[72:75], v4 offset:49152
    v_cvt_pk_bf16_f32 v93, v30, v31
    v_mfma_f32_16x16x32_bf16 v[24:27], a[124:127], a[44:47], v[24:27]
    v_exp_f32 v58, v58
    v_mfma_f32_16x16x32_bf16 v[28:31], a[124:127], a[60:63], v[52:55]
    v_exp_f32 v59, v59
    v_mfma_f32_16x16x32_bf16 v[28:31], a[120:123], a[56:59], v[28:31]
    ds_read_b64_tr_b16 a[136:137], v7 offset:32768
    v_cvt_pk_bf16_f32 v70, v56, v57
    v_mfma_f32_16x16x32_bf16 v[28:31], a[116:119], a[52:55], v[28:31]
    ds_read_b64_tr_b16 a[138:139], v7 offset:36864
    v_mfma_f32_16x16x32_bf16 v[28:31], a[112:115], a[48:51], v[28:31]
    s_waitcnt lgkmcnt(3)
    buffer_load_dwordx4 v1, s[56:59], s87 offen offset:3072 sc1 lds
    v_smfmac_f32_16x16x64_bf16 a[172:175], v[36:39], v[120:127], v35
    v_mfma_f32_16x16x32_bf16 v[224:227], a[144:147], v[96:99], v[224:227]
    s_add_u32 s87, s87, 8192
    v_exp_f32 v60, v60
    v_mfma_f32_16x16x32_bf16 v[224:227], a[148:151], v[100:103], v[224:227]
    s_add_u32 m0, s15, 0
    v_exp_f32 v61, v61
    v_mfma_f32_16x16x32_bf16 v[228:231], a[148:151], v[108:111], v[228:231]
    ds_read_b128 a[76:79], v5 offset:49152
    v_cvt_pk_bf16_f32 v71, v58, v59
    v_mfma_f32_16x16x32_bf16 v[228:231], a[144:147], v[104:107], v[228:231]
    v_exp_f32 v62, v62
    v_mfma_f32_16x16x32_bf16 v[232:235], a[144:147], v[112:115], v[232:235]
    v_exp_f32 v63, v63
    v_mfma_f32_16x16x32_bf16 v[232:235], a[148:151], v[116:119], v[232:235]
    ds_read_b64_tr_b16 a[140:141], v7 offset:40960
    v_cvt_pk_bf16_f32 v78, v60, v61
    v_mfma_f32_16x16x32_bf16 v[236:239], a[148:151], v[124:127], v[236:239]
    ds_read_b64_tr_b16 a[142:143], v7 offset:45056
    v_mfma_f32_16x16x32_bf16 v[236:239], a[144:147], v[120:123], v[236:239]
    buffer_load_dwordx4 v1, s[60:63], s88 offen offset:0 sc1 lds
    v_mfma_f32_16x16x32_bf16 v[252:255], a[152:155], v[120:123], v[252:255]
    v_exp_f32 v24, v24
    v_mfma_f32_16x16x32_bf16 v[252:255], a[156:159], v[124:127], v[252:255]
    v_exp_f32 v25, v25
    v_mfma_f32_16x16x32_bf16 v[248:251], a[156:159], v[116:119], v[248:251]
    ds_read_b128 a[80:83], v2 offset:53248
    v_cvt_pk_bf16_f32 v79, v62, v63
    v_mfma_f32_16x16x32_bf16 v[248:251], a[152:155], v[112:115], v[248:251]
    v_exp_f32 v26, v26
    v_mfma_f32_16x16x32_bf16 v[244:247], a[152:155], v[104:107], v[244:247]
    v_exp_f32 v27, v27
    v_mfma_f32_16x16x32_bf16 v[244:247], a[156:159], v[108:111], v[244:247]
    ds_read_b64_tr_b16 a[144:145], v8 offset:32768
    v_cvt_pk_bf16_f32 v86, v24, v25
    v_mfma_f32_16x16x32_bf16 v[240:243], a[156:159], v[100:103], v[240:243]
    ds_read_b64_tr_b16 a[146:147], v8 offset:36864
    v_mfma_f32_16x16x32_bf16 v[240:243], a[152:155], v[96:99], v[240:243]
    s_waitcnt lgkmcnt(3)
    buffer_load_dwordx4 v1, s[60:63], s88 offen offset:1024 sc1 lds
    v_mfma_f32_16x16x32_bf16 v[56:59], a[64:67], a[0:3], v[40:43]
    v_exp_f32 v28, v28
    v_mfma_f32_16x16x32_bf16 v[56:59], a[68:71], a[4:7], v[56:59]
    v_exp_f32 v29, v29
    v_mfma_f32_16x16x32_bf16 v[56:59], a[72:75], a[8:11], v[56:59]
    ds_read_b128 a[84:87], v3 offset:53248
    v_cvt_pk_bf16_f32 v87, v26, v27
    v_mfma_f32_16x16x32_bf16 v[56:59], a[76:79], a[12:15], v[56:59]
    v_exp_f32 v30, v30
    v_mfma_f32_16x16x32_bf16 v[60:63], a[76:79], a[28:31], v[44:47]
    v_exp_f32 v31, v31
    v_mfma_f32_16x16x32_bf16 v[60:63], a[72:75], a[24:27], v[60:63]
    ds_read_b64_tr_b16 a[148:149], v8 offset:40960
    v_cvt_pk_bf16_f32 v94, v28, v29
    v_mfma_f32_16x16x32_bf16 v[60:63], a[68:71], a[20:23], v[60:63]
    ds_read_b64_tr_b16 a[150:151], v8 offset:45056
    v_mfma_f32_16x16x32_bf16 v[60:63], a[64:67], a[16:19], v[60:63]
    buffer_load_dwordx4 v1, s[60:63], s88 offen offset:2048 sc1 lds
    v_mfma_f32_16x16x32_bf16 v[24:27], a[64:67], a[32:35], v[48:51]
    v_exp_f32 v56, v56
    v_mfma_f32_16x16x32_bf16 v[24:27], a[68:71], a[36:39], v[24:27]
    v_exp_f32 v57, v57
    v_mfma_f32_16x16x32_bf16 v[24:27], a[72:75], a[40:43], v[24:27]
    ds_read_b128 a[88:91], v4 offset:53248
    v_cvt_pk_bf16_f32 v95, v30, v31
    v_mfma_f32_16x16x32_bf16 v[24:27], a[76:79], a[44:47], v[24:27]
    v_exp_f32 v58, v58
    v_mfma_f32_16x16x32_bf16 v[28:31], a[76:79], a[60:63], v[52:55]
    v_exp_f32 v59, v59
    v_mfma_f32_16x16x32_bf16 v[28:31], a[72:75], a[56:59], v[28:31]
    ds_read_b64_tr_b16 a[152:153], v9 offset:32768
    v_cvt_pk_bf16_f32 v96, v56, v57
    v_mfma_f32_16x16x32_bf16 v[28:31], a[68:71], a[52:55], v[28:31]
    ds_read_b64_tr_b16 a[154:155], v9 offset:36864
    v_mfma_f32_16x16x32_bf16 v[28:31], a[64:67], a[48:51], v[28:31]
    s_waitcnt lgkmcnt(3)
    buffer_load_dwordx4 v1, s[60:63], s88 offen offset:3072 sc1 lds
    v_smfmac_f32_16x16x64_bf16 a[160:163], v[36:39], v[64:71], v35
    v_mfma_f32_16x16x32_bf16 v[128:131], a[128:131], v[64:67], v[128:131]
    s_add_u32 m0, s15, 4096
    v_exp_f32 v60, v60
    v_mfma_f32_16x16x32_bf16 v[128:131], a[132:135], v[68:71], v[128:131]
    v_exp_f32 v61, v61
    v_mfma_f32_16x16x32_bf16 v[132:135], a[132:135], v[76:79], v[132:135]
    ds_read_b128 a[92:95], v5 offset:53248
    v_cvt_pk_bf16_f32 v97, v58, v59
    v_mfma_f32_16x16x32_bf16 v[132:135], a[128:131], v[72:75], v[132:135]
    v_exp_f32 v62, v62
    v_mfma_f32_16x16x32_bf16 v[136:139], a[128:131], v[80:83], v[136:139]
    v_exp_f32 v63, v63
    v_mfma_f32_16x16x32_bf16 v[136:139], a[132:135], v[84:87], v[136:139]
    ds_read_b64_tr_b16 a[156:157], v9 offset:40960
    v_cvt_pk_bf16_f32 v104, v60, v61
    v_mfma_f32_16x16x32_bf16 v[140:143], a[132:135], v[92:95], v[140:143]
    ds_read_b64_tr_b16 a[158:159], v9 offset:45056
    v_mfma_f32_16x16x32_bf16 v[140:143], a[128:131], v[88:91], v[140:143]
    buffer_load_dwordx4 v22, s[60:63], s88 offen sc1 lds
    v_mfma_f32_16x16x32_bf16 v[156:159], a[136:139], v[88:91], v[156:159]
    s_add_u32 s88, s88, 81920
    v_exp_f32 v24, v24
    v_mfma_f32_16x16x32_bf16 v[156:159], a[140:143], v[92:95], v[156:159]
    v_exp_f32 v25, v25
    v_mfma_f32_16x16x32_bf16 v[152:155], a[140:143], v[84:87], v[152:155]
    ds_read_b128 a[96:99], v2 offset:57344
    v_cvt_pk_bf16_f32 v105, v62, v63
    v_mfma_f32_16x16x32_bf16 v[152:155], a[136:139], v[80:83], v[152:155]
    v_exp_f32 v26, v26
    v_mfma_f32_16x16x32_bf16 v[148:151], a[136:139], v[72:75], v[148:151]
    v_exp_f32 v27, v27
    v_mfma_f32_16x16x32_bf16 v[148:151], a[140:143], v[76:79], v[148:151]
    ds_read_b64_tr_b16 a[128:129], v10 offset:32768
    v_cvt_pk_bf16_f32 v112, v24, v25
    v_mfma_f32_16x16x32_bf16 v[144:147], a[140:143], v[68:71], v[144:147]
    ds_read_b64_tr_b16 a[130:131], v10 offset:36864
    v_mfma_f32_16x16x32_bf16 v[144:147], a[136:139], v[64:67], v[144:147]
    s_waitcnt lgkmcnt(3)
    v_mfma_f32_16x16x32_bf16 v[56:59], a[80:83], a[0:3], v[40:43]
    v_exp_f32 v28, v28
    v_mfma_f32_16x16x32_bf16 v[56:59], a[84:87], a[4:7], v[56:59]
    v_exp_f32 v29, v29
    v_mfma_f32_16x16x32_bf16 v[56:59], a[88:91], a[8:11], v[56:59]
    ds_read_b128 a[100:103], v3 offset:57344
    v_cvt_pk_bf16_f32 v113, v26, v27
    v_mfma_f32_16x16x32_bf16 v[56:59], a[92:95], a[12:15], v[56:59]
    v_exp_f32 v30, v30
    v_mfma_f32_16x16x32_bf16 v[60:63], a[92:95], a[28:31], v[44:47]
    v_exp_f32 v31, v31
    v_mfma_f32_16x16x32_bf16 v[60:63], a[88:91], a[24:27], v[60:63]
    ds_read_b64_tr_b16 a[132:133], v10 offset:40960
    v_cvt_pk_bf16_f32 v120, v28, v29
    v_mfma_f32_16x16x32_bf16 v[60:63], a[84:87], a[20:23], v[60:63]
    ds_read_b64_tr_b16 a[134:135], v10 offset:45056
    v_mfma_f32_16x16x32_bf16 v[60:63], a[80:83], a[16:19], v[60:63]
    v_mfma_f32_16x16x32_bf16 v[24:27], a[80:83], a[32:35], v[48:51]
    v_exp_f32 v56, v56
    v_mfma_f32_16x16x32_bf16 v[24:27], a[84:87], a[36:39], v[24:27]
    v_exp_f32 v57, v57
    v_mfma_f32_16x16x32_bf16 v[24:27], a[88:91], a[40:43], v[24:27]
    ds_read_b128 a[104:107], v4 offset:57344
    v_cvt_pk_bf16_f32 v121, v30, v31
    v_mfma_f32_16x16x32_bf16 v[24:27], a[92:95], a[44:47], v[24:27]
    v_exp_f32 v58, v58
    v_mfma_f32_16x16x32_bf16 v[28:31], a[92:95], a[60:63], v[52:55]
    v_exp_f32 v59, v59
    v_mfma_f32_16x16x32_bf16 v[28:31], a[88:91], a[56:59], v[28:31]
    ds_read_b64_tr_b16 a[136:137], v11 offset:32768
    v_cvt_pk_bf16_f32 v98, v56, v57
    v_mfma_f32_16x16x32_bf16 v[28:31], a[84:87], a[52:55], v[28:31]
    ds_read_b64_tr_b16 a[138:139], v11 offset:36864
    v_mfma_f32_16x16x32_bf16 v[28:31], a[80:83], a[48:51], v[28:31]
    s_waitcnt lgkmcnt(3)
    v_smfmac_f32_16x16x64_bf16 a[164:167], v[36:39], v[72:79], v35
    v_mfma_f32_16x16x32_bf16 v[160:163], a[144:147], v[64:67], v[160:163]
    v_exp_f32 v60, v60
    v_mfma_f32_16x16x32_bf16 v[160:163], a[148:151], v[68:71], v[160:163]
    v_exp_f32 v61, v61
    v_mfma_f32_16x16x32_bf16 v[164:167], a[148:151], v[76:79], v[164:167]
    ds_read_b128 a[108:111], v5 offset:57344
    v_cvt_pk_bf16_f32 v99, v58, v59
    v_mfma_f32_16x16x32_bf16 v[164:167], a[144:147], v[72:75], v[164:167]
    v_exp_f32 v62, v62
    v_mfma_f32_16x16x32_bf16 v[168:171], a[144:147], v[80:83], v[168:171]
    v_exp_f32 v63, v63
    v_mfma_f32_16x16x32_bf16 v[168:171], a[148:151], v[84:87], v[168:171]
    ds_read_b64_tr_b16 a[140:141], v11 offset:40960
    v_cvt_pk_bf16_f32 v106, v60, v61
    v_mfma_f32_16x16x32_bf16 v[172:175], a[148:151], v[92:95], v[172:175]
    ds_read_b64_tr_b16 a[142:143], v11 offset:45056
    v_mfma_f32_16x16x32_bf16 v[172:175], a[144:147], v[88:91], v[172:175]
    v_mfma_f32_16x16x32_bf16 v[188:191], a[152:155], v[88:91], v[188:191]
    v_exp_f32 v24, v24
    v_mfma_f32_16x16x32_bf16 v[188:191], a[156:159], v[92:95], v[188:191]
    v_exp_f32 v25, v25
    v_mfma_f32_16x16x32_bf16 v[184:187], a[156:159], v[84:87], v[184:187]
    ds_read_b128 a[112:115], v2 offset:61440
    v_cvt_pk_bf16_f32 v107, v62, v63
    v_mfma_f32_16x16x32_bf16 v[184:187], a[152:155], v[80:83], v[184:187]
    v_exp_f32 v26, v26
    v_mfma_f32_16x16x32_bf16 v[180:183], a[152:155], v[72:75], v[180:183]
    v_exp_f32 v27, v27
    v_mfma_f32_16x16x32_bf16 v[180:183], a[156:159], v[76:79], v[180:183]
    ds_read_b64_tr_b16 a[144:145], v12 offset:32768
    v_cvt_pk_bf16_f32 v114, v24, v25
    v_mfma_f32_16x16x32_bf16 v[176:179], a[156:159], v[68:71], v[176:179]
    ds_read_b64_tr_b16 a[146:147], v12 offset:36864
    v_mfma_f32_16x16x32_bf16 v[176:179], a[152:155], v[64:67], v[176:179]
    s_waitcnt lgkmcnt(3)
    v_mfma_f32_16x16x32_bf16 v[56:59], a[96:99], a[0:3], v[40:43]
    v_exp_f32 v28, v28
    v_mfma_f32_16x16x32_bf16 v[56:59], a[100:103], a[4:7], v[56:59]
    v_exp_f32 v29, v29
    v_mfma_f32_16x16x32_bf16 v[56:59], a[104:107], a[8:11], v[56:59]
    ds_read_b128 a[116:119], v3 offset:61440
    v_cvt_pk_bf16_f32 v115, v26, v27
    v_mfma_f32_16x16x32_bf16 v[56:59], a[108:111], a[12:15], v[56:59]
    v_exp_f32 v30, v30
    v_mfma_f32_16x16x32_bf16 v[60:63], a[108:111], a[28:31], v[44:47]
    v_exp_f32 v31, v31
    v_mfma_f32_16x16x32_bf16 v[60:63], a[104:107], a[24:27], v[60:63]
    ds_read_b64_tr_b16 a[148:149], v12 offset:40960
    v_cvt_pk_bf16_f32 v122, v28, v29
    v_mfma_f32_16x16x32_bf16 v[60:63], a[100:103], a[20:23], v[60:63]
    ds_read_b64_tr_b16 a[150:151], v12 offset:45056
    v_mfma_f32_16x16x32_bf16 v[60:63], a[96:99], a[16:19], v[60:63]
    v_mfma_f32_16x16x32_bf16 v[24:27], a[96:99], a[32:35], v[48:51]
    v_exp_f32 v56, v56
    v_mfma_f32_16x16x32_bf16 v[24:27], a[100:103], a[36:39], v[24:27]
    v_exp_f32 v57, v57
    v_mfma_f32_16x16x32_bf16 v[24:27], a[104:107], a[40:43], v[24:27]
    ds_read_b128 a[120:123], v4 offset:61440
    v_cvt_pk_bf16_f32 v123, v30, v31
    v_mfma_f32_16x16x32_bf16 v[24:27], a[108:111], a[44:47], v[24:27]
    v_exp_f32 v58, v58
    v_mfma_f32_16x16x32_bf16 v[28:31], a[108:111], a[60:63], v[52:55]
    v_exp_f32 v59, v59
    v_mfma_f32_16x16x32_bf16 v[28:31], a[104:107], a[56:59], v[28:31]
    ds_read_b64_tr_b16 a[152:153], v13 offset:32768
    v_cvt_pk_bf16_f32 v100, v56, v57
    v_mfma_f32_16x16x32_bf16 v[28:31], a[100:103], a[52:55], v[28:31]
    ds_read_b64_tr_b16 a[154:155], v13 offset:36864
    v_mfma_f32_16x16x32_bf16 v[28:31], a[96:99], a[48:51], v[28:31]
    s_waitcnt lgkmcnt(3)
    v_smfmac_f32_16x16x64_bf16 a[168:171], v[36:39], v[80:87], v35
    s_waitcnt vmcnt(14)
    s_barrier
    v_mfma_f32_16x16x32_bf16 v[192:195], a[128:131], v[64:67], v[192:195]
    s_mov_b32 m0, s73
    v_exp_f32 v60, v60
    v_mfma_f32_16x16x32_bf16 v[192:195], a[132:135], v[68:71], v[192:195]
    v_exp_f32 v61, v61
    v_mfma_f32_16x16x32_bf16 v[196:199], a[132:135], v[76:79], v[196:199]
    ds_read_b128 a[124:127], v5 offset:61440
    v_cvt_pk_bf16_f32 v101, v58, v59
    v_mfma_f32_16x16x32_bf16 v[196:199], a[128:131], v[72:75], v[196:199]
    v_exp_f32 v62, v62
    v_mfma_f32_16x16x32_bf16 v[200:203], a[128:131], v[80:83], v[200:203]
    v_exp_f32 v63, v63
    v_mfma_f32_16x16x32_bf16 v[200:203], a[132:135], v[84:87], v[200:203]
    ds_read_b64_tr_b16 a[156:157], v13 offset:40960
    v_cvt_pk_bf16_f32 v108, v60, v61
    v_mfma_f32_16x16x32_bf16 v[204:207], a[132:135], v[92:95], v[204:207]
    ds_read_b64_tr_b16 a[158:159], v13 offset:45056
    v_mfma_f32_16x16x32_bf16 v[204:207], a[128:131], v[88:91], v[204:207]
    buffer_load_dwordx4 v1, s[56:59], s87 offen offset:0 sc1 lds
    v_mfma_f32_16x16x32_bf16 v[220:223], a[136:139], v[88:91], v[220:223]
    v_exp_f32 v24, v24
    v_mfma_f32_16x16x32_bf16 v[220:223], a[140:143], v[92:95], v[220:223]
    v_exp_f32 v25, v25
    v_mfma_f32_16x16x32_bf16 v[216:219], a[140:143], v[84:87], v[216:219]
    v_cvt_pk_bf16_f32 v109, v62, v63
    v_mfma_f32_16x16x32_bf16 v[216:219], a[136:139], v[80:83], v[216:219]
    v_exp_f32 v26, v26
    v_mfma_f32_16x16x32_bf16 v[212:215], a[136:139], v[72:75], v[212:215]
    v_exp_f32 v27, v27
    v_mfma_f32_16x16x32_bf16 v[212:215], a[140:143], v[76:79], v[212:215]
    ds_read_b64_tr_b16 a[128:129], v6 offset:49152
    v_cvt_pk_bf16_f32 v116, v24, v25
    v_mfma_f32_16x16x32_bf16 v[208:211], a[140:143], v[68:71], v[208:211]
    ds_read_b64_tr_b16 a[130:131], v6 offset:53248
    v_mfma_f32_16x16x32_bf16 v[208:211], a[136:139], v[64:67], v[208:211]
    s_waitcnt lgkmcnt(2)
    buffer_load_dwordx4 v1, s[56:59], s87 offen offset:1024 sc1 lds
    v_mfma_f32_16x16x32_bf16 v[56:59], a[112:115], a[0:3], v[40:43]
    v_exp_f32 v28, v28
    v_mfma_f32_16x16x32_bf16 v[56:59], a[116:119], a[4:7], v[56:59]
    v_exp_f32 v29, v29
    v_mfma_f32_16x16x32_bf16 v[56:59], a[120:123], a[8:11], v[56:59]
    v_cvt_pk_bf16_f32 v117, v26, v27
    v_mfma_f32_16x16x32_bf16 v[56:59], a[124:127], a[12:15], v[56:59]
    v_exp_f32 v30, v30
    v_mfma_f32_16x16x32_bf16 v[60:63], a[124:127], a[28:31], v[44:47]
    v_exp_f32 v31, v31
    v_mfma_f32_16x16x32_bf16 v[60:63], a[120:123], a[24:27], v[60:63]
    ds_read_b64_tr_b16 a[132:133], v6 offset:57344
    v_cvt_pk_bf16_f32 v124, v28, v29
    v_mfma_f32_16x16x32_bf16 v[60:63], a[116:119], a[20:23], v[60:63]
    ds_read_b64_tr_b16 a[134:135], v6 offset:61440
    v_mfma_f32_16x16x32_bf16 v[60:63], a[112:115], a[16:19], v[60:63]
    buffer_load_dwordx4 v1, s[56:59], s87 offen offset:2048 sc1 lds
    v_mfma_f32_16x16x32_bf16 v[24:27], a[112:115], a[32:35], v[48:51]
    v_exp_f32 v56, v56
    v_mfma_f32_16x16x32_bf16 v[24:27], a[116:119], a[36:39], v[24:27]
    v_exp_f32 v57, v57
    v_mfma_f32_16x16x32_bf16 v[24:27], a[120:123], a[40:43], v[24:27]
    v_cvt_pk_bf16_f32 v125, v30, v31
    v_mfma_f32_16x16x32_bf16 v[24:27], a[124:127], a[44:47], v[24:27]
    v_exp_f32 v58, v58
    v_mfma_f32_16x16x32_bf16 v[28:31], a[124:127], a[60:63], v[52:55]
    v_exp_f32 v59, v59
    v_mfma_f32_16x16x32_bf16 v[28:31], a[120:123], a[56:59], v[28:31]
    ds_read_b64_tr_b16 a[136:137], v7 offset:49152
    v_cvt_pk_bf16_f32 v102, v56, v57
    v_mfma_f32_16x16x32_bf16 v[28:31], a[116:119], a[52:55], v[28:31]
    ds_read_b64_tr_b16 a[138:139], v7 offset:53248
    v_mfma_f32_16x16x32_bf16 v[28:31], a[112:115], a[48:51], v[28:31]
    s_waitcnt lgkmcnt(2)
    buffer_load_dwordx4 v1, s[56:59], s87 offen offset:3072 sc1 lds
    v_smfmac_f32_16x16x64_bf16 a[172:175], v[36:39], v[88:95], v35
    s_barrier
    v_mfma_f32_16x16x32_bf16 v[224:227], a[144:147], v[64:67], v[224:227]
    s_add_u32 s87, s87, 8192
    v_exp_f32 v60, v60
    v_mfma_f32_16x16x32_bf16 v[224:227], a[148:151], v[68:71], v[224:227]
    s_add_u32 m0, s15, 20480
    v_exp_f32 v61, v61
    v_mfma_f32_16x16x32_bf16 v[228:231], a[148:151], v[76:79], v[228:231]
    v_cvt_pk_bf16_f32 v103, v58, v59
    v_mfma_f32_16x16x32_bf16 v[228:231], a[144:147], v[72:75], v[228:231]
    v_exp_f32 v62, v62
    v_mfma_f32_16x16x32_bf16 v[232:235], a[144:147], v[80:83], v[232:235]
    v_exp_f32 v63, v63
    v_mfma_f32_16x16x32_bf16 v[232:235], a[148:151], v[84:87], v[232:235]
    ds_read_b64_tr_b16 a[140:141], v7 offset:57344
    v_cvt_pk_bf16_f32 v110, v60, v61
    v_mfma_f32_16x16x32_bf16 v[236:239], a[148:151], v[92:95], v[236:239]
    ds_read_b64_tr_b16 a[142:143], v7 offset:61440
    v_mfma_f32_16x16x32_bf16 v[236:239], a[144:147], v[88:91], v[236:239]
    buffer_load_dwordx4 v1, s[60:63], s88 offen offset:0 sc1 lds
    v_mfma_f32_16x16x32_bf16 v[252:255], a[152:155], v[88:91], v[252:255]
    v_exp_f32 v24, v24
    v_mfma_f32_16x16x32_bf16 v[252:255], a[156:159], v[92:95], v[252:255]
    v_exp_f32 v25, v25
    v_mfma_f32_16x16x32_bf16 v[248:251], a[156:159], v[84:87], v[248:251]
    v_cvt_pk_bf16_f32 v111, v62, v63
    v_mfma_f32_16x16x32_bf16 v[248:251], a[152:155], v[80:83], v[248:251]
    v_exp_f32 v26, v26
    v_mfma_f32_16x16x32_bf16 v[244:247], a[152:155], v[72:75], v[244:247]
    v_exp_f32 v27, v27
    v_mfma_f32_16x16x32_bf16 v[244:247], a[156:159], v[76:79], v[244:247]
    ds_read_b64_tr_b16 a[144:145], v8 offset:49152
    v_cvt_pk_bf16_f32 v118, v24, v25
    v_mfma_f32_16x16x32_bf16 v[240:243], a[156:159], v[68:71], v[240:243]
    ds_read_b64_tr_b16 a[146:147], v8 offset:53248
    v_mfma_f32_16x16x32_bf16 v[240:243], a[152:155], v[64:67], v[240:243]
    s_waitcnt lgkmcnt(2)
    buffer_load_dwordx4 v1, s[60:63], s88 offen offset:1024 sc1 lds
    s_mov_b32 s6, 8192
    v_exp_f32 v28, v28
    v_exp_f32 v29, v29
    v_cvt_pk_bf16_f32 v119, v26, v27
    v_exp_f32 v30, v30
    v_exp_f32 v31, v31
    v_mfma_f32_16x16x32_bf16 v[128:131], a[128:131], v[96:99], v[128:131]
    ds_read_b64_tr_b16 a[148:149], v8 offset:57344
    ds_read_b64_tr_b16 a[150:151], v8 offset:61440
    v_cvt_pk_bf16_f32 v126, v28, v29
    v_mfma_f32_16x16x32_bf16 v[128:131], a[132:135], v[100:103], v[128:131]
    v_mfma_f32_16x16x32_bf16 v[132:135], a[132:135], v[108:111], v[132:135]
    buffer_load_dwordx4 v1, s[60:63], s88 offen offset:2048 sc1 lds
    v_mfma_f32_16x16x32_bf16 v[132:135], a[128:131], v[104:107], v[132:135]
    buffer_load_dwordx4 v1, s[60:63], s88 offen offset:3072 sc1 lds
    s_add_u32 m0, s15, 24576
    v_cvt_pk_bf16_f32 v127, v30, v31
    v_mfma_f32_16x16x32_bf16 v[136:139], a[128:131], v[112:115], v[136:139]
    ds_read_b64_tr_b16 a[152:153], v9 offset:49152
    ds_read_b64_tr_b16 a[154:155], v9 offset:53248
    v_mfma_f32_16x16x32_bf16 v[136:139], a[132:135], v[116:119], v[136:139]
    buffer_load_dwordx4 v22, s[60:63], s88 offen sc1 lds
    s_add_u32 s88, s88, 81920
    v_mfma_f32_16x16x32_bf16 v[140:143], a[132:135], v[124:127], v[140:143]
    s_mov_b32 m0, s74
    v_mfma_f32_16x16x32_bf16 v[140:143], a[128:131], v[120:123], v[140:143]
    buffer_load_dwordx4 v1, s[56:59], s87 offen offset:0 sc1 lds
    v_maximum3_f32 v40, |v128|, |v129|, |v129|
    s_waitcnt lgkmcnt(2)
    v_mfma_f32_16x16x32_bf16 v[144:147], a[136:139], v[96:99], v[144:147]
    s_lshr_b32 s5, s76, 1
    ds_read_b64_tr_b16 a[156:157], v9 offset:57344
    ds_read_b64_tr_b16 a[158:159], v9 offset:61440
    s_lshl_b32 s5, s5, 2
    v_mfma_f32_16x16x32_bf16 v[144:147], a[140:143], v[100:103], v[144:147]
    s_bfe_u32 s4, s2, 0x20001
    buffer_load_dwordx4 v1, s[56:59], s87 offen offset:1024 sc1 lds
    s_add_u32 s5, s5, s4
    v_mfma_f32_16x16x32_bf16 v[148:151], a[140:143], v[108:111], v[148:151]
    s_lshl_b32 s5, s5, 11
    buffer_load_dwordx4 v1, s[56:59], s87 offen offset:2048 sc1 lds
    s_add_u32 s5, s5, 65536
    v_mfma_f32_16x16x32_bf16 v[148:151], a[136:139], v[104:107], v[148:151]
    v_add_u32 v48, s5, v1
    v_xor_b32 v49, 2048, v48
    v_xor_b32 v50, 4096, v48
    v_smfmac_f32_16x16x64_bf16 a[160:163], v[36:39], v[96:103], v35
    v_xor_b32 v51, 6144, v48
    s_and_b32 s5, s76, 1
    s_mul_i32 s5, s5, 10240
    v_mfma_f32_16x16x32_bf16 v[152:155], a[136:139], v[112:115], v[152:155]
    ds_read_b64_tr_b16 a[128:129], v10 offset:49152
    ds_read_b64_tr_b16 a[130:131], v10 offset:53248
    v_mfma_f32_16x16x32_bf16 v[152:155], a[140:143], v[116:119], v[152:155]
    buffer_load_dwordx4 v1, s[56:59], s87 offen offset:3072 sc1 lds
    s_add_u32 s87, s87, 8192
    v_mfma_f32_16x16x32_bf16 v[156:159], a[140:143], v[124:127], v[156:159]
    s_add_u32 m0, s15, 40960
    v_mfma_f32_16x16x32_bf16 v[156:159], a[136:139], v[120:123], v[156:159]
    buffer_load_dwordx4 v1, s[60:63], s88 offen offset:0 sc1 lds
    v_add_u32 v52, s5, v1
    v_smfmac_f32_16x16x64_bf16 a[164:167], v[36:39], v[104:111], v35
    v_add_u32 v53, 139264, v52
    v_maximum3_f32 v40, |v130|, |v131|, v40
    v_maximum3_f32 v41, |v132|, |v133|, |v133|
    s_waitcnt lgkmcnt(2)
    v_mfma_f32_16x16x32_bf16 v[160:163], a[144:147], v[96:99], v[160:163]
    ds_read_b64_tr_b16 a[132:133], v10 offset:57344
    ds_read_b64_tr_b16 a[134:135], v10 offset:61440
    v_mfma_f32_16x16x32_bf16 v[160:163], a[148:151], v[100:103], v[160:163]
    buffer_load_dwordx4 v1, s[60:63], s88 offen offset:1024 sc1 lds
    v_mfma_f32_16x16x32_bf16 v[164:167], a[148:151], v[108:111], v[164:167]
    buffer_load_dwordx4 v1, s[60:63], s88 offen offset:2048 sc1 lds
    v_maximum3_f32 v41, |v134|, |v135|, v41
    v_mfma_f32_16x16x32_bf16 v[164:167], a[144:147], v[104:107], v[164:167]
    v_maximum3_f32 v42, |v136|, |v137|, |v137|
    v_maximum3_f32 v42, |v138|, |v139|, v42
    v_maximum3_f32 v43, |v140|, |v141|, |v141|
    v_smfmac_f32_16x16x64_bf16 a[168:171], v[36:39], v[112:119], v35
    v_maximum3_f32 v43, |v142|, |v143|, v43
    v_maximum3_f32 v40, |v144|, |v145|, v40
    v_maximum3_f32 v40, |v146|, |v147|, v40
    v_mfma_f32_16x16x32_bf16 v[168:171], a[144:147], v[112:115], v[168:171]
    ds_read_b64_tr_b16 a[136:137], v11 offset:49152
    ds_read_b64_tr_b16 a[138:139], v11 offset:53248
    v_mfma_f32_16x16x32_bf16 v[168:171], a[148:151], v[116:119], v[168:171]
    buffer_load_dwordx4 v1, s[60:63], s88 offen offset:3072 sc1 lds
    s_add_u32 m0, s15, 45056
    v_mfma_f32_16x16x32_bf16 v[172:175], a[148:151], v[124:127], v[172:175]
    buffer_load_dwordx4 v22, s[60:63], s88 offen sc1 lds
    s_add_u32 s88, s88, 81920
    v_mfma_f32_16x16x32_bf16 v[172:175], a[144:147], v[120:123], v[172:175]
    v_maximum3_f32 v41, |v148|, |v149|, v41
    v_maximum3_f32 v41, |v150|, |v151|, v41
    v_maximum3_f32 v42, |v152|, |v153|, v42
    v_smfmac_f32_16x16x64_bf16 a[172:175], v[36:39], v[120:127], v35
    v_maximum3_f32 v42, |v154|, |v155|, v42
    v_maximum3_f32 v43, |v156|, |v157|, v43
    v_maximum3_f32 v43, |v158|, |v159|, v43
    s_waitcnt lgkmcnt(2)
    v_mfma_f32_16x16x32_bf16 v[176:179], a[152:155], v[96:99], v[176:179]
    ds_read_b64_tr_b16 a[140:141], v11 offset:57344
    ds_read_b64_tr_b16 a[142:143], v11 offset:61440
    v_accvgpr_read_b32 v24, a160
    v_mfma_f32_16x16x32_bf16 v[176:179], a[156:159], v[100:103], v[176:179]
    v_accvgpr_read_b32 v25, a161
    v_accvgpr_read_b32 v26, a164
    v_accvgpr_read_b32 v27, a165
    v_mfma_f32_16x16x32_bf16 v[180:183], a[156:159], v[108:111], v[180:183]
    v_accvgpr_read_b32 v28, a168
    v_accvgpr_read_b32 v29, a169
    v_accvgpr_read_b32 v30, a172
    v_mfma_f32_16x16x32_bf16 v[180:183], a[152:155], v[104:107], v[180:183]
    v_accvgpr_read_b32 v31, a173
    v_add_f32 v25, v24, v25
    v_add_f32 v27, v26, v27
    v_mfma_f32_16x16x32_bf16 v[184:187], a[152:155], v[112:115], v[184:187]
    ds_read_b64_tr_b16 a[144:145], v12 offset:49152
    ds_read_b64_tr_b16 a[146:147], v12 offset:53248
    v_add_f32 v29, v28, v29
    v_mfma_f32_16x16x32_bf16 v[184:187], a[156:159], v[116:119], v[184:187]
    v_add_f32 v31, v30, v31
    v_rcp_f32 v24, v25
    v_mfma_f32_16x16x32_bf16 v[188:191], a[156:159], v[124:127], v[188:191]
    v_rcp_f32 v26, v27
    v_maximum3_f32 v40, |v160|, |v161|, v40
    v_mfma_f32_16x16x32_bf16 v[188:191], a[152:155], v[120:123], v[188:191]
    v_rcp_f32 v28, v29
    v_maximum3_f32 v40, |v162|, |v163|, v40
    s_waitcnt lgkmcnt(2)
    v_mfma_f32_16x16x32_bf16 v[192:195], a[128:131], v[96:99], v[192:195]
    ds_read_b64_tr_b16 a[148:149], v12 offset:57344
    ds_read_b64_tr_b16 a[150:151], v12 offset:61440
    v_maximum3_f32 v41, |v164|, |v165|, v41
    v_mfma_f32_16x16x32_bf16 v[192:195], a[132:135], v[100:103], v[192:195]
    v_rcp_f32 v30, v31
    v_maximum3_f32 v41, |v166|, |v167|, v41
    v_mfma_f32_16x16x32_bf16 v[196:199], a[132:135], v[108:111], v[196:199]
    v_maximum3_f32 v42, |v168|, |v169|, v42
    v_maximum3_f32 v42, |v170|, |v171|, v42
    v_maximum3_f32 v43, |v172|, |v173|, v43
    v_mfma_f32_16x16x32_bf16 v[196:199], a[128:131], v[104:107], v[196:199]
    v_maximum3_f32 v43, |v174|, |v175|, v43
    v_maximum3_f32 v40, |v176|, |v177|, v40
    v_maximum3_f32 v40, |v178|, |v179|, v40
    v_maximum3_f32 v41, |v180|, |v181|, v41
    v_maximum3_f32 v41, |v182|, |v183|, v41
    v_maximum3_f32 v42, |v184|, |v185|, v42
    v_maximum3_f32 v42, |v186|, |v187|, v42
    v_maximum3_f32 v43, |v188|, |v189|, v43
    v_maximum3_f32 v43, |v190|, |v191|, v43
    v_pk_mul_f32 v[128:129], v[128:129], v[24:25] op_sel_hi:[1,0]
    v_pk_mul_f32 v[130:131], v[130:131], v[24:25] op_sel_hi:[1,0]
    v_pk_mul_f32 v[144:145], v[144:145], v[24:25] op_sel_hi:[1,0]
    v_pk_mul_f32 v[146:147], v[146:147], v[24:25] op_sel_hi:[1,0]
    v_cvt_pk_bf16_f32 v64, v128, v129
    v_cvt_pk_bf16_f32 v65, v130, v131
    v_cvt_pk_bf16_f32 v66, v144, v145
    v_cvt_pk_bf16_f32 v67, v146, v147
    buffer_store_dwordx4 v[64:67], v1, s[28:31], 0 offen offset:0 sc1
    v_pk_mul_f32 v[160:161], v[160:161], v[24:25] op_sel_hi:[1,0]
    v_pk_mul_f32 v[162:163], v[162:163], v[24:25] op_sel_hi:[1,0]
    v_pk_mul_f32 v[176:177], v[176:177], v[24:25] op_sel_hi:[1,0]
    v_pk_mul_f32 v[178:179], v[178:179], v[24:25] op_sel_hi:[1,0]
    v_cvt_pk_bf16_f32 v68, v160, v161
    v_cvt_pk_bf16_f32 v69, v162, v163
    v_cvt_pk_bf16_f32 v70, v176, v177
    v_cvt_pk_bf16_f32 v71, v178, v179
    v_pk_mul_f32 v[132:133], v[132:133], v[26:27] op_sel_hi:[1,0]
    v_pk_mul_f32 v[134:135], v[134:135], v[26:27] op_sel_hi:[1,0]
    v_pk_mul_f32 v[148:149], v[148:149], v[26:27] op_sel_hi:[1,0]
    v_pk_mul_f32 v[150:151], v[150:151], v[26:27] op_sel_hi:[1,0]
    v_cvt_pk_bf16_f32 v72, v132, v133
    v_cvt_pk_bf16_f32 v73, v134, v135
    v_cvt_pk_bf16_f32 v74, v148, v149
    v_cvt_pk_bf16_f32 v75, v150, v151
    v_pk_mul_f32 v[164:165], v[164:165], v[26:27] op_sel_hi:[1,0]
    v_pk_mul_f32 v[166:167], v[166:167], v[26:27] op_sel_hi:[1,0]
    v_pk_mul_f32 v[180:181], v[180:181], v[26:27] op_sel_hi:[1,0]
    v_pk_mul_f32 v[182:183], v[182:183], v[26:27] op_sel_hi:[1,0]
    v_cvt_pk_bf16_f32 v76, v164, v165
    v_cvt_pk_bf16_f32 v77, v166, v167
    v_cvt_pk_bf16_f32 v78, v180, v181
    v_cvt_pk_bf16_f32 v79, v182, v183
    v_pk_mul_f32 v[136:137], v[136:137], v[28:29] op_sel_hi:[1,0]
    v_pk_mul_f32 v[138:139], v[138:139], v[28:29] op_sel_hi:[1,0]
    v_pk_mul_f32 v[152:153], v[152:153], v[28:29] op_sel_hi:[1,0]
    v_pk_mul_f32 v[154:155], v[154:155], v[28:29] op_sel_hi:[1,0]
    v_cvt_pk_bf16_f32 v80, v136, v137
    v_cvt_pk_bf16_f32 v81, v138, v139
    v_cvt_pk_bf16_f32 v82, v152, v153
    v_cvt_pk_bf16_f32 v83, v154, v155
    v_pk_mul_f32 v[168:169], v[168:169], v[28:29] op_sel_hi:[1,0]
    v_pk_mul_f32 v[170:171], v[170:171], v[28:29] op_sel_hi:[1,0]
    v_pk_mul_f32 v[184:185], v[184:185], v[28:29] op_sel_hi:[1,0]
    v_pk_mul_f32 v[186:187], v[186:187], v[28:29] op_sel_hi:[1,0]
    v_cvt_pk_bf16_f32 v84, v168, v169
    v_cvt_pk_bf16_f32 v85, v170, v171
    v_cvt_pk_bf16_f32 v86, v184, v185
    v_cvt_pk_bf16_f32 v87, v186, v187
    v_pk_mul_f32 v[140:141], v[140:141], v[30:31] op_sel_hi:[1,0]
    v_pk_mul_f32 v[142:143], v[142:143], v[30:31] op_sel_hi:[1,0]
    v_pk_mul_f32 v[156:157], v[156:157], v[30:31] op_sel_hi:[1,0]
    v_pk_mul_f32 v[158:159], v[158:159], v[30:31] op_sel_hi:[1,0]
    v_cvt_pk_bf16_f32 v88, v140, v141
    v_cvt_pk_bf16_f32 v89, v142, v143
    v_cvt_pk_bf16_f32 v90, v156, v157
    v_cvt_pk_bf16_f32 v91, v158, v159
    v_pk_mul_f32 v[172:173], v[172:173], v[30:31] op_sel_hi:[1,0]
    v_pk_mul_f32 v[174:175], v[174:175], v[30:31] op_sel_hi:[1,0]
    v_pk_mul_f32 v[188:189], v[188:189], v[30:31] op_sel_hi:[1,0]
    v_pk_mul_f32 v[190:191], v[190:191], v[30:31] op_sel_hi:[1,0]
    v_cvt_pk_bf16_f32 v92, v172, v173
    v_cvt_pk_bf16_f32 v93, v174, v175
    v_cvt_pk_bf16_f32 v94, v188, v189
    v_cvt_pk_bf16_f32 v95, v190, v191
    v_mfma_f32_16x16x32_bf16 v[200:203], a[128:131], v[112:115], v[200:203]
    ds_read_b64_tr_b16 a[152:153], v13 offset:49152
    ds_read_b64_tr_b16 a[154:155], v13 offset:53248
    v_maximum3_f32 v40, |v192|, |v193|, v40
    v_mfma_f32_16x16x32_bf16 v[200:203], a[132:135], v[116:119], v[200:203]
    v_maximum3_f32 v40, |v194|, |v195|, v40
    v_maximum3_f32 v41, |v196|, |v197|, v41
    v_maximum3_f32 v41, |v198|, |v199|, v41
    v_mfma_f32_16x16x32_bf16 v[204:207], a[132:135], v[124:127], v[204:207]
    v_mfma_f32_16x16x32_bf16 v[204:207], a[128:131], v[120:123], v[204:207]
    s_waitcnt lgkmcnt(2)
    v_mfma_f32_16x16x32_bf16 v[208:211], a[136:139], v[96:99], v[208:211]
    ds_read_b64_tr_b16 a[156:157], v13 offset:57344
    ds_read_b64_tr_b16 a[158:159], v13 offset:61440
    v_maximum3_f32 v42, |v200|, |v201|, v42
    v_mfma_f32_16x16x32_bf16 v[208:211], a[140:143], v[100:103], v[208:211]
    v_maximum3_f32 v42, |v202|, |v203|, v42
    v_mfma_f32_16x16x32_bf16 v[212:215], a[140:143], v[108:111], v[212:215]
    v_maximum3_f32 v43, |v204|, |v205|, v43
    v_maximum3_f32 v43, |v206|, |v207|, v43
    v_mfma_f32_16x16x32_bf16 v[212:215], a[136:139], v[104:107], v[212:215]
    v_mfma_f32_16x16x32_bf16 v[216:219], a[136:139], v[112:115], v[216:219]
    v_mfma_f32_16x16x32_bf16 v[216:219], a[140:143], v[116:119], v[216:219]
    v_mfma_f32_16x16x32_bf16 v[220:223], a[140:143], v[124:127], v[220:223]
    v_maximum3_f32 v40, |v208|, |v209|, v40
    v_maximum3_f32 v40, |v210|, |v211|, v40
    v_mfma_f32_16x16x32_bf16 v[220:223], a[136:139], v[120:123], v[220:223]
    s_waitcnt lgkmcnt(0)
    v_mfma_f32_16x16x32_bf16 v[224:227], a[144:147], v[96:99], v[224:227]
    buffer_store_dwordx4 v[68:71], v1, s[28:31], 0 offen offset:1024 sc1
    v_mfma_f32_16x16x32_bf16 v[224:227], a[148:151], v[100:103], v[224:227]
    v_maximum3_f32 v41, |v212|, |v213|, v41
    v_maximum3_f32 v41, |v214|, |v215|, v41
    v_maximum3_f32 v42, |v216|, |v217|, v42
    v_mfma_f32_16x16x32_bf16 v[228:231], a[148:151], v[108:111], v[228:231]
    v_maximum3_f32 v42, |v218|, |v219|, v42
    v_maximum3_f32 v43, |v220|, |v221|, v43
    v_maximum3_f32 v43, |v222|, |v223|, v43
    v_mfma_f32_16x16x32_bf16 v[228:231], a[144:147], v[104:107], v[228:231]
    v_mfma_f32_16x16x32_bf16 v[232:235], a[144:147], v[112:115], v[232:235]
    v_maximum3_f32 v40, |v224|, |v225|, v40
    v_maximum3_f32 v40, |v226|, |v227|, v40
    v_mfma_f32_16x16x32_bf16 v[232:235], a[148:151], v[116:119], v[232:235]
    v_mfma_f32_16x16x32_bf16 v[236:239], a[148:151], v[124:127], v[236:239]
    v_mfma_f32_16x16x32_bf16 v[236:239], a[144:147], v[120:123], v[236:239]
    s_waitcnt lgkmcnt(0)
    v_mfma_f32_16x16x32_bf16 v[240:243], a[152:155], v[96:99], v[240:243]
    v_maximum3_f32 v41, |v228|, |v229|, v41
    v_maximum3_f32 v41, |v230|, |v231|, v41
    v_mfma_f32_16x16x32_bf16 v[240:243], a[156:159], v[100:103], v[240:243]
    v_mfma_f32_16x16x32_bf16 v[244:247], a[156:159], v[108:111], v[244:247]
    v_maximum3_f32 v42, |v232|, |v233|, v42
    v_maximum3_f32 v42, |v234|, |v235|, v42
    v_maximum3_f32 v43, |v236|, |v237|, v43
    v_mfma_f32_16x16x32_bf16 v[244:247], a[152:155], v[104:107], v[244:247]
    v_maximum3_f32 v43, |v238|, |v239|, v43
    v_mfma_f32_16x16x32_bf16 v[248:251], a[152:155], v[112:115], v[248:251]
    v_mfma_f32_16x16x32_bf16 v[248:251], a[156:159], v[116:119], v[248:251]
    buffer_store_dwordx4 v[72:75], v1, s[28:31], 0 offen offset:2048 sc1
    v_mfma_f32_16x16x32_bf16 v[252:255], a[156:159], v[124:127], v[252:255]
    v_maximum3_f32 v40, |v240|, |v241|, v40
    v_maximum3_f32 v40, |v242|, |v243|, v40
    v_mfma_f32_16x16x32_bf16 v[252:255], a[152:155], v[120:123], v[252:255]
    v_maximum3_f32 v41, |v244|, |v245|, v41
    v_maximum3_f32 v41, |v246|, |v247|, v41
    s_waitcnt lgkmcnt(0)
    v_maximum3_f32 v42, |v248|, |v249|, v42
    v_maximum3_f32 v42, |v250|, |v251|, v42
    s_nop 0
    s_nop 0
    s_nop 0
    v_maximum3_f32 v43, |v252|, |v253|, v43
    v_maximum3_f32 v43, |v254|, |v255|, v43
    v_maximum3_f32 v58, v40, v41, v42
    v_minimum3_f32 v59, v40, v41, v42
    v_maximum3_f32 v58, v58, v43, v25
    v_minimum3_f32 v59, v59, v43, v43
    v_maximum3_f32 v58, v58, v27, v29
    v_cmp_nle_f32 vcc, 0x08800000, v59
    v_maximum3_f32 v58, v58, v31, v31
    s_mov_b64 s[4:5], vcc
    v_cmp_nge_f32 vcc, 0x7b800000, v58
    s_lshl_b32 s7, s76, 2
    s_add_u32 s7, s7, 163824
    s_or_b64 s[4:5], s[4:5], vcc
    s_or_b32 s4, s4, s5
    v_mov_b32 v59, s7
    v_mov_b32 v58, s4
    ds_write_b32 v59, v58
    v_mov_b32 v59, 163824
    s_waitcnt lgkmcnt(0)
    s_waitcnt vmcnt(26)
    s_barrier
    ds_read_b128 v[60:63], v59
    ds_read_b128 a[104:107], v53 offset:0
    ds_read_b128 a[108:111], v53 offset:1024
    ds_read_b128 a[72:75], v48 offset:0
    ds_read_b128 a[76:79], v48 offset:1024
    ds_read_b128 a[80:83], v49 offset:0
    ds_read_b128 a[84:87], v49 offset:1024
    ds_read_b128 a[88:91], v50 offset:0
    ds_read_b128 a[92:95], v50 offset:1024
    ds_read_b128 a[96:99], v51 offset:0
    ds_read_b128 a[100:103], v51 offset:1024
    ds_read_b128 a[112:115], v53 offset:2048
    ds_read_b128 a[116:119], v53 offset:3072
    ds_read_b128 a[120:123], v53 offset:4096
    ds_read_b128 a[124:127], v53 offset:5120
    ds_read_b128 a[128:131], v53 offset:6144
    ds_read_b128 a[132:135], v53 offset:7168
    ds_read_b128 a[136:139], v53 offset:8192
    ds_read_b128 a[140:143], v53 offset:9216
    v_pk_mul_f32 v[192:193], v[192:193], v[24:25] op_sel_hi:[1,0]
    v_pk_mul_f32 v[194:195], v[194:195], v[24:25] op_sel_hi:[1,0]
    v_pk_mul_f32 v[208:209], v[208:209], v[24:25] op_sel_hi:[1,0]
    v_pk_mul_f32 v[210:211], v[210:211], v[24:25] op_sel_hi:[1,0]
    v_cvt_pk_bf16_f32 v96, v192, v193
    v_cvt_pk_bf16_f32 v97, v194, v195
    v_cvt_pk_bf16_f32 v98, v208, v209
    v_cvt_pk_bf16_f32 v99, v210, v211
    buffer_store_dwordx4 v[76:79], v1, s[28:31], 0 offen offset:3072 sc1
    v_pk_mul_f32 v[224:225], v[224:225], v[24:25] op_sel_hi:[1,0]
    v_pk_mul_f32 v[226:227], v[226:227], v[24:25] op_sel_hi:[1,0]
    v_pk_mul_f32 v[240:241], v[240:241], v[24:25] op_sel_hi:[1,0]
    v_pk_mul_f32 v[242:243], v[242:243], v[24:25] op_sel_hi:[1,0]
    v_cvt_pk_bf16_f32 v100, v224, v225
    v_cvt_pk_bf16_f32 v101, v226, v227
    v_cvt_pk_bf16_f32 v102, v240, v241
    v_cvt_pk_bf16_f32 v103, v242, v243
    v_pk_mul_f32 v[196:197], v[196:197], v[26:27] op_sel_hi:[1,0]
    v_pk_mul_f32 v[198:199], v[198:199], v[26:27] op_sel_hi:[1,0]
    v_pk_mul_f32 v[212:213], v[212:213], v[26:27] op_sel_hi:[1,0]
    v_pk_mul_f32 v[214:215], v[214:215], v[26:27] op_sel_hi:[1,0]
    v_cvt_pk_bf16_f32 v104, v196, v197
    v_cvt_pk_bf16_f32 v105, v198, v199
    v_cvt_pk_bf16_f32 v106, v212, v213
    v_cvt_pk_bf16_f32 v107, v214, v215
    v_pk_mul_f32 v[228:229], v[228:229], v[26:27] op_sel_hi:[1,0]
    v_pk_mul_f32 v[230:231], v[230:231], v[26:27] op_sel_hi:[1,0]
    v_pk_mul_f32 v[244:245], v[244:245], v[26:27] op_sel_hi:[1,0]
    v_pk_mul_f32 v[246:247], v[246:247], v[26:27] op_sel_hi:[1,0]
    v_cvt_pk_bf16_f32 v108, v228, v229
    v_cvt_pk_bf16_f32 v109, v230, v231
    v_cvt_pk_bf16_f32 v110, v244, v245
    v_cvt_pk_bf16_f32 v111, v246, v247
    v_pk_mul_f32 v[200:201], v[200:201], v[28:29] op_sel_hi:[1,0]
    v_pk_mul_f32 v[202:203], v[202:203], v[28:29] op_sel_hi:[1,0]
    v_pk_mul_f32 v[216:217], v[216:217], v[28:29] op_sel_hi:[1,0]
    v_pk_mul_f32 v[218:219], v[218:219], v[28:29] op_sel_hi:[1,0]
    v_cvt_pk_bf16_f32 v112, v200, v201
    v_cvt_pk_bf16_f32 v113, v202, v203
    v_cvt_pk_bf16_f32 v114, v216, v217
    v_cvt_pk_bf16_f32 v115, v218, v219
    v_pk_mul_f32 v[232:233], v[232:233], v[28:29] op_sel_hi:[1,0]
    v_pk_mul_f32 v[234:235], v[234:235], v[28:29] op_sel_hi:[1,0]
    v_pk_mul_f32 v[248:249], v[248:249], v[28:29] op_sel_hi:[1,0]
    v_pk_mul_f32 v[250:251], v[250:251], v[28:29] op_sel_hi:[1,0]
    v_cvt_pk_bf16_f32 v116, v232, v233
    v_cvt_pk_bf16_f32 v117, v234, v235
    v_cvt_pk_bf16_f32 v118, v248, v249
    v_cvt_pk_bf16_f32 v119, v250, v251
    buffer_store_dwordx4 v[80:83], v22, s[28:31], 0 offen offset:0 sc1
    v_pk_mul_f32 v[204:205], v[204:205], v[30:31] op_sel_hi:[1,0]
    v_pk_mul_f32 v[206:207], v[206:207], v[30:31] op_sel_hi:[1,0]
    v_pk_mul_f32 v[220:221], v[220:221], v[30:31] op_sel_hi:[1,0]
    v_pk_mul_f32 v[222:223], v[222:223], v[30:31] op_sel_hi:[1,0]
    v_cvt_pk_bf16_f32 v120, v204, v205
    v_cvt_pk_bf16_f32 v121, v206, v207
    v_cvt_pk_bf16_f32 v122, v220, v221
    v_cvt_pk_bf16_f32 v123, v222, v223
    v_pk_mul_f32 v[236:237], v[236:237], v[30:31] op_sel_hi:[1,0]
    v_pk_mul_f32 v[238:239], v[238:239], v[30:31] op_sel_hi:[1,0]
    v_pk_mul_f32 v[252:253], v[252:253], v[30:31] op_sel_hi:[1,0]
    v_pk_mul_f32 v[254:255], v[254:255], v[30:31] op_sel_hi:[1,0]
    v_cvt_pk_bf16_f32 v124, v236, v237
    v_cvt_pk_bf16_f32 v125, v238, v239
    v_cvt_pk_bf16_f32 v126, v252, v253
    v_cvt_pk_bf16_f32 v127, v254, v255
    s_waitcnt lgkmcnt(15)
    v_or_b32 v60, v60, v61
    v_or3_b32 v60, v60, v62, v63
    s_nop 0
    v_readfirstlane_b32 s4, v60
    s_andn2_b32 s4, s4, s82
    s_cbranch_scc1 M_fallback
    s_waitcnt lgkmcnt(0)
    s_waitcnt vmcnt(19)
    s_barrier
    v_mfma_f32_16x16x32_bf16 v[128:131], a[104:107], a[72:75], 0
    s_mov_b32 m0, s75
    ds_read_b128 a[32:35], v52 offset:0
    v_mfma_f32_16x16x32_bf16 v[128:131], a[108:111], a[76:79], v[128:131]
    buffer_load_dwordx4 v1, s[56:59], s87 offen offset:0 sc1 lds
    v_mfma_f32_16x16x32_bf16 v[132:135], a[108:111], a[84:87], 0
    ds_read_b128 a[36:39], v52 offset:1024
    v_mfma_f32_16x16x32_bf16 v[132:135], a[104:107], a[80:83], v[132:135]
    buffer_store_dwordx4 v[84:87], v22, s[28:31], 0 offen offset:1024 sc1
    v_mfma_f32_16x16x32_bf16 v[136:139], a[104:107], a[88:91], 0
    ds_read_b128 a[0:3], v48 offset:16384
    v_mfma_f32_16x16x32_bf16 v[136:139], a[108:111], a[92:95], v[136:139]
    buffer_load_dwordx4 v1, s[56:59], s87 offen offset:1024 sc1 lds
    v_mfma_f32_16x16x32_bf16 v[140:143], a[108:111], a[100:103], 0
    ds_read_b128 a[4:7], v48 offset:17408
    v_mfma_f32_16x16x32_bf16 v[140:143], a[104:107], a[96:99], v[140:143]
    buffer_load_dwordx4 v1, s[56:59], s87 offen offset:2048 sc1 lds
    v_mfma_f32_16x16x32_bf16 v[156:159], a[112:115], a[96:99], 0
    ds_read_b128 a[8:11], v49 offset:16384
    v_mfma_f32_16x16x32_bf16 v[156:159], a[116:119], a[100:103], v[156:159]
    buffer_load_dwordx4 v1, s[56:59], s87 offen offset:3072 sc1 lds
    v_mfma_f32_16x16x32_bf16 v[152:155], a[116:119], a[92:95], 0
    s_add_u32 s87, s87, 8192
    ds_read_b128 a[12:15], v49 offset:17408
    s_add_u32 m0, s15, 139264
    v_mfma_f32_16x16x32_bf16 v[152:155], a[112:115], a[88:91], v[152:155]
    buffer_load_dwordx4 v1, s[60:63], s88 offen offset:0 sc1 lds
    v_mfma_f32_16x16x32_bf16 v[148:151], a[112:115], a[80:83], 0
    ds_read_b128 a[16:19], v50 offset:16384
    v_mfma_f32_16x16x32_bf16 v[148:151], a[116:119], a[84:87], v[148:151]
    buffer_store_dwordx4 v[88:91], v22, s[28:31], 0 offen offset:2048 sc1
    v_mfma_f32_16x16x32_bf16 v[144:147], a[116:119], a[76:79], 0
    ds_read_b128 a[20:23], v50 offset:17408
    v_mfma_f32_16x16x32_bf16 v[144:147], a[112:115], a[72:75], v[144:147]
    buffer_load_dwordx4 v1, s[60:63], s88 offen offset:1024 sc1 lds
    v_mfma_f32_16x16x32_bf16 v[160:163], a[120:123], a[72:75], 0
    ds_read_b128 a[24:27], v51 offset:16384
    v_mfma_f32_16x16x32_bf16 v[160:163], a[124:127], a[76:79], v[160:163]
    buffer_load_dwordx4 v1, s[60:63], s88 offen offset:2048 sc1 lds
    v_mfma_f32_16x16x32_bf16 v[164:167], a[124:127], a[84:87], 0
    ds_read_b128 a[28:31], v51 offset:17408
    v_mfma_f32_16x16x32_bf16 v[164:167], a[120:123], a[80:83], v[164:167]
    buffer_load_dwordx4 v1, s[60:63], s88 offen offset:3072 sc1 lds
    v_mfma_f32_16x16x32_bf16 v[168:171], a[120:123], a[88:91], 0
    s_add_u32 m0, s15, 143360
    ds_read_b128 a[40:43], v52 offset:2048
    v_mfma_f32_16x16x32_bf16 v[168:171], a[124:127], a[92:95], v[168:171]
    buffer_load_dwordx4 v22, s[60:63], s88 offen sc1 lds
    v_mfma_f32_16x16x32_bf16 v[172:175], a[124:127], a[100:103], 0
    ds_read_b128 a[44:47], v52 offset:3072
    v_mfma_f32_16x16x32_bf16 v[172:175], a[120:123], a[96:99], v[172:175]
    buffer_store_dwordx4 v[92:95], v22, s[28:31], 0 offen offset:3072 sc1
    v_mfma_f32_16x16x32_bf16 v[188:191], a[128:131], a[96:99], 0
    s_add_u32 s88, s88, 81920
    ds_read_b128 a[48:51], v52 offset:4096
    s_mov_b32 m0, s72
    v_mfma_f32_16x16x32_bf16 v[188:191], a[132:135], a[100:103], v[188:191]
    buffer_load_dwordx4 v1, s[56:59], s87 offen offset:0 sc1 lds
    v_mfma_f32_16x16x32_bf16 v[184:187], a[132:135], a[92:95], 0
    ds_read_b128 a[52:55], v52 offset:5120
    v_mfma_f32_16x16x32_bf16 v[184:187], a[128:131], a[88:91], v[184:187]
    buffer_load_dwordx4 v1, s[56:59], s87 offen offset:1024 sc1 lds
    v_mfma_f32_16x16x32_bf16 v[180:183], a[128:131], a[80:83], 0
    ds_read_b128 a[56:59], v52 offset:6144
    v_mfma_f32_16x16x32_bf16 v[180:183], a[132:135], a[84:87], v[180:183]
    buffer_load_dwordx4 v1, s[56:59], s87 offen offset:2048 sc1 lds
    v_mfma_f32_16x16x32_bf16 v[176:179], a[132:135], a[76:79], 0
    ds_read_b128 a[60:63], v52 offset:7168
    v_mfma_f32_16x16x32_bf16 v[176:179], a[128:131], a[72:75], v[176:179]
    buffer_load_dwordx4 v1, s[56:59], s87 offen offset:3072 sc1 lds
    v_mfma_f32_16x16x32_bf16 v[192:195], a[136:139], a[72:75], 0
    s_add_u32 s87, s87, 8192
    ds_read_b128 a[64:67], v52 offset:8192
    v_and_b32 v12, 255, v1
    v_mfma_f32_16x16x32_bf16 v[192:195], a[140:143], a[76:79], v[192:195]
    v_mul_u32_u24 v12, 10, v12
    v_lshrrev_b32 v13, 8, v1
    v_mfma_f32_16x16x32_bf16 v[196:199], a[140:143], a[84:87], 0
    ds_read_b128 a[68:71], v52 offset:9216
    v_lshl_add_u32 v12, v13, 3, v12
    v_mfma_f32_16x16x32_bf16 v[196:199], a[136:139], a[80:83], v[196:199]
    v_add_u32 v46, s75, v12
    v_lshrrev_b32 v45, 1, v1
    v_mfma_f32_16x16x32_bf16 v[200:203], a[136:139], a[88:91], 0
    v_add_u32 v14, 8192, v1
    v_add_u32 v15, 8192, v45
    v_mfma_f32_16x16x32_bf16 v[200:203], a[140:143], a[92:95], v[200:203]
    v_mov_b32 v47, 0x100
    v_and_b32 v12, 255, v1
    v_mfma_f32_16x16x32_bf16 v[204:207], a[140:143], a[100:103], 0
    v_mul_u32_u24 v12, 11, v12
    v_lshl_add_u32 v12, v13, 3, v12
    v_mfma_f32_16x16x32_bf16 v[204:207], a[136:139], a[96:99], v[204:207]
    v_add_u32 v24, s68, v12
    v_lshrrev_b32 v18, 4, v1
    s_waitcnt lgkmcnt(0)
    s_waitcnt vmcnt(26)
    s_barrier
    v_mfma_f32_16x16x32_bf16 v[128:131], a[32:35], a[0:3], v[128:131]
    s_add_u32 m0, s15, 0
    ds_read_b128 a[104:107], v52 offset:20480
    v_mfma_f32_16x16x32_bf16 v[128:131], a[36:39], a[4:7], v[128:131]
    buffer_load_dwordx4 v1, s[60:63], s88 offen offset:0 sc1 lds
    v_mfma_f32_16x16x32_bf16 v[132:135], a[36:39], a[12:15], v[132:135]
    ds_read_b128 a[108:111], v52 offset:21504
    v_mfma_f32_16x16x32_bf16 v[132:135], a[32:35], a[8:11], v[132:135]
    buffer_store_dwordx4 v[96:99], v1, s[28:31], s6 offen offset:0 sc1
    v_mfma_f32_16x16x32_bf16 v[136:139], a[32:35], a[16:19], v[136:139]
    ds_read_b128 a[72:75], v48 offset:32768
    v_mfma_f32_16x16x32_bf16 v[136:139], a[36:39], a[20:23], v[136:139]
    buffer_load_dwordx4 v1, s[60:63], s88 offen offset:1024 sc1 lds
    v_mfma_f32_16x16x32_bf16 v[140:143], a[36:39], a[28:31], v[140:143]
    ds_read_b128 a[76:79], v48 offset:33792
    v_mfma_f32_16x16x32_bf16 v[140:143], a[32:35], a[24:27], v[140:143]
    buffer_load_dwordx4 v1, s[60:63], s88 offen offset:2048 sc1 lds
    v_mfma_f32_16x16x32_bf16 v[156:159], a[40:43], a[24:27], v[156:159]
    ds_read_b128 a[80:83], v49 offset:32768
    v_mfma_f32_16x16x32_bf16 v[156:159], a[44:47], a[28:31], v[156:159]
    buffer_load_dwordx4 v1, s[60:63], s88 offen offset:3072 sc1 lds
    v_mfma_f32_16x16x32_bf16 v[152:155], a[44:47], a[20:23], v[152:155]
    ds_read_b128 a[84:87], v49 offset:33792
    v_mfma_f32_16x16x32_bf16 v[152:155], a[40:43], a[16:19], v[152:155]
    buffer_store_dwordx4 v[100:103], v1, s[28:31], s6 offen offset:1024 sc1
    v_mfma_f32_16x16x32_bf16 v[148:151], a[40:43], a[8:11], v[148:151]
    s_add_u32 m0, s15, 4096
    ds_read_b128 a[88:91], v50 offset:32768
    v_mfma_f32_16x16x32_bf16 v[148:151], a[44:47], a[12:15], v[148:151]
    buffer_load_dwordx4 v22, s[60:63], s88 offen sc1 lds
    v_mfma_f32_16x16x32_bf16 v[144:147], a[44:47], a[4:7], v[144:147]
    s_add_u32 s88, s88, 81920
    ds_read_b128 a[92:95], v50 offset:33792
    s_mov_b32 m0, s73
    v_mfma_f32_16x16x32_bf16 v[144:147], a[40:43], a[0:3], v[144:147]
    buffer_load_dwordx4 v1, s[56:59], s87 offen offset:0 sc1 lds
    v_mfma_f32_16x16x32_bf16 v[160:163], a[48:51], a[0:3], v[160:163]
    ds_read_b128 a[96:99], v51 offset:32768
    v_mfma_f32_16x16x32_bf16 v[160:163], a[52:55], a[4:7], v[160:163]
    buffer_load_dwordx4 v1, s[56:59], s87 offen offset:1024 sc1 lds
    v_mfma_f32_16x16x32_bf16 v[164:167], a[52:55], a[12:15], v[164:167]
    ds_read_b128 a[100:103], v51 offset:33792
    v_mfma_f32_16x16x32_bf16 v[164:167], a[48:51], a[8:11], v[164:167]
    buffer_store_dwordx4 v[104:107], v1, s[28:31], s6 offen offset:2048 sc1
    v_mfma_f32_16x16x32_bf16 v[168:171], a[48:51], a[16:19], v[168:171]
    ds_read_b128 a[112:115], v52 offset:22528
    v_mfma_f32_16x16x32_bf16 v[168:171], a[52:55], a[20:23], v[168:171]
    buffer_load_dwordx4 v1, s[56:59], s87 offen offset:2048 sc1 lds
    v_mfma_f32_16x16x32_bf16 v[172:175], a[52:55], a[28:31], v[172:175]
    ds_read_b128 a[116:119], v52 offset:23552
    v_mfma_f32_16x16x32_bf16 v[172:175], a[48:51], a[24:27], v[172:175]
    buffer_load_dwordx4 v1, s[56:59], s87 offen offset:3072 sc1 lds
    v_mfma_f32_16x16x32_bf16 v[188:191], a[56:59], a[24:27], v[188:191]
    s_add_u32 s87, s87, 8192
    ds_read_b128 a[120:123], v52 offset:24576
    v_mul_u32_u24 v12, 6554, v18
    v_mfma_f32_16x16x32_bf16 v[188:191], a[60:63], a[28:31], v[188:191]
    v_lshrrev_b32 v12, 16, v12
    v_lshlrev_b32 v13, 4, v18
    v_mfma_f32_16x16x32_bf16 v[184:187], a[60:63], a[20:23], v[184:187]
    ds_read_b128 a[124:127], v52 offset:25600
    v_lshl_add_u32 v25, v12, 4, v13
    v_mfma_f32_16x16x32_bf16 v[184:187], a[56:59], a[16:19], v[184:187]
    v_add_u32 v25, s68, v25
    v_mul_u32_u24 v19, 1120, v12
    v_mfma_f32_16x16x32_bf16 v[180:183], a[56:59], a[8:11], v[180:183]
    ds_read_b128 a[128:131], v52 offset:26624
    v_add_u32 v28, v19, v13
    v_mfma_f32_16x16x32_bf16 v[180:183], a[60:63], a[12:15], v[180:183]
    v_add_u32 v18, 64, v18
    v_mul_u32_u24 v12, 6554, v18
    v_mfma_f32_16x16x32_bf16 v[176:179], a[60:63], a[4:7], v[176:179]
    ds_read_b128 a[132:135], v52 offset:27648
    v_lshrrev_b32 v12, 16, v12
    v_mfma_f32_16x16x32_bf16 v[176:179], a[56:59], a[0:3], v[176:179]
    v_lshlrev_b32 v13, 4, v18
    v_lshl_add_u32 v26, v12, 4, v13
    v_mfma_f32_16x16x32_bf16 v[192:195], a[64:67], a[0:3], v[192:195]
    ds_read_b128 a[136:139], v52 offset:28672
    v_add_u32 v26, s68, v26
    v_mfma_f32_16x16x32_bf16 v[192:195], a[68:71], a[4:7], v[192:195]
    v_mul_u32_u24 v19, 1120, v12
    v_add_u32 v29, v19, v13
    v_mfma_f32_16x16x32_bf16 v[196:199], a[68:71], a[12:15], v[196:199]
    ds_read_b128 a[140:143], v52 offset:29696
    v_add_u32 v18, 64, v18
    v_mfma_f32_16x16x32_bf16 v[196:199], a[64:67], a[8:11], v[196:199]
    v_mul_u32_u24 v12, 6554, v18
    v_lshrrev_b32 v12, 16, v12
    v_mfma_f32_16x16x32_bf16 v[200:203], a[64:67], a[16:19], v[200:203]
    v_lshlrev_b32 v13, 4, v18
    v_lshl_add_u32 v27, v12, 4, v13
    v_mfma_f32_16x16x32_bf16 v[200:203], a[68:71], a[20:23], v[200:203]
    v_add_u32 v27, s68, v27
    v_mul_u32_u24 v19, 1120, v12
    v_mfma_f32_16x16x32_bf16 v[204:207], a[68:71], a[28:31], v[204:207]
    v_add_u32 v30, v19, v13
    v_lshrrev_b32 v12, 4, v12
    v_mfma_f32_16x16x32_bf16 v[204:207], a[64:67], a[24:27], v[204:207]
    v_lshl_add_u32 v30, v12, 24, v30
    s_bfe_u32 s4, s2, 0x20001
    s_waitcnt lgkmcnt(0)
    s_waitcnt vmcnt(16)
    s_barrier
    v_mfma_f32_16x16x32_bf16 v[128:131], a[104:107], a[72:75], v[128:131]
    ds_read_b128 a[32:35], v52 offset:40960
    v_mfma_f32_16x16x32_bf16 v[128:131], a[108:111], a[76:79], v[128:131]
    buffer_atomic_add v32, v33, s[40:43], s94 offen
    v_mfma_f32_16x16x32_bf16 v[132:135], a[108:111], a[84:87], v[132:135]
    s_add_u32 m0, s15, 20480
    ds_read_b128 a[36:39], v52 offset:41984
    v_mfma_f32_16x16x32_bf16 v[132:135], a[104:107], a[80:83], v[132:135]
    buffer_load_dwordx4 v1, s[60:63], s88 offen offset:0 sc1 lds
    v_mfma_f32_16x16x32_bf16 v[136:139], a[104:107], a[88:91], v[136:139]
    ds_read_b128 a[0:3], v48 offset:49152
    v_mfma_f32_16x16x32_bf16 v[136:139], a[108:111], a[92:95], v[136:139]
    buffer_store_dwordx4 v[108:111], v1, s[28:31], s6 offen offset:3072 sc1
    v_mfma_f32_16x16x32_bf16 v[140:143], a[108:111], a[100:103], v[140:143]
    ds_read_b128 a[4:7], v48 offset:50176
    v_mfma_f32_16x16x32_bf16 v[140:143], a[104:107], a[96:99], v[140:143]
    buffer_load_dwordx4 v1, s[60:63], s88 offen offset:1024 sc1 lds
    v_mfma_f32_16x16x32_bf16 v[156:159], a[112:115], a[96:99], v[156:159]
    ds_read_b128 a[8:11], v49 offset:49152
    v_mfma_f32_16x16x32_bf16 v[156:159], a[116:119], a[100:103], v[156:159]
    buffer_load_dwordx4 v1, s[60:63], s88 offen offset:2048 sc1 lds
    v_mfma_f32_16x16x32_bf16 v[152:155], a[116:119], a[92:95], v[152:155]
    ds_read_b128 a[12:15], v49 offset:50176
    v_mfma_f32_16x16x32_bf16 v[152:155], a[112:115], a[88:91], v[152:155]
    buffer_load_dwordx4 v1, s[60:63], s88 offen offset:3072 sc1 lds
    v_mfma_f32_16x16x32_bf16 v[148:151], a[112:115], a[80:83], v[148:151]
    ds_read_b128 a[16:19], v50 offset:49152
    v_mfma_f32_16x16x32_bf16 v[148:151], a[116:119], a[84:87], v[148:151]
    buffer_store_dwordx4 v[112:115], v22, s[28:31], s6 offen offset:0 sc1
    v_mfma_f32_16x16x32_bf16 v[144:147], a[116:119], a[76:79], v[144:147]
    s_add_u32 m0, s15, 24576
    ds_read_b128 a[20:23], v50 offset:50176
    v_mfma_f32_16x16x32_bf16 v[144:147], a[112:115], a[72:75], v[144:147]
    buffer_load_dwordx4 v22, s[60:63], s88 offen sc1 lds
    v_mfma_f32_16x16x32_bf16 v[160:163], a[120:123], a[72:75], v[160:163]
    s_add_u32 s88, s88, 81920
    ds_read_b128 a[24:27], v51 offset:49152
    s_mov_b32 m0, s74
    v_mfma_f32_16x16x32_bf16 v[160:163], a[124:127], a[76:79], v[160:163]
    buffer_load_dwordx4 v1, s[56:59], s87 offen offset:0 sc1 lds
    v_mfma_f32_16x16x32_bf16 v[164:167], a[124:127], a[84:87], v[164:167]
    ds_read_b128 a[28:31], v51 offset:50176
    v_mfma_f32_16x16x32_bf16 v[164:167], a[120:123], a[80:83], v[164:167]
    buffer_load_dwordx4 v1, s[56:59], s87 offen offset:1024 sc1 lds
    v_mfma_f32_16x16x32_bf16 v[168:171], a[120:123], a[88:91], v[168:171]
    ds_read_b128 a[40:43], v52 offset:43008
    v_mfma_f32_16x16x32_bf16 v[168:171], a[124:127], a[92:95], v[168:171]
    buffer_store_dwordx4 v[116:119], v22, s[28:31], s6 offen offset:1024 sc1
    v_mfma_f32_16x16x32_bf16 v[172:175], a[124:127], a[100:103], v[172:175]
    ds_read_b128 a[44:47], v52 offset:44032
    v_mfma_f32_16x16x32_bf16 v[172:175], a[120:123], a[96:99], v[172:175]
    buffer_load_dwordx4 v1, s[56:59], s87 offen offset:2048 sc1 lds
    v_mfma_f32_16x16x32_bf16 v[188:191], a[128:131], a[96:99], v[188:191]
    ds_read_b128 a[48:51], v52 offset:45056
    v_mfma_f32_16x16x32_bf16 v[188:191], a[132:135], a[100:103], v[188:191]
    buffer_load_dwordx4 v1, s[56:59], s87 offen offset:3072 sc1 lds
    v_mfma_f32_16x16x32_bf16 v[184:187], a[132:135], a[92:95], v[184:187]
    s_add_u32 s87, s87, 8192
    ds_read_b128 a[52:55], v52 offset:46080
    v_lshrrev_b32 v12, 4, v1
    v_mfma_f32_16x16x32_bf16 v[184:187], a[128:131], a[88:91], v[184:187]
    v_lshlrev_b32 v17, v12, v32
    v_add_u32 v13, 1, v12
    v_mfma_f32_16x16x32_bf16 v[180:183], a[128:131], a[80:83], v[180:183]
    ds_read_b128 a[56:59], v52 offset:47104
    v_xor_b32 v16, s4, v13
    v_mfma_f32_16x16x32_bf16 v[180:183], a[132:135], a[84:87], v[180:183]
    v_lshl_add_u32 v16, v16, 2, 4
    v_lshrrev_b32 v13, 2, v13
    v_mfma_f32_16x16x32_bf16 v[176:179], a[132:135], a[76:79], v[176:179]
    ds_read_b128 a[60:63], v52 offset:48128
    v_add_u32 v13, s76, v13
    v_mfma_f32_16x16x32_bf16 v[176:179], a[128:131], a[72:75], v[176:179]
    v_lshl_add_u32 v16, v13, 24, v16
    s_lshl_b32 s4, s4, 2
    v_mfma_f32_16x16x32_bf16 v[192:195], a[136:139], a[72:75], v[192:195]
    s_add_u32 s92, s4, s13
    ds_read_b128 a[64:67], v52 offset:49152
    s_add_u32 s92, s92, 4
    v_mfma_f32_16x16x32_bf16 v[192:195], a[140:143], a[76:79], v[192:195]
    v_mov_b32 v12, 0x3f80
    v_mov_b32 v13, 0x3f800000
    v_mfma_f32_16x16x32_bf16 v[196:199], a[140:143], a[84:87], v[196:199]
    ds_read_b128 a[68:71], v52 offset:50176
    v_mfma_f32_16x16x32_bf16 v[196:199], a[136:139], a[80:83], v[196:199]
    v_mfma_f32_16x16x32_bf16 v[200:203], a[136:139], a[88:91], v[200:203]
    v_mfma_f32_16x16x32_bf16 v[200:203], a[140:143], a[92:95], v[200:203]
    v_mfma_f32_16x16x32_bf16 v[204:207], a[140:143], a[100:103], v[204:207]
    v_mfma_f32_16x16x32_bf16 v[204:207], a[136:139], a[96:99], v[204:207]
    s_waitcnt lgkmcnt(0)
    s_waitcnt vmcnt(25)
    s_barrier
    v_mfma_f32_16x16x32_bf16 v[128:131], a[32:35], a[0:3], v[128:131]
    ds_read_b128 a[104:107], v53 offset:0
    v_mfma_f32_16x16x32_bf16 v[128:131], a[36:39], a[4:7], v[128:131]
    buffer_load_dword v21, off, s[40:43], s95 sc1
    v_mfma_f32_16x16x32_bf16 v[132:135], a[36:39], a[12:15], v[132:135]
    s_add_u32 m0, s15, 40960
    ds_read_b128 a[108:111], v53 offset:1024
    v_mfma_f32_16x16x32_bf16 v[132:135], a[32:35], a[8:11], v[132:135]
    ds_read_b128 a[72:75], v48 offset:0
    v_mfma_f32_16x16x32_bf16 v[136:139], a[32:35], a[16:19], v[136:139]
    ds_read_b128 a[76:79], v48 offset:1024
    v_mfma_f32_16x16x32_bf16 v[136:139], a[36:39], a[20:23], v[136:139]
    buffer_load_dwordx4 v1, s[60:63], s90 offen offset:0 sc1 lds
    v_mfma_f32_16x16x32_bf16 v[140:143], a[36:39], a[28:31], v[140:143]
    ds_read_b128 a[80:83], v49 offset:0
    v_mfma_f32_16x16x32_bf16 v[140:143], a[32:35], a[24:27], v[140:143]
    ds_read_b128 a[84:87], v49 offset:1024
    v_mfma_f32_16x16x32_bf16 v[156:159], a[40:43], a[24:27], v[156:159]
    ds_read_b128 a[88:91], v50 offset:0
    v_mfma_f32_16x16x32_bf16 v[156:159], a[44:47], a[28:31], v[156:159]
    buffer_store_dwordx4 v[120:123], v22, s[28:31], s6 offen offset:2048 sc1
    v_mfma_f32_16x16x32_bf16 v[152:155], a[44:47], a[20:23], v[152:155]
    ds_read_b128 a[92:95], v50 offset:1024
    v_mfma_f32_16x16x32_bf16 v[152:155], a[40:43], a[16:19], v[152:155]
    ds_read_b128 a[96:99], v51 offset:0
    v_mfma_f32_16x16x32_bf16 v[148:151], a[40:43], a[8:11], v[148:151]
    ds_read_b128 a[100:103], v51 offset:1024
    v_mfma_f32_16x16x32_bf16 v[148:151], a[44:47], a[12:15], v[148:151]
    buffer_load_dwordx4 v1, s[60:63], s90 offen offset:1024 sc1 lds
    v_mfma_f32_16x16x32_bf16 v[144:147], a[44:47], a[4:7], v[144:147]
    ds_read_b128 a[112:115], v53 offset:2048
    v_mfma_f32_16x16x32_bf16 v[144:147], a[40:43], a[0:3], v[144:147]
    ds_read_b128 a[116:119], v53 offset:3072
    v_mfma_f32_16x16x32_bf16 v[160:163], a[48:51], a[0:3], v[160:163]
    ds_read_b128 a[120:123], v53 offset:4096
    v_mfma_f32_16x16x32_bf16 v[160:163], a[52:55], a[4:7], v[160:163]
    buffer_load_dwordx4 v1, s[60:63], s90 offen offset:2048 sc1 lds
    v_mfma_f32_16x16x32_bf16 v[164:167], a[52:55], a[12:15], v[164:167]
    ds_read_b128 a[124:127], v53 offset:5120
    v_mfma_f32_16x16x32_bf16 v[164:167], a[48:51], a[8:11], v[164:167]
    ds_read_b128 a[128:131], v53 offset:6144
    v_mfma_f32_16x16x32_bf16 v[168:171], a[48:51], a[16:19], v[168:171]
    ds_read_b128 a[132:135], v53 offset:7168
    v_mfma_f32_16x16x32_bf16 v[168:171], a[52:55], a[20:23], v[168:171]
    buffer_store_dwordx4 v[124:127], v22, s[28:31], s6 offen offset:3072 sc1
    v_mfma_f32_16x16x32_bf16 v[172:175], a[52:55], a[28:31], v[172:175]
    ds_read_b128 a[136:139], v53 offset:8192
    v_mfma_f32_16x16x32_bf16 v[172:175], a[48:51], a[24:27], v[172:175]
    ds_read_b128 a[140:143], v53 offset:9216
    v_mfma_f32_16x16x32_bf16 v[188:191], a[56:59], a[24:27], v[188:191]
    v_mfma_f32_16x16x32_bf16 v[188:191], a[60:63], a[28:31], v[188:191]
    buffer_load_dwordx4 v1, s[60:63], s90 offen offset:3072 sc1 lds
    v_mfma_f32_16x16x32_bf16 v[184:187], a[60:63], a[20:23], v[184:187]
    s_add_u32 m0, s15, 45056
    v_mfma_f32_16x16x32_bf16 v[184:187], a[56:59], a[16:19], v[184:187]
    v_mfma_f32_16x16x32_bf16 v[180:183], a[56:59], a[8:11], v[180:183]
    v_mfma_f32_16x16x32_bf16 v[180:183], a[60:63], a[12:15], v[180:183]
    buffer_load_dwordx4 v22, s[60:63], s90 offen sc1 lds
    v_mfma_f32_16x16x32_bf16 v[176:179], a[60:63], a[4:7], v[176:179]
    s_add_u32 s90, s90, 163840
    v_mfma_f32_16x16x32_bf16 v[176:179], a[56:59], a[0:3], v[176:179]
    v_mfma_f32_16x16x32_bf16 v[192:195], a[64:67], a[0:3], v[192:195]
    v_mfma_f32_16x16x32_bf16 v[192:195], a[68:71], a[4:7], v[192:195]
    v_mfma_f32_16x16x32_bf16 v[196:199], a[68:71], a[12:15], v[196:199]
    v_mfma_f32_16x16x32_bf16 v[196:199], a[64:67], a[8:11], v[196:199]
    v_mfma_f32_16x16x32_bf16 v[200:203], a[64:67], a[16:19], v[200:203]
    v_mfma_f32_16x16x32_bf16 v[200:203], a[68:71], a[20:23], v[200:203]
    v_mfma_f32_16x16x32_bf16 v[204:207], a[68:71], a[28:31], v[204:207]
    v_mfma_f32_16x16x32_bf16 v[204:207], a[64:67], a[24:27], v[204:207]
    s_waitcnt lgkmcnt(0)
    s_waitcnt vmcnt(7)
    s_barrier
    v_and_b32 v21, 0xff, v21
    v_cmp_gt_u32 vcc, 8, v21
    s_cbranch_vccnz M_poa_spin
M_poa_back:
    v_mfma_f32_16x16x32_bf16 v[128:131], a[104:107], a[72:75], v[128:131]
    s_mov_b32 m0, s75
    ds_read_b128 a[32:35], v52 offset:0
    v_mfma_f32_16x16x32_bf16 v[128:131], a[108:111], a[76:79], v[128:131]
    buffer_load_dwordx4 v1, s[56:59], s89 offen offset:0 sc1 lds
    v_mfma_f32_16x16x32_bf16 v[132:135], a[108:111], a[84:87], v[132:135]
    ds_read_b128 a[36:39], v52 offset:1024
    v_mfma_f32_16x16x32_bf16 v[132:135], a[104:107], a[80:83], v[132:135]
    buffer_load_dwordx4 v1, s[56:59], s89 offen offset:1024 sc1 lds
    v_mfma_f32_16x16x32_bf16 v[136:139], a[104:107], a[88:91], v[136:139]
    ds_read_b128 a[0:3], v48 offset:16384
    v_mfma_f32_16x16x32_bf16 v[136:139], a[108:111], a[92:95], v[136:139]
    buffer_load_dwordx4 v1, s[56:59], s89 offen offset:2048 sc1 lds
    v_mfma_f32_16x16x32_bf16 v[140:143], a[108:111], a[100:103], v[140:143]
    ds_read_b128 a[4:7], v48 offset:17408
    v_mfma_f32_16x16x32_bf16 v[140:143], a[104:107], a[96:99], v[140:143]
    buffer_load_dwordx4 v1, s[56:59], s89 offen offset:3072 sc1 lds
    v_mfma_f32_16x16x32_bf16 v[156:159], a[112:115], a[96:99], v[156:159]
    s_add_u32 s89, s89, 16384
    ds_read_b128 a[8:11], v49 offset:16384
    s_add_u32 m0, s15, 139264
    v_mfma_f32_16x16x32_bf16 v[156:159], a[116:119], a[100:103], v[156:159]
    buffer_load_dwordx4 v1, s[60:63], s90 offen offset:0 sc1 lds
    v_mfma_f32_16x16x32_bf16 v[152:155], a[116:119], a[92:95], v[152:155]
    ds_read_b128 a[12:15], v49 offset:17408
    v_mfma_f32_16x16x32_bf16 v[152:155], a[112:115], a[88:91], v[152:155]
    buffer_load_dwordx4 v1, s[60:63], s90 offen offset:1024 sc1 lds
    v_mfma_f32_16x16x32_bf16 v[148:151], a[112:115], a[80:83], v[148:151]
    ds_read_b128 a[16:19], v50 offset:16384
    v_mfma_f32_16x16x32_bf16 v[148:151], a[116:119], a[84:87], v[148:151]
    buffer_load_dwordx4 v1, s[60:63], s90 offen offset:2048 sc1 lds
    v_mfma_f32_16x16x32_bf16 v[144:147], a[116:119], a[76:79], v[144:147]
    ds_read_b128 a[20:23], v50 offset:17408
    v_mfma_f32_16x16x32_bf16 v[144:147], a[112:115], a[72:75], v[144:147]
    buffer_load_dwordx4 v1, s[60:63], s90 offen offset:3072 sc1 lds
    v_mfma_f32_16x16x32_bf16 v[160:163], a[120:123], a[72:75], v[160:163]
    s_add_u32 m0, s15, 143360
    ds_read_b128 a[24:27], v51 offset:16384
    v_mfma_f32_16x16x32_bf16 v[160:163], a[124:127], a[76:79], v[160:163]
    buffer_load_dwordx4 v22, s[60:63], s90 offen sc1 lds
    v_mfma_f32_16x16x32_bf16 v[164:167], a[124:127], a[84:87], v[164:167]
    s_add_u32 s90, s90, 163840
    ds_read_b128 a[28:31], v51 offset:17408
    s_mov_b32 m0, s72
    v_mfma_f32_16x16x32_bf16 v[164:167], a[120:123], a[80:83], v[164:167]
    buffer_load_dwordx4 v1, s[56:59], s89 offen offset:0 sc1 lds
    v_mfma_f32_16x16x32_bf16 v[168:171], a[120:123], a[88:91], v[168:171]
    ds_read_b128 a[40:43], v52 offset:2048
    v_mfma_f32_16x16x32_bf16 v[168:171], a[124:127], a[92:95], v[168:171]
    buffer_load_dwordx4 v1, s[56:59], s89 offen offset:1024 sc1 lds
    v_mfma_f32_16x16x32_bf16 v[172:175], a[124:127], a[100:103], v[172:175]
    ds_read_b128 a[44:47], v52 offset:3072
    v_mfma_f32_16x16x32_bf16 v[172:175], a[120:123], a[96:99], v[172:175]
    buffer_load_dwordx4 v1, s[56:59], s89 offen offset:2048 sc1 lds
    v_mfma_f32_16x16x32_bf16 v[188:191], a[128:131], a[96:99], v[188:191]
    ds_read_b128 a[48:51], v52 offset:4096
    v_mfma_f32_16x16x32_bf16 v[188:191], a[132:135], a[100:103], v[188:191]
    buffer_load_dwordx4 v1, s[56:59], s89 offen offset:3072 sc1 lds
    v_mfma_f32_16x16x32_bf16 v[184:187], a[132:135], a[92:95], v[184:187]
    s_add_u32 s89, s89, 16384
    ds_read_b128 a[52:55], v52 offset:5120
    v_mfma_f32_16x16x32_bf16 v[184:187], a[128:131], a[88:91], v[184:187]
    v_mfma_f32_16x16x32_bf16 v[180:183], a[128:131], a[80:83], v[180:183]
    ds_read_b128 a[56:59], v52 offset:6144
    v_mfma_f32_16x16x32_bf16 v[180:183], a[132:135], a[84:87], v[180:183]
    v_mfma_f32_16x16x32_bf16 v[176:179], a[132:135], a[76:79], v[176:179]
    ds_read_b128 a[60:63], v52 offset:7168
    v_mfma_f32_16x16x32_bf16 v[176:179], a[128:131], a[72:75], v[176:179]
    v_mfma_f32_16x16x32_bf16 v[192:195], a[136:139], a[72:75], v[192:195]
    ds_read_b128 a[64:67], v52 offset:8192
    v_mfma_f32_16x16x32_bf16 v[192:195], a[140:143], a[76:79], v[192:195]
    v_mfma_f32_16x16x32_bf16 v[196:199], a[140:143], a[84:87], v[196:199]
    ds_read_b128 a[68:71], v52 offset:9216
    v_mfma_f32_16x16x32_bf16 v[196:199], a[136:139], a[80:83], v[196:199]
    v_mfma_f32_16x16x32_bf16 v[200:203], a[136:139], a[88:91], v[200:203]
    v_mfma_f32_16x16x32_bf16 v[200:203], a[140:143], a[92:95], v[200:203]
    v_mfma_f32_16x16x32_bf16 v[204:207], a[140:143], a[100:103], v[204:207]
    v_mfma_f32_16x16x32_bf16 v[204:207], a[136:139], a[96:99], v[204:207]
    s_waitcnt lgkmcnt(0)
    s_waitcnt vmcnt(21)
    s_barrier
    v_mfma_f32_16x16x32_bf16 v[128:131], a[32:35], a[0:3], v[128:131]
    s_add_u32 m0, s15, 0
    ds_read_b128 a[104:107], v52 offset:20480
    v_mfma_f32_16x16x32_bf16 v[128:131], a[36:39], a[4:7], v[128:131]
    buffer_load_dwordx4 v1, s[60:63], s90 offen offset:0 sc1 lds
    v_mfma_f32_16x16x32_bf16 v[132:135], a[36:39], a[12:15], v[132:135]
    ds_read_b128 a[108:111], v52 offset:21504
    v_mfma_f32_16x16x32_bf16 v[132:135], a[32:35], a[8:11], v[132:135]
    ds_read_b128 a[72:75], v48 offset:32768
    v_mfma_f32_16x16x32_bf16 v[136:139], a[32:35], a[16:19], v[136:139]
    ds_read_b128 a[76:79], v48 offset:33792
    v_mfma_f32_16x16x32_bf16 v[136:139], a[36:39], a[20:23], v[136:139]
    buffer_load_dwordx4 v1, s[60:63], s90 offen offset:1024 sc1 lds
    v_mfma_f32_16x16x32_bf16 v[140:143], a[36:39], a[28:31], v[140:143]
    ds_read_b128 a[80:83], v49 offset:32768
    v_mfma_f32_16x16x32_bf16 v[140:143], a[32:35], a[24:27], v[140:143]
    ds_read_b128 a[84:87], v49 offset:33792
    v_mfma_f32_16x16x32_bf16 v[156:159], a[40:43], a[24:27], v[156:159]
    ds_read_b128 a[88:91], v50 offset:32768
    v_mfma_f32_16x16x32_bf16 v[156:159], a[44:47], a[28:31], v[156:159]
    buffer_load_dwordx4 v1, s[60:63], s90 offen offset:2048 sc1 lds
    v_mfma_f32_16x16x32_bf16 v[152:155], a[44:47], a[20:23], v[152:155]
    ds_read_b128 a[92:95], v50 offset:33792
    v_mfma_f32_16x16x32_bf16 v[152:155], a[40:43], a[16:19], v[152:155]
    ds_read_b128 a[96:99], v51 offset:32768
    v_mfma_f32_16x16x32_bf16 v[148:151], a[40:43], a[8:11], v[148:151]
    ds_read_b128 a[100:103], v51 offset:33792
    v_mfma_f32_16x16x32_bf16 v[148:151], a[44:47], a[12:15], v[148:151]
    buffer_load_dwordx4 v1, s[60:63], s90 offen offset:3072 sc1 lds
    v_mfma_f32_16x16x32_bf16 v[144:147], a[44:47], a[4:7], v[144:147]
    s_add_u32 m0, s15, 4096
    ds_read_b128 a[112:115], v52 offset:22528
    v_mfma_f32_16x16x32_bf16 v[144:147], a[40:43], a[0:3], v[144:147]
    ds_read_b128 a[116:119], v52 offset:23552
    v_mfma_f32_16x16x32_bf16 v[160:163], a[48:51], a[0:3], v[160:163]
    ds_read_b128 a[120:123], v52 offset:24576
    v_mfma_f32_16x16x32_bf16 v[160:163], a[52:55], a[4:7], v[160:163]
    buffer_load_dwordx4 v22, s[60:63], s90 offen sc1 lds
    v_mfma_f32_16x16x32_bf16 v[164:167], a[52:55], a[12:15], v[164:167]
    s_add_u32 s90, s90, 163840
    ds_read_b128 a[124:127], v52 offset:25600
    s_mov_b32 m0, s73
    v_mfma_f32_16x16x32_bf16 v[164:167], a[48:51], a[8:11], v[164:167]
    ds_read_b128 a[128:131], v52 offset:26624
    v_mfma_f32_16x16x32_bf16 v[168:171], a[48:51], a[16:19], v[168:171]
    ds_read_b128 a[132:135], v52 offset:27648
    v_mfma_f32_16x16x32_bf16 v[168:171], a[52:55], a[20:23], v[168:171]
    buffer_load_dwordx4 v1, s[56:59], s89 offen offset:0 sc1 lds
    v_mfma_f32_16x16x32_bf16 v[172:175], a[52:55], a[28:31], v[172:175]
    ds_read_b128 a[136:139], v52 offset:28672
    v_mfma_f32_16x16x32_bf16 v[172:175], a[48:51], a[24:27], v[172:175]
    ds_read_b128 a[140:143], v52 offset:29696
    v_mfma_f32_16x16x32_bf16 v[188:191], a[56:59], a[24:27], v[188:191]
    v_mfma_f32_16x16x32_bf16 v[188:191], a[60:63], a[28:31], v[188:191]
    buffer_load_dwordx4 v1, s[56:59], s89 offen offset:1024 sc1 lds
    v_mfma_f32_16x16x32_bf16 v[184:187], a[60:63], a[20:23], v[184:187]
    v_mfma_f32_16x16x32_bf16 v[184:187], a[56:59], a[16:19], v[184:187]
    v_mfma_f32_16x16x32_bf16 v[180:183], a[56:59], a[8:11], v[180:183]
    v_mfma_f32_16x16x32_bf16 v[180:183], a[60:63], a[12:15], v[180:183]
    buffer_load_dwordx4 v1, s[56:59], s89 offen offset:2048 sc1 lds
    v_mfma_f32_16x16x32_bf16 v[176:179], a[60:63], a[4:7], v[176:179]
    v_mfma_f32_16x16x32_bf16 v[176:179], a[56:59], a[0:3], v[176:179]
    v_mfma_f32_16x16x32_bf16 v[192:195], a[64:67], a[0:3], v[192:195]
    v_mfma_f32_16x16x32_bf16 v[192:195], a[68:71], a[4:7], v[192:195]
    buffer_load_dwordx4 v1, s[56:59], s89 offen offset:3072 sc1 lds
    v_mfma_f32_16x16x32_bf16 v[196:199], a[68:71], a[12:15], v[196:199]
    s_add_u32 s89, s89, 16384
    v_mfma_f32_16x16x32_bf16 v[196:199], a[64:67], a[8:11], v[196:199]
    v_mfma_f32_16x16x32_bf16 v[200:203], a[64:67], a[16:19], v[200:203]
    v_mfma_f32_16x16x32_bf16 v[200:203], a[68:71], a[20:23], v[200:203]
    v_mfma_f32_16x16x32_bf16 v[204:207], a[68:71], a[28:31], v[204:207]
    v_mfma_f32_16x16x32_bf16 v[204:207], a[64:67], a[24:27], v[204:207]
    s_waitcnt lgkmcnt(0)
    s_waitcnt vmcnt(18)
    s_barrier
    v_mfma_f32_16x16x32_bf16 v[128:131], a[104:107], a[72:75], v[128:131]
    ds_read_b128 a[32:35], v52 offset:40960
    v_mfma_f32_16x16x32_bf16 v[128:131], a[108:111], a[76:79], v[128:131]
    buffer_atomic_add v47, v33, s[40:43], s94 offen
    v_mfma_f32_16x16x32_bf16 v[132:135], a[108:111], a[84:87], v[132:135]
    s_add_u32 m0, s15, 20480
    ds_read_b128 a[36:39], v52 offset:41984
    v_mfma_f32_16x16x32_bf16 v[132:135], a[104:107], a[80:83], v[132:135]
    ds_read_b128 a[0:3], v48 offset:49152
    v_mfma_f32_16x16x32_bf16 v[136:139], a[104:107], a[88:91], v[136:139]
    ds_read_b128 a[4:7], v48 offset:50176
    v_mfma_f32_16x16x32_bf16 v[136:139], a[108:111], a[92:95], v[136:139]
    buffer_load_dwordx4 v1, s[60:63], s90 offen offset:0 sc1 lds
    v_mfma_f32_16x16x32_bf16 v[140:143], a[108:111], a[100:103], v[140:143]
    ds_read_b128 a[8:11], v49 offset:49152
    v_mfma_f32_16x16x32_bf16 v[140:143], a[104:107], a[96:99], v[140:143]
    ds_read_b128 a[12:15], v49 offset:50176
    v_mfma_f32_16x16x32_bf16 v[156:159], a[112:115], a[96:99], v[156:159]
    ds_read_b128 a[16:19], v50 offset:49152
    v_mfma_f32_16x16x32_bf16 v[156:159], a[116:119], a[100:103], v[156:159]
    buffer_load_dwordx4 v1, s[60:63], s90 offen offset:1024 sc1 lds
    v_mfma_f32_16x16x32_bf16 v[152:155], a[116:119], a[92:95], v[152:155]
    ds_read_b128 a[20:23], v50 offset:50176
    v_mfma_f32_16x16x32_bf16 v[152:155], a[112:115], a[88:91], v[152:155]
    ds_read_b128 a[24:27], v51 offset:49152
    v_mfma_f32_16x16x32_bf16 v[148:151], a[112:115], a[80:83], v[148:151]
    ds_read_b128 a[28:31], v51 offset:50176
    v_mfma_f32_16x16x32_bf16 v[148:151], a[116:119], a[84:87], v[148:151]
    buffer_load_dwordx4 v1, s[60:63], s90 offen offset:2048 sc1 lds
    v_mfma_f32_16x16x32_bf16 v[144:147], a[116:119], a[76:79], v[144:147]
    ds_read_b128 a[40:43], v52 offset:43008
    v_mfma_f32_16x16x32_bf16 v[144:147], a[112:115], a[72:75], v[144:147]
    ds_read_b128 a[44:47], v52 offset:44032
    v_mfma_f32_16x16x32_bf16 v[160:163], a[120:123], a[72:75], v[160:163]
    ds_read_b128 a[48:51], v52 offset:45056
    v_mfma_f32_16x16x32_bf16 v[160:163], a[124:127], a[76:79], v[160:163]
    buffer_load_dwordx4 v1, s[60:63], s90 offen offset:3072 sc1 lds
    v_mfma_f32_16x16x32_bf16 v[164:167], a[124:127], a[84:87], v[164:167]
    s_add_u32 m0, s15, 24576
    ds_read_b128 a[52:55], v52 offset:46080
    v_mfma_f32_16x16x32_bf16 v[164:167], a[120:123], a[80:83], v[164:167]
    ds_read_b128 a[56:59], v52 offset:47104
    v_mfma_f32_16x16x32_bf16 v[168:171], a[120:123], a[88:91], v[168:171]
    ds_read_b128 a[60:63], v52 offset:48128
    v_mfma_f32_16x16x32_bf16 v[168:171], a[124:127], a[92:95], v[168:171]
    buffer_load_dwordx4 v22, s[60:63], s90 offen sc1 lds
    v_mfma_f32_16x16x32_bf16 v[172:175], a[124:127], a[100:103], v[172:175]
    s_add_u32 s90, s90, 163840
    ds_read_b128 a[64:67], v52 offset:49152
    s_mov_b32 m0, s74
    v_mfma_f32_16x16x32_bf16 v[172:175], a[120:123], a[96:99], v[172:175]
    ds_read_b128 a[68:71], v52 offset:50176
    v_mfma_f32_16x16x32_bf16 v[188:191], a[128:131], a[96:99], v[188:191]
    v_mfma_f32_16x16x32_bf16 v[188:191], a[132:135], a[100:103], v[188:191]
    buffer_load_dwordx4 v1, s[56:59], s89 offen offset:0 sc1 lds
    v_mfma_f32_16x16x32_bf16 v[184:187], a[132:135], a[92:95], v[184:187]
    v_mfma_f32_16x16x32_bf16 v[184:187], a[128:131], a[88:91], v[184:187]
    v_mfma_f32_16x16x32_bf16 v[180:183], a[128:131], a[80:83], v[180:183]
    v_mfma_f32_16x16x32_bf16 v[180:183], a[132:135], a[84:87], v[180:183]
    buffer_load_dwordx4 v1, s[56:59], s89 offen offset:1024 sc1 lds
    v_mfma_f32_16x16x32_bf16 v[176:179], a[132:135], a[76:79], v[176:179]
    v_mfma_f32_16x16x32_bf16 v[176:179], a[128:131], a[72:75], v[176:179]
    v_mfma_f32_16x16x32_bf16 v[192:195], a[136:139], a[72:75], v[192:195]
    v_mfma_f32_16x16x32_bf16 v[192:195], a[140:143], a[76:79], v[192:195]
    buffer_load_dwordx4 v1, s[56:59], s89 offen offset:2048 sc1 lds
    v_mfma_f32_16x16x32_bf16 v[196:199], a[140:143], a[84:87], v[196:199]
    v_mfma_f32_16x16x32_bf16 v[196:199], a[136:139], a[80:83], v[196:199]
    v_mfma_f32_16x16x32_bf16 v[200:203], a[136:139], a[88:91], v[200:203]
    v_mfma_f32_16x16x32_bf16 v[200:203], a[140:143], a[92:95], v[200:203]
    buffer_load_dwordx4 v1, s[56:59], s89 offen offset:3072 sc1 lds
    v_mfma_f32_16x16x32_bf16 v[204:207], a[140:143], a[100:103], v[204:207]
    s_add_u32 s89, s89, 16384
    v_mfma_f32_16x16x32_bf16 v[204:207], a[136:139], a[96:99], v[204:207]
    s_waitcnt lgkmcnt(0)
    s_waitcnt vmcnt(19)
    s_barrier
    v_mfma_f32_16x16x32_bf16 v[64:67], a[32:35], a[0:3], 0
    s_add_u32 m0, s15, 40960
    ds_read_b128 a[104:107], v53 offset:0
    v_mfma_f32_16x16x32_bf16 v[64:67], a[36:39], a[4:7], v[64:67]
    buffer_load_dwordx4 v1, s[60:63], s90 offen offset:0 sc1 lds
    v_mfma_f32_16x16x32_bf16 v[68:71], a[36:39], a[12:15], 0
    ds_read_b128 a[108:111], v53 offset:1024
    v_cvt_pk_bf16_f32 v224, v132, v133
    v_mfma_f32_16x16x32_bf16 v[68:71], a[32:35], a[8:11], v[68:71]
    ds_read_b128 a[72:75], v48 offset:0
    v_cvt_pk_bf16_f32 v225, v134, v135
    v_mfma_f32_16x16x32_bf16 v[72:75], a[32:35], a[16:19], 0
    ds_read_b128 a[76:79], v48 offset:1024
    v_mfma_f32_16x16x32_bf16 v[72:75], a[36:39], a[20:23], v[72:75]
    buffer_load_dwordx4 v1, s[60:63], s90 offen offset:1024 sc1 lds
    v_mfma_f32_16x16x32_bf16 v[76:79], a[36:39], a[28:31], 0
    ds_read_b128 a[80:83], v49 offset:0
    v_cvt_pk_bf16_f32 v226, v148, v149
    v_mfma_f32_16x16x32_bf16 v[76:79], a[32:35], a[24:27], v[76:79]
    ds_read_b128 a[84:87], v49 offset:1024
    v_cvt_pk_bf16_f32 v227, v150, v151
    v_mfma_f32_16x16x32_bf16 v[92:95], a[40:43], a[24:27], 0
    ds_read_b128 a[88:91], v50 offset:0
    v_mfma_f32_16x16x32_bf16 v[92:95], a[44:47], a[28:31], v[92:95]
    buffer_load_dwordx4 v1, s[60:63], s90 offen offset:2048 sc1 lds
    v_mfma_f32_16x16x32_bf16 v[88:91], a[44:47], a[20:23], 0
    ds_read_b128 a[92:95], v50 offset:1024
    v_cvt_pk_bf16_f32 v228, v164, v165
    v_mfma_f32_16x16x32_bf16 v[88:91], a[40:43], a[16:19], v[88:91]
    ds_read_b128 a[96:99], v51 offset:0
    v_cvt_pk_bf16_f32 v229, v166, v167
    v_mfma_f32_16x16x32_bf16 v[84:87], a[40:43], a[8:11], 0
    ds_read_b128 a[100:103], v51 offset:1024
    v_mfma_f32_16x16x32_bf16 v[84:87], a[44:47], a[12:15], v[84:87]
    buffer_load_dwordx4 v1, s[60:63], s90 offen offset:3072 sc1 lds
    v_mfma_f32_16x16x32_bf16 v[80:83], a[44:47], a[4:7], 0
    s_add_u32 m0, s15, 45056
    ds_read_b128 a[112:115], v53 offset:2048
    v_cvt_pk_bf16_f32 v230, v180, v181
    v_mfma_f32_16x16x32_bf16 v[80:83], a[40:43], a[0:3], v[80:83]
    ds_read_b128 a[116:119], v53 offset:3072
    v_cvt_pk_bf16_f32 v231, v182, v183
    v_mfma_f32_16x16x32_bf16 v[96:99], a[48:51], a[0:3], 0
    ds_read_b128 a[120:123], v53 offset:4096
    v_mfma_f32_16x16x32_bf16 v[96:99], a[52:55], a[4:7], v[96:99]
    buffer_load_dwordx4 v22, s[60:63], s90 offen sc1 lds
    v_mfma_f32_16x16x32_bf16 v[100:103], a[52:55], a[12:15], 0
    s_add_u32 s90, s90, 163840
    ds_read_b128 a[124:127], v53 offset:5120
    s_mov_b32 m0, s75
    v_mfma_f32_16x16x32_bf16 v[100:103], a[48:51], a[8:11], v[100:103]
    ds_read_b128 a[128:131], v53 offset:6144
    v_cvt_pk_bf16_f32 v232, v196, v197
    v_mfma_f32_16x16x32_bf16 v[104:107], a[48:51], a[16:19], 0
    ds_read_b128 a[132:135], v53 offset:7168
    v_mfma_f32_16x16x32_bf16 v[104:107], a[52:55], a[20:23], v[104:107]
    buffer_load_dwordx4 v1, s[56:59], s89 offen offset:0 sc1 lds
    v_mfma_f32_16x16x32_bf16 v[108:111], a[52:55], a[28:31], 0
    ds_read_b128 a[136:139], v53 offset:8192
    v_cvt_pk_bf16_f32 v233, v198, v199
    v_mfma_f32_16x16x32_bf16 v[108:111], a[48:51], a[24:27], v[108:111]
    ds_read_b128 a[140:143], v53 offset:9216
    v_cvt_pk_bf16_f32 v234, v136, v137
    v_mfma_f32_16x16x32_bf16 v[124:127], a[56:59], a[24:27], 0
    v_mfma_f32_16x16x32_bf16 v[124:127], a[60:63], a[28:31], v[124:127]
    buffer_load_dwordx4 v1, s[56:59], s89 offen offset:1024 sc1 lds
    v_mfma_f32_16x16x32_bf16 v[120:123], a[60:63], a[20:23], 0
    v_cvt_pk_bf16_f32 v235, v138, v139
    v_cvt_pk_bf16_f32 v236, v152, v153
    v_mfma_f32_16x16x32_bf16 v[120:123], a[56:59], a[16:19], v[120:123]
    v_cvt_pk_bf16_f32 v237, v154, v155
    v_cvt_pk_bf16_f32 v238, v168, v169
    v_mfma_f32_16x16x32_bf16 v[116:119], a[56:59], a[8:11], 0
    v_mfma_f32_16x16x32_bf16 v[116:119], a[60:63], a[12:15], v[116:119]
    buffer_load_dwordx4 v1, s[56:59], s89 offen offset:2048 sc1 lds
    v_mfma_f32_16x16x32_bf16 v[112:115], a[60:63], a[4:7], 0
    v_cvt_pk_bf16_f32 v239, v170, v171
    v_cvt_pk_bf16_f32 v240, v184, v185
    v_mfma_f32_16x16x32_bf16 v[112:115], a[56:59], a[0:3], v[112:115]
    v_cvt_pk_bf16_f32 v241, v186, v187
    v_cvt_pk_bf16_f32 v242, v200, v201
    v_mfma_f32_16x16x32_bf16 v[208:211], a[64:67], a[0:3], 0
    v_mfma_f32_16x16x32_bf16 v[208:211], a[68:71], a[4:7], v[208:211]
    buffer_load_dwordx4 v1, s[56:59], s89 offen offset:3072 sc1 lds
    v_mfma_f32_16x16x32_bf16 v[212:215], a[68:71], a[12:15], 0
    s_add_u32 s89, s89, 16384
    v_cvt_pk_bf16_f32 v243, v202, v203
    v_cvt_pk_bf16_f32 v244, v140, v141
    v_mfma_f32_16x16x32_bf16 v[212:215], a[64:67], a[8:11], v[212:215]
    v_cvt_pk_bf16_f32 v245, v142, v143
    v_cvt_pk_bf16_f32 v246, v156, v157
    v_mfma_f32_16x16x32_bf16 v[216:219], a[64:67], a[16:19], 0
    v_cvt_pk_bf16_f32 v247, v158, v159
    v_cvt_pk_bf16_f32 v248, v172, v173
    v_mfma_f32_16x16x32_bf16 v[216:219], a[68:71], a[20:23], v[216:219]
    v_cvt_pk_bf16_f32 v249, v174, v175
    v_cvt_pk_bf16_f32 v250, v188, v189
    v_mfma_f32_16x16x32_bf16 v[220:223], a[68:71], a[28:31], 0
    v_cvt_pk_bf16_f32 v251, v190, v191
    v_cvt_pk_bf16_f32 v252, v204, v205
    v_mfma_f32_16x16x32_bf16 v[220:223], a[64:67], a[24:27], v[220:223]
    v_cvt_pk_bf16_f32 v253, v206, v207
    s_waitcnt lgkmcnt(0)
    s_waitcnt vmcnt(19)
    s_barrier
    v_mfma_f32_16x16x32_bf16 v[64:67], a[104:107], a[72:75], v[64:67]
    s_add_u32 m0, s15, 139264
    ds_read_b128 a[32:35], v52 offset:0
    v_mfma_f32_16x16x32_bf16 v[64:67], a[108:111], a[76:79], v[64:67]
    buffer_load_dwordx4 v1, s[60:63], s90 offen offset:0 sc1 lds
    v_mfma_f32_16x16x32_bf16 v[68:71], a[108:111], a[84:87], v[68:71]
    ds_read_b128 a[36:39], v52 offset:1024
    v_mfma_f32_16x16x32_bf16 v[68:71], a[104:107], a[80:83], v[68:71]
    buffer_store_dwordx4 v[224:227], v14, s[48:51], s17 offen sc1
    v_mfma_f32_16x16x32_bf16 v[72:75], a[104:107], a[88:91], v[72:75]
    ds_read_b128 a[0:3], v48 offset:16384
    v_mfma_f32_16x16x32_bf16 v[72:75], a[108:111], a[92:95], v[72:75]
    buffer_load_dwordx4 v1, s[60:63], s90 offen offset:1024 sc1 lds
    v_mfma_f32_16x16x32_bf16 v[76:79], a[108:111], a[100:103], v[76:79]
    ds_read_b128 a[4:7], v48 offset:17408
    v_mfma_f32_16x16x32_bf16 v[76:79], a[104:107], a[96:99], v[76:79]
    buffer_load_dwordx4 v1, s[60:63], s90 offen offset:2048 sc1 lds
    v_mfma_f32_16x16x32_bf16 v[92:95], a[112:115], a[96:99], v[92:95]
    ds_read_b128 a[8:11], v49 offset:16384
    v_mfma_f32_16x16x32_bf16 v[92:95], a[116:119], a[100:103], v[92:95]
    buffer_load_dwordx4 v1, s[60:63], s90 offen offset:3072 sc1 lds
    v_mfma_f32_16x16x32_bf16 v[88:91], a[116:119], a[92:95], v[88:91]
    s_add_u32 m0, s15, 143360
    ds_read_b128 a[12:15], v49 offset:17408
    v_mfma_f32_16x16x32_bf16 v[88:91], a[112:115], a[88:91], v[88:91]
    buffer_load_dwordx4 v22, s[60:63], s90 offen sc1 lds
    v_mfma_f32_16x16x32_bf16 v[84:87], a[112:115], a[80:83], v[84:87]
    ds_read_b128 a[16:19], v50 offset:16384
    v_mfma_f32_16x16x32_bf16 v[84:87], a[116:119], a[84:87], v[84:87]
    buffer_store_dwordx4 v[228:231], v14, s[48:51], s17 offen offset:1024 sc1
    v_mfma_f32_16x16x32_bf16 v[80:83], a[116:119], a[76:79], v[80:83]
    s_add_u32 s90, s90, 163840
    ds_read_b128 a[20:23], v50 offset:17408
    s_mov_b32 m0, s72
    v_mfma_f32_16x16x32_bf16 v[80:83], a[112:115], a[72:75], v[80:83]
    buffer_load_dwordx4 v1, s[56:59], s89 offen offset:0 sc1 lds
    v_mfma_f32_16x16x32_bf16 v[96:99], a[120:123], a[72:75], v[96:99]
    ds_read_b128 a[24:27], v51 offset:16384
    v_mfma_f32_16x16x32_bf16 v[96:99], a[124:127], a[76:79], v[96:99]
    buffer_load_dwordx4 v1, s[56:59], s89 offen offset:1024 sc1 lds
    v_mfma_f32_16x16x32_bf16 v[100:103], a[124:127], a[84:87], v[100:103]
    ds_read_b128 a[28:31], v51 offset:17408
    v_mfma_f32_16x16x32_bf16 v[100:103], a[120:123], a[80:83], v[100:103]
    buffer_load_dwordx4 v1, s[56:59], s89 offen offset:2048 sc1 lds
    v_mfma_f32_16x16x32_bf16 v[104:107], a[120:123], a[88:91], v[104:107]
    ds_read_b128 a[40:43], v52 offset:2048
    v_mfma_f32_16x16x32_bf16 v[104:107], a[124:127], a[92:95], v[104:107]
    buffer_load_dwordx4 v1, s[56:59], s89 offen offset:3072 sc1 lds
    v_mfma_f32_16x16x32_bf16 v[108:111], a[124:127], a[100:103], v[108:111]
    s_add_u32 s89, s89, 16384
    ds_read_b128 a[44:47], v52 offset:3072
    v_mfma_f32_16x16x32_bf16 v[108:111], a[120:123], a[96:99], v[108:111]
    v_mfma_f32_16x16x32_bf16 v[124:127], a[128:131], a[96:99], v[124:127]
    ds_read_b128 a[48:51], v52 offset:4096
    v_mfma_f32_16x16x32_bf16 v[124:127], a[132:135], a[100:103], v[124:127]
    v_mfma_f32_16x16x32_bf16 v[120:123], a[132:135], a[92:95], v[120:123]
    ds_read_b128 a[52:55], v52 offset:5120
    v_mfma_f32_16x16x32_bf16 v[120:123], a[128:131], a[88:91], v[120:123]
    v_mfma_f32_16x16x32_bf16 v[116:119], a[128:131], a[80:83], v[116:119]
    ds_read_b128 a[56:59], v52 offset:6144
    v_mfma_f32_16x16x32_bf16 v[116:119], a[132:135], a[84:87], v[116:119]
    v_mfma_f32_16x16x32_bf16 v[112:115], a[132:135], a[76:79], v[112:115]
    ds_read_b128 a[60:63], v52 offset:7168
    v_mfma_f32_16x16x32_bf16 v[112:115], a[128:131], a[72:75], v[112:115]
    v_mfma_f32_16x16x32_bf16 v[208:211], a[136:139], a[72:75], v[208:211]
    ds_read_b128 a[64:67], v52 offset:8192
    v_mfma_f32_16x16x32_bf16 v[208:211], a[140:143], a[76:79], v[208:211]
    v_mfma_f32_16x16x32_bf16 v[212:215], a[140:143], a[84:87], v[212:215]
    ds_read_b128 a[68:71], v52 offset:9216
    v_mfma_f32_16x16x32_bf16 v[212:215], a[136:139], a[80:83], v[212:215]
    v_mfma_f32_16x16x32_bf16 v[216:219], a[136:139], a[88:91], v[216:219]
    v_mfma_f32_16x16x32_bf16 v[216:219], a[140:143], a[92:95], v[216:219]
    v_mfma_f32_16x16x32_bf16 v[220:223], a[140:143], a[100:103], v[220:223]
    v_mfma_f32_16x16x32_bf16 v[220:223], a[136:139], a[96:99], v[220:223]
    s_waitcnt lgkmcnt(0)
    s_waitcnt vmcnt(20)
    s_barrier
    v_mfma_f32_16x16x32_bf16 v[64:67], a[32:35], a[0:3], v[64:67]
    ds_read_b128 a[104:107], v52 offset:20480
    v_mfma_f32_16x16x32_bf16 v[64:67], a[36:39], a[4:7], v[64:67]
    buffer_load_dword v21, off, s[40:43], s95 sc1
    v_mfma_f32_16x16x32_bf16 v[68:71], a[36:39], a[12:15], v[68:71]
    s_add_u32 m0, s15, 0
    ds_read_b128 a[108:111], v52 offset:21504
    v_mfma_f32_16x16x32_bf16 v[68:71], a[32:35], a[8:11], v[68:71]
    buffer_load_dwordx4 v1, s[60:63], s90 offen offset:0 sc1 lds
    v_mfma_f32_16x16x32_bf16 v[72:75], a[32:35], a[16:19], v[72:75]
    ds_read_b128 a[72:75], v48 offset:32768
    v_mfma_f32_16x16x32_bf16 v[72:75], a[36:39], a[20:23], v[72:75]
    buffer_store_dwordx2 v[232:233], v15, s[48:51], s17 offen offset:2048 sc1
    v_mfma_f32_16x16x32_bf16 v[76:79], a[36:39], a[28:31], v[76:79]
    ds_read_b128 a[76:79], v48 offset:33792
    v_mfma_f32_16x16x32_bf16 v[76:79], a[32:35], a[24:27], v[76:79]
    buffer_load_dwordx4 v1, s[60:63], s90 offen offset:1024 sc1 lds
    v_mfma_f32_16x16x32_bf16 v[92:95], a[40:43], a[24:27], v[92:95]
    ds_read_b128 a[80:83], v49 offset:32768
    v_mfma_f32_16x16x32_bf16 v[92:95], a[44:47], a[28:31], v[92:95]
    buffer_load_dwordx4 v1, s[60:63], s90 offen offset:2048 sc1 lds
    v_mfma_f32_16x16x32_bf16 v[88:91], a[44:47], a[20:23], v[88:91]
    ds_read_b128 a[84:87], v49 offset:33792
    v_mfma_f32_16x16x32_bf16 v[88:91], a[40:43], a[16:19], v[88:91]
    buffer_load_dwordx4 v1, s[60:63], s90 offen offset:3072 sc1 lds
    v_mfma_f32_16x16x32_bf16 v[84:87], a[40:43], a[8:11], v[84:87]
    s_add_u32 m0, s15, 4096
    ds_read_b128 a[88:91], v50 offset:32768
    v_mfma_f32_16x16x32_bf16 v[84:87], a[44:47], a[12:15], v[84:87]
    buffer_load_dwordx4 v22, s[60:63], s90 offen sc1 lds
    v_mfma_f32_16x16x32_bf16 v[80:83], a[44:47], a[4:7], v[80:83]
    ds_read_b128 a[92:95], v50 offset:33792
    v_mfma_f32_16x16x32_bf16 v[80:83], a[40:43], a[0:3], v[80:83]
    buffer_store_dwordx4 v[234:237], v14, s[48:51], s18 offen sc1
    v_mfma_f32_16x16x32_bf16 v[96:99], a[48:51], a[0:3], v[96:99]
    s_add_u32 s90, s90, 163840
    ds_read_b128 a[96:99], v51 offset:32768
    s_mov_b32 m0, s73
    v_mfma_f32_16x16x32_bf16 v[96:99], a[52:55], a[4:7], v[96:99]
    buffer_load_dwordx4 v1, s[56:59], s89 offen offset:0 sc1 lds
    v_mfma_f32_16x16x32_bf16 v[100:103], a[52:55], a[12:15], v[100:103]
    ds_read_b128 a[100:103], v51 offset:33792
    v_mfma_f32_16x16x32_bf16 v[100:103], a[48:51], a[8:11], v[100:103]
    buffer_load_dwordx4 v1, s[56:59], s89 offen offset:1024 sc1 lds
    v_mfma_f32_16x16x32_bf16 v[104:107], a[48:51], a[16:19], v[104:107]
    ds_read_b128 a[112:115], v52 offset:22528
    v_mfma_f32_16x16x32_bf16 v[104:107], a[52:55], a[20:23], v[104:107]
    buffer_load_dwordx4 v1, s[56:59], s89 offen offset:2048 sc1 lds
    v_mfma_f32_16x16x32_bf16 v[108:111], a[52:55], a[28:31], v[108:111]
    ds_read_b128 a[116:119], v52 offset:23552
    v_mfma_f32_16x16x32_bf16 v[108:111], a[48:51], a[24:27], v[108:111]
    buffer_load_dwordx4 v1, s[56:59], s89 offen offset:3072 sc1 lds
    v_mfma_f32_16x16x32_bf16 v[124:127], a[56:59], a[24:27], v[124:127]
    s_add_u32 s89, s89, 16384
    ds_read_b128 a[120:123], v52 offset:24576
    v_mfma_f32_16x16x32_bf16 v[124:127], a[60:63], a[28:31], v[124:127]
    v_mfma_f32_16x16x32_bf16 v[120:123], a[60:63], a[20:23], v[120:123]
    ds_read_b128 a[124:127], v52 offset:25600
    v_mfma_f32_16x16x32_bf16 v[120:123], a[56:59], a[16:19], v[120:123]
    v_mfma_f32_16x16x32_bf16 v[116:119], a[56:59], a[8:11], v[116:119]
    ds_read_b128 a[128:131], v52 offset:26624
    v_mfma_f32_16x16x32_bf16 v[116:119], a[60:63], a[12:15], v[116:119]
    v_mfma_f32_16x16x32_bf16 v[112:115], a[60:63], a[4:7], v[112:115]
    ds_read_b128 a[132:135], v52 offset:27648
    v_mfma_f32_16x16x32_bf16 v[112:115], a[56:59], a[0:3], v[112:115]
    v_mfma_f32_16x16x32_bf16 v[208:211], a[64:67], a[0:3], v[208:211]
    ds_read_b128 a[136:139], v52 offset:28672
    v_mfma_f32_16x16x32_bf16 v[208:211], a[68:71], a[4:7], v[208:211]
    v_mfma_f32_16x16x32_bf16 v[212:215], a[68:71], a[12:15], v[212:215]
    ds_read_b128 a[140:143], v52 offset:29696
    v_mfma_f32_16x16x32_bf16 v[212:215], a[64:67], a[8:11], v[212:215]
    v_mfma_f32_16x16x32_bf16 v[216:219], a[64:67], a[16:19], v[216:219]
    v_mfma_f32_16x16x32_bf16 v[216:219], a[68:71], a[20:23], v[216:219]
    v_mfma_f32_16x16x32_bf16 v[220:223], a[68:71], a[28:31], v[220:223]
    v_mfma_f32_16x16x32_bf16 v[220:223], a[64:67], a[24:27], v[220:223]
    s_waitcnt lgkmcnt(0)
    s_waitcnt vmcnt(23)
    s_barrier
    v_mfma_f32_16x16x32_bf16 v[64:67], a[104:107], a[72:75], v[64:67]
    s_add_u32 m0, s15, 20480
    ds_read_b128 a[32:35], v52 offset:40960
    v_mfma_f32_16x16x32_bf16 v[64:67], a[108:111], a[76:79], v[64:67]
    buffer_load_dwordx4 v1, s[60:63], s90 offen offset:0 sc1 lds
    v_mfma_f32_16x16x32_bf16 v[68:71], a[108:111], a[84:87], v[68:71]
    ds_read_b128 a[36:39], v52 offset:41984
    v_mfma_f32_16x16x32_bf16 v[68:71], a[104:107], a[80:83], v[68:71]
    buffer_store_dwordx4 v[238:241], v14, s[48:51], s18 offen offset:1024 sc1
    v_mfma_f32_16x16x32_bf16 v[72:75], a[104:107], a[88:91], v[72:75]
    ds_read_b128 a[0:3], v48 offset:49152
    v_mfma_f32_16x16x32_bf16 v[72:75], a[108:111], a[92:95], v[72:75]
    buffer_load_dwordx4 v1, s[60:63], s90 offen offset:1024 sc1 lds
    v_mfma_f32_16x16x32_bf16 v[76:79], a[108:111], a[100:103], v[76:79]
    ds_read_b128 a[4:7], v48 offset:50176
    v_mfma_f32_16x16x32_bf16 v[76:79], a[104:107], a[96:99], v[76:79]
    buffer_load_dwordx4 v1, s[60:63], s90 offen offset:2048 sc1 lds
    v_mfma_f32_16x16x32_bf16 v[92:95], a[112:115], a[96:99], v[92:95]
    ds_read_b128 a[8:11], v49 offset:49152
    v_mfma_f32_16x16x32_bf16 v[92:95], a[116:119], a[100:103], v[92:95]
    buffer_load_dwordx4 v1, s[60:63], s90 offen offset:3072 sc1 lds
    v_mfma_f32_16x16x32_bf16 v[88:91], a[116:119], a[92:95], v[88:91]
    s_add_u32 m0, s15, 24576
    ds_read_b128 a[12:15], v49 offset:50176
    v_mfma_f32_16x16x32_bf16 v[88:91], a[112:115], a[88:91], v[88:91]
    buffer_load_dwordx4 v22, s[60:63], s90 offen sc1 lds
    v_mfma_f32_16x16x32_bf16 v[84:87], a[112:115], a[80:83], v[84:87]
    ds_read_b128 a[16:19], v50 offset:49152
    v_mfma_f32_16x16x32_bf16 v[84:87], a[116:119], a[84:87], v[84:87]
    buffer_store_dwordx2 v[242:243], v15, s[48:51], s18 offen offset:2048 sc1
    v_mfma_f32_16x16x32_bf16 v[80:83], a[116:119], a[76:79], v[80:83]
    s_sub_u32 s90, s90, 1064960
    ds_read_b128 a[20:23], v50 offset:50176
    s_mov_b32 m0, s74
    v_mfma_f32_16x16x32_bf16 v[80:83], a[112:115], a[72:75], v[80:83]
    buffer_load_dwordx4 v1, s[56:59], s89 offen offset:0 sc1 lds
    v_mfma_f32_16x16x32_bf16 v[96:99], a[120:123], a[72:75], v[96:99]
    ds_read_b128 a[24:27], v51 offset:49152
    v_mfma_f32_16x16x32_bf16 v[96:99], a[124:127], a[76:79], v[96:99]
    buffer_load_dwordx4 v1, s[56:59], s89 offen offset:1024 sc1 lds
    v_mfma_f32_16x16x32_bf16 v[100:103], a[124:127], a[84:87], v[100:103]
    ds_read_b128 a[28:31], v51 offset:50176
    v_mfma_f32_16x16x32_bf16 v[100:103], a[120:123], a[80:83], v[100:103]
    buffer_load_dwordx4 v1, s[56:59], s89 offen offset:2048 sc1 lds
    v_mfma_f32_16x16x32_bf16 v[104:107], a[120:123], a[88:91], v[104:107]
    ds_read_b128 a[40:43], v52 offset:43008
    v_mfma_f32_16x16x32_bf16 v[104:107], a[124:127], a[92:95], v[104:107]
    buffer_load_dwordx4 v1, s[56:59], s89 offen offset:3072 sc1 lds
    v_mfma_f32_16x16x32_bf16 v[108:111], a[124:127], a[100:103], v[108:111]
    s_sub_u32 s89, s89, 106496
    ds_read_b128 a[44:47], v52 offset:44032
    v_mfma_f32_16x16x32_bf16 v[108:111], a[120:123], a[96:99], v[108:111]
    v_mfma_f32_16x16x32_bf16 v[124:127], a[128:131], a[96:99], v[124:127]
    ds_read_b128 a[48:51], v52 offset:45056
    v_mfma_f32_16x16x32_bf16 v[124:127], a[132:135], a[100:103], v[124:127]
    v_mfma_f32_16x16x32_bf16 v[120:123], a[132:135], a[92:95], v[120:123]
    ds_read_b128 a[52:55], v52 offset:46080
    v_mfma_f32_16x16x32_bf16 v[120:123], a[128:131], a[88:91], v[120:123]
    v_mfma_f32_16x16x32_bf16 v[116:119], a[128:131], a[80:83], v[116:119]
    ds_read_b128 a[56:59], v52 offset:47104
    v_mfma_f32_16x16x32_bf16 v[116:119], a[132:135], a[84:87], v[116:119]
    v_mfma_f32_16x16x32_bf16 v[112:115], a[132:135], a[76:79], v[112:115]
    ds_read_b128 a[60:63], v52 offset:48128
    v_mfma_f32_16x16x32_bf16 v[112:115], a[128:131], a[72:75], v[112:115]
    v_mfma_f32_16x16x32_bf16 v[208:211], a[136:139], a[72:75], v[208:211]
    ds_read_b128 a[64:67], v52 offset:49152
    v_mfma_f32_16x16x32_bf16 v[208:211], a[140:143], a[76:79], v[208:211]
    v_mfma_f32_16x16x32_bf16 v[212:215], a[140:143], a[84:87], v[212:215]
    ds_read_b128 a[68:71], v52 offset:50176
    v_mfma_f32_16x16x32_bf16 v[212:215], a[136:139], a[80:83], v[212:215]
    v_mfma_f32_16x16x32_bf16 v[216:219], a[136:139], a[88:91], v[216:219]
    v_mfma_f32_16x16x32_bf16 v[216:219], a[140:143], a[92:95], v[216:219]
    v_mfma_f32_16x16x32_bf16 v[220:223], a[140:143], a[100:103], v[220:223]
    v_mfma_f32_16x16x32_bf16 v[220:223], a[136:139], a[96:99], v[220:223]
    s_waitcnt lgkmcnt(0)
    s_waitcnt vmcnt(22)
    s_barrier
    v_cmp_gt_u32 vcc, 0x800, v21
    s_cbranch_vccnz M_pob_spin
M_pob_back:
    v_mfma_f32_16x16x32_bf16 v[64:67], a[32:35], a[0:3], v[64:67]
    s_add_u32 m0, s15, 40960
    ds_read_b128 a[104:107], v53 offset:0
    v_mfma_f32_16x16x32_bf16 v[64:67], a[36:39], a[4:7], v[64:67]
    buffer_load_dwordx4 v1, s[60:63], s90 offen offset:0 sc1 lds
    v_mfma_f32_16x16x32_bf16 v[68:71], a[36:39], a[12:15], v[68:71]
    ds_read_b128 a[108:111], v53 offset:1024
    v_mfma_f32_16x16x32_bf16 v[68:71], a[32:35], a[8:11], v[68:71]
    buffer_store_dwordx4 v[244:247], v14, s[48:51], s19 offen sc1
    v_mfma_f32_16x16x32_bf16 v[72:75], a[32:35], a[16:19], v[72:75]
    ds_read_b128 a[72:75], v48 offset:0
    v_mfma_f32_16x16x32_bf16 v[72:75], a[36:39], a[20:23], v[72:75]
    buffer_load_dwordx4 v1, s[60:63], s90 offen offset:1024 sc1 lds
    v_mfma_f32_16x16x32_bf16 v[76:79], a[36:39], a[28:31], v[76:79]
    ds_read_b128 a[76:79], v48 offset:1024
    v_mfma_f32_16x16x32_bf16 v[76:79], a[32:35], a[24:27], v[76:79]
    buffer_load_dwordx4 v1, s[60:63], s90 offen offset:2048 sc1 lds
    v_mfma_f32_16x16x32_bf16 v[92:95], a[40:43], a[24:27], v[92:95]
    ds_read_b128 a[80:83], v49 offset:0
    v_mfma_f32_16x16x32_bf16 v[92:95], a[44:47], a[28:31], v[92:95]
    buffer_load_dwordx4 v1, s[60:63], s90 offen offset:3072 sc1 lds
    v_mfma_f32_16x16x32_bf16 v[88:91], a[44:47], a[20:23], v[88:91]
    s_add_u32 m0, s15, 45056
    ds_read_b128 a[84:87], v49 offset:1024
    v_mfma_f32_16x16x32_bf16 v[88:91], a[40:43], a[16:19], v[88:91]
    buffer_load_dwordx4 v22, s[60:63], s90 offen sc1 lds
    v_mfma_f32_16x16x32_bf16 v[84:87], a[40:43], a[8:11], v[84:87]
    ds_read_b128 a[88:91], v50 offset:0
    v_mfma_f32_16x16x32_bf16 v[84:87], a[44:47], a[12:15], v[84:87]
    buffer_store_dwordx4 v[248:251], v14, s[48:51], s19 offen offset:1024 sc1
    v_mfma_f32_16x16x32_bf16 v[80:83], a[44:47], a[4:7], v[80:83]
    s_add_u32 s90, s90, 163840
    ds_read_b128 a[92:95], v50 offset:1024
    s_mov_b32 m0, s75
    v_mfma_f32_16x16x32_bf16 v[80:83], a[40:43], a[0:3], v[80:83]
    buffer_load_dwordx4 v1, s[56:59], s89 offen offset:0 sc1 lds
    v_mfma_f32_16x16x32_bf16 v[96:99], a[48:51], a[0:3], v[96:99]
    ds_read_b128 a[96:99], v51 offset:0
    v_mfma_f32_16x16x32_bf16 v[96:99], a[52:55], a[4:7], v[96:99]
    buffer_load_dwordx4 v1, s[56:59], s89 offen offset:1024 sc1 lds
    v_mfma_f32_16x16x32_bf16 v[100:103], a[52:55], a[12:15], v[100:103]
    ds_read_b128 a[100:103], v51 offset:1024
    v_mfma_f32_16x16x32_bf16 v[100:103], a[48:51], a[8:11], v[100:103]
    buffer_load_dwordx4 v1, s[56:59], s89 offen offset:2048 sc1 lds
    v_mfma_f32_16x16x32_bf16 v[104:107], a[48:51], a[16:19], v[104:107]
    ds_read_b128 a[112:115], v53 offset:2048
    v_mfma_f32_16x16x32_bf16 v[104:107], a[52:55], a[20:23], v[104:107]
    buffer_load_dwordx4 v1, s[56:59], s89 offen offset:3072 sc1 lds
    v_mfma_f32_16x16x32_bf16 v[108:111], a[52:55], a[28:31], v[108:111]
    s_add_u32 s89, s89, 16384
    ds_read_b128 a[116:119], v53 offset:3072
    v_mfma_f32_16x16x32_bf16 v[108:111], a[48:51], a[24:27], v[108:111]
    v_mfma_f32_16x16x32_bf16 v[124:127], a[56:59], a[24:27], v[124:127]
    ds_read_b128 a[120:123], v53 offset:4096
    v_mfma_f32_16x16x32_bf16 v[124:127], a[60:63], a[28:31], v[124:127]
    v_mfma_f32_16x16x32_bf16 v[120:123], a[60:63], a[20:23], v[120:123]
    ds_read_b128 a[124:127], v53 offset:5120
    v_mfma_f32_16x16x32_bf16 v[120:123], a[56:59], a[16:19], v[120:123]
    v_mfma_f32_16x16x32_bf16 v[116:119], a[56:59], a[8:11], v[116:119]
    ds_read_b128 a[128:131], v53 offset:6144
    v_mfma_f32_16x16x32_bf16 v[116:119], a[60:63], a[12:15], v[116:119]
    v_mfma_f32_16x16x32_bf16 v[112:115], a[60:63], a[4:7], v[112:115]
    ds_read_b128 a[132:135], v53 offset:7168
    v_mfma_f32_16x16x32_bf16 v[112:115], a[56:59], a[0:3], v[112:115]
    v_mfma_f32_16x16x32_bf16 v[208:211], a[64:67], a[0:3], v[208:211]
    ds_read_b128 a[136:139], v53 offset:8192
    v_mfma_f32_16x16x32_bf16 v[208:211], a[68:71], a[4:7], v[208:211]
    v_mfma_f32_16x16x32_bf16 v[212:215], a[68:71], a[12:15], v[212:215]
    ds_read_b128 a[140:143], v53 offset:9216
    v_mfma_f32_16x16x32_bf16 v[212:215], a[64:67], a[8:11], v[212:215]
    v_mfma_f32_16x16x32_bf16 v[216:219], a[64:67], a[16:19], v[216:219]
    v_mfma_f32_16x16x32_bf16 v[216:219], a[68:71], a[20:23], v[216:219]
    v_mfma_f32_16x16x32_bf16 v[220:223], a[68:71], a[28:31], v[220:223]
    v_mfma_f32_16x16x32_bf16 v[220:223], a[64:67], a[24:27], v[220:223]
    s_waitcnt lgkmcnt(0)
    s_waitcnt vmcnt(22)
    s_barrier
    v_mfma_f32_16x16x32_bf16 v[64:67], a[104:107], a[72:75], v[64:67]
    s_add_u32 m0, s15, 139264
    ds_read_b128 a[32:35], v52 offset:0
    v_mfma_f32_16x16x32_bf16 v[64:67], a[108:111], a[76:79], v[64:67]
    buffer_load_dwordx4 v1, s[60:63], s90 offen offset:0 sc1 lds
    v_mfma_f32_16x16x32_bf16 v[68:71], a[108:111], a[84:87], v[68:71]
    ds_read_b128 a[36:39], v52 offset:1024
    v_mfma_f32_16x16x32_bf16 v[68:71], a[104:107], a[80:83], v[68:71]
    ds_read_b128 a[0:3], v48 offset:16384
    v_mfma_f32_16x16x32_bf16 v[72:75], a[104:107], a[88:91], v[72:75]
    ds_read_b128 a[4:7], v48 offset:17408
    v_mfma_f32_16x16x32_bf16 v[72:75], a[108:111], a[92:95], v[72:75]
    buffer_store_dwordx2 v[252:253], v15, s[48:51], s19 offen offset:2048 sc1
    v_mfma_f32_16x16x32_bf16 v[76:79], a[108:111], a[100:103], v[76:79]
    ds_read_b128 a[8:11], v49 offset:16384
    v_mfma_f32_16x16x32_bf16 v[76:79], a[104:107], a[96:99], v[76:79]
    ds_read_b128 a[12:15], v49 offset:17408
    v_mfma_f32_16x16x32_bf16 v[92:95], a[112:115], a[96:99], v[92:95]
    ds_read_b128 a[16:19], v50 offset:16384
    v_mfma_f32_16x16x32_bf16 v[92:95], a[116:119], a[100:103], v[92:95]
    buffer_load_dwordx4 v1, s[60:63], s90 offen offset:1024 sc1 lds
    v_mfma_f32_16x16x32_bf16 v[88:91], a[116:119], a[92:95], v[88:91]
    ds_read_b128 a[20:23], v50 offset:17408
    v_mfma_f32_16x16x32_bf16 v[88:91], a[112:115], a[88:91], v[88:91]
    ds_read_b128 a[24:27], v51 offset:16384
    v_mfma_f32_16x16x32_bf16 v[84:87], a[112:115], a[80:83], v[84:87]
    ds_read_b128 a[28:31], v51 offset:17408
    v_mfma_f32_16x16x32_bf16 v[84:87], a[116:119], a[84:87], v[84:87]
    buffer_load_dwordx4 v1, s[60:63], s90 offen offset:2048 sc1 lds
    v_mfma_f32_16x16x32_bf16 v[80:83], a[116:119], a[76:79], v[80:83]
    ds_read_b128 a[40:43], v52 offset:2048
    v_mfma_f32_16x16x32_bf16 v[80:83], a[112:115], a[72:75], v[80:83]
    ds_read_b128 a[44:47], v52 offset:3072
    v_mfma_f32_16x16x32_bf16 v[96:99], a[120:123], a[72:75], v[96:99]
    ds_read_b128 a[48:51], v52 offset:4096
    v_mfma_f32_16x16x32_bf16 v[96:99], a[124:127], a[76:79], v[96:99]
    buffer_load_dwordx4 v1, s[60:63], s90 offen offset:3072 sc1 lds
    v_mfma_f32_16x16x32_bf16 v[100:103], a[124:127], a[84:87], v[100:103]
    s_add_u32 m0, s15, 143360
    ds_read_b128 a[52:55], v52 offset:5120
    v_mfma_f32_16x16x32_bf16 v[100:103], a[120:123], a[80:83], v[100:103]
    ds_read_b128 a[56:59], v52 offset:6144
    v_mfma_f32_16x16x32_bf16 v[104:107], a[120:123], a[88:91], v[104:107]
    ds_read_b128 a[60:63], v52 offset:7168
    v_mfma_f32_16x16x32_bf16 v[104:107], a[124:127], a[92:95], v[104:107]
    buffer_load_dwordx4 v22, s[60:63], s90 offen sc1 lds
    v_mfma_f32_16x16x32_bf16 v[108:111], a[124:127], a[100:103], v[108:111]
    s_add_u32 s90, s90, 163840
    ds_read_b128 a[64:67], v52 offset:8192
    s_mov_b32 m0, s72
    v_mfma_f32_16x16x32_bf16 v[108:111], a[120:123], a[96:99], v[108:111]
    ds_read_b128 a[68:71], v52 offset:9216
    v_mfma_f32_16x16x32_bf16 v[124:127], a[128:131], a[96:99], v[124:127]
    v_mfma_f32_16x16x32_bf16 v[124:127], a[132:135], a[100:103], v[124:127]
    buffer_load_dwordx4 v1, s[56:59], s89 offen offset:0 sc1 lds
    v_mfma_f32_16x16x32_bf16 v[120:123], a[132:135], a[92:95], v[120:123]
    v_mfma_f32_16x16x32_bf16 v[120:123], a[128:131], a[88:91], v[120:123]
    v_mfma_f32_16x16x32_bf16 v[116:119], a[128:131], a[80:83], v[116:119]
    v_mfma_f32_16x16x32_bf16 v[116:119], a[132:135], a[84:87], v[116:119]
    buffer_load_dwordx4 v1, s[56:59], s89 offen offset:1024 sc1 lds
    v_mfma_f32_16x16x32_bf16 v[112:115], a[132:135], a[76:79], v[112:115]
    v_mfma_f32_16x16x32_bf16 v[112:115], a[128:131], a[72:75], v[112:115]
    v_mfma_f32_16x16x32_bf16 v[208:211], a[136:139], a[72:75], v[208:211]
    v_mfma_f32_16x16x32_bf16 v[208:211], a[140:143], a[76:79], v[208:211]
    buffer_load_dwordx4 v1, s[56:59], s89 offen offset:2048 sc1 lds
    v_mfma_f32_16x16x32_bf16 v[212:215], a[140:143], a[84:87], v[212:215]
    v_mfma_f32_16x16x32_bf16 v[212:215], a[136:139], a[80:83], v[212:215]
    v_mfma_f32_16x16x32_bf16 v[216:219], a[136:139], a[88:91], v[216:219]
    v_mfma_f32_16x16x32_bf16 v[216:219], a[140:143], a[92:95], v[216:219]
    buffer_load_dwordx4 v1, s[56:59], s89 offen offset:3072 sc1 lds
    v_mfma_f32_16x16x32_bf16 v[220:223], a[140:143], a[100:103], v[220:223]
    s_add_u32 s89, s89, 16384
    v_mfma_f32_16x16x32_bf16 v[220:223], a[136:139], a[96:99], v[220:223]
    s_waitcnt lgkmcnt(0)
    s_waitcnt vmcnt(21)
    s_barrier
    v_mfma_f32_16x16x32_bf16 v[64:67], a[32:35], a[0:3], v[64:67]
    s_add_u32 m0, s15, 0
    ds_read_b128 a[104:107], v52 offset:20480
    v_mfma_f32_16x16x32_bf16 v[64:67], a[36:39], a[4:7], v[64:67]
    buffer_load_dwordx4 v1, s[60:63], s90 offen offset:0 sc1 lds
    v_mfma_f32_16x16x32_bf16 v[68:71], a[36:39], a[12:15], v[68:71]
    ds_read_b128 a[108:111], v52 offset:21504
    v_mfma_f32_16x16x32_bf16 v[68:71], a[32:35], a[8:11], v[68:71]
    ds_read_b128 a[72:75], v48 offset:32768
    v_mfma_f32_16x16x32_bf16 v[72:75], a[32:35], a[16:19], v[72:75]
    ds_read_b128 a[76:79], v48 offset:33792
    v_mfma_f32_16x16x32_bf16 v[72:75], a[36:39], a[20:23], v[72:75]
    buffer_load_dwordx4 v1, s[60:63], s90 offen offset:1024 sc1 lds
    v_mfma_f32_16x16x32_bf16 v[76:79], a[36:39], a[28:31], v[76:79]
    ds_read_b128 a[80:83], v49 offset:32768
    v_mfma_f32_16x16x32_bf16 v[76:79], a[32:35], a[24:27], v[76:79]
    ds_read_b128 a[84:87], v49 offset:33792
    v_mfma_f32_16x16x32_bf16 v[92:95], a[40:43], a[24:27], v[92:95]
    ds_read_b128 a[88:91], v50 offset:32768
    v_mfma_f32_16x16x32_bf16 v[92:95], a[44:47], a[28:31], v[92:95]
    buffer_load_dwordx4 v1, s[60:63], s90 offen offset:2048 sc1 lds
    v_mfma_f32_16x16x32_bf16 v[88:91], a[44:47], a[20:23], v[88:91]
    ds_read_b128 a[92:95], v50 offset:33792
    v_mfma_f32_16x16x32_bf16 v[88:91], a[40:43], a[16:19], v[88:91]
    ds_read_b128 a[96:99], v51 offset:32768
    v_mfma_f32_16x16x32_bf16 v[84:87], a[40:43], a[8:11], v[84:87]
    ds_read_b128 a[100:103], v51 offset:33792
    v_mfma_f32_16x16x32_bf16 v[84:87], a[44:47], a[12:15], v[84:87]
    buffer_load_dwordx4 v1, s[60:63], s90 offen offset:3072 sc1 lds
    v_mfma_f32_16x16x32_bf16 v[80:83], a[44:47], a[4:7], v[80:83]
    s_add_u32 m0, s15, 4096
    ds_read_b128 a[112:115], v52 offset:22528
    v_mfma_f32_16x16x32_bf16 v[80:83], a[40:43], a[0:3], v[80:83]
    ds_read_b128 a[116:119], v52 offset:23552
    v_mfma_f32_16x16x32_bf16 v[96:99], a[48:51], a[0:3], v[96:99]
    ds_read_b128 a[120:123], v52 offset:24576
    v_mfma_f32_16x16x32_bf16 v[96:99], a[52:55], a[4:7], v[96:99]
    buffer_load_dwordx4 v22, s[60:63], s90 offen sc1 lds
    v_mfma_f32_16x16x32_bf16 v[100:103], a[52:55], a[12:15], v[100:103]
    s_add_u32 s90, s90, 163840
    ds_read_b128 a[124:127], v52 offset:25600
    s_mov_b32 m0, s73
    v_mfma_f32_16x16x32_bf16 v[100:103], a[48:51], a[8:11], v[100:103]
    ds_read_b128 a[128:131], v52 offset:26624
    v_mfma_f32_16x16x32_bf16 v[104:107], a[48:51], a[16:19], v[104:107]
    ds_read_b128 a[132:135], v52 offset:27648
    v_mfma_f32_16x16x32_bf16 v[104:107], a[52:55], a[20:23], v[104:107]
    buffer_load_dwordx4 v1, s[56:59], s89 offen offset:0 sc1 lds
    v_mfma_f32_16x16x32_bf16 v[108:111], a[52:55], a[28:31], v[108:111]
    ds_read_b128 a[136:139], v52 offset:28672
    v_mfma_f32_16x16x32_bf16 v[108:111], a[48:51], a[24:27], v[108:111]
    ds_read_b128 a[140:143], v52 offset:29696
    v_mfma_f32_16x16x32_bf16 v[124:127], a[56:59], a[24:27], v[124:127]
    v_mfma_f32_16x16x32_bf16 v[124:127], a[60:63], a[28:31], v[124:127]
    buffer_load_dwordx4 v1, s[56:59], s89 offen offset:1024 sc1 lds
    v_mfma_f32_16x16x32_bf16 v[120:123], a[60:63], a[20:23], v[120:123]
    v_mfma_f32_16x16x32_bf16 v[120:123], a[56:59], a[16:19], v[120:123]
    v_mfma_f32_16x16x32_bf16 v[116:119], a[56:59], a[8:11], v[116:119]
    v_mfma_f32_16x16x32_bf16 v[116:119], a[60:63], a[12:15], v[116:119]
    buffer_load_dwordx4 v1, s[56:59], s89 offen offset:2048 sc1 lds
    v_mfma_f32_16x16x32_bf16 v[112:115], a[60:63], a[4:7], v[112:115]
    v_mfma_f32_16x16x32_bf16 v[112:115], a[56:59], a[0:3], v[112:115]
    v_mfma_f32_16x16x32_bf16 v[208:211], a[64:67], a[0:3], v[208:211]
    v_mfma_f32_16x16x32_bf16 v[208:211], a[68:71], a[4:7], v[208:211]
    buffer_load_dwordx4 v1, s[56:59], s89 offen offset:3072 sc1 lds
    v_mfma_f32_16x16x32_bf16 v[212:215], a[68:71], a[12:15], v[212:215]
    s_add_u32 s89, s89, 16384
    v_mfma_f32_16x16x32_bf16 v[212:215], a[64:67], a[8:11], v[212:215]
    v_mfma_f32_16x16x32_bf16 v[216:219], a[64:67], a[16:19], v[216:219]
    v_mfma_f32_16x16x32_bf16 v[216:219], a[68:71], a[20:23], v[216:219]
    v_mfma_f32_16x16x32_bf16 v[220:223], a[68:71], a[28:31], v[220:223]
    v_mfma_f32_16x16x32_bf16 v[220:223], a[64:67], a[24:27], v[220:223]
    s_waitcnt lgkmcnt(0)
    s_waitcnt vmcnt(17)
    s_barrier
    v_mfma_f32_16x16x32_bf16 v[64:67], a[104:107], a[72:75], v[64:67]
    ds_read_b128 a[32:35], v52 offset:40960
    v_mfma_f32_16x16x32_bf16 v[64:67], a[108:111], a[76:79], v[64:67]
    buffer_atomic_add v32, v33, s[40:43], s13 offen
    v_mfma_f32_16x16x32_bf16 v[68:71], a[108:111], a[84:87], v[68:71]
    s_add_u32 m0, s15, 20480
    ds_read_b128 a[36:39], v52 offset:41984
    v_mfma_f32_16x16x32_bf16 v[68:71], a[104:107], a[80:83], v[68:71]
    ds_read_b128 a[0:3], v48 offset:49152
    v_mfma_f32_16x16x32_bf16 v[72:75], a[104:107], a[88:91], v[72:75]
    ds_read_b128 a[4:7], v48 offset:50176
    v_mfma_f32_16x16x32_bf16 v[72:75], a[108:111], a[92:95], v[72:75]
    buffer_load_dwordx4 v1, s[60:63], s90 offen offset:0 sc1 lds
    v_mfma_f32_16x16x32_bf16 v[76:79], a[108:111], a[100:103], v[76:79]
    ds_read_b128 a[8:11], v49 offset:49152
    v_mfma_f32_16x16x32_bf16 v[76:79], a[104:107], a[96:99], v[76:79]
    ds_read_b128 a[12:15], v49 offset:50176
    v_mfma_f32_16x16x32_bf16 v[92:95], a[112:115], a[96:99], v[92:95]
    ds_read_b128 a[16:19], v50 offset:49152
    v_mfma_f32_16x16x32_bf16 v[92:95], a[116:119], a[100:103], v[92:95]
    buffer_load_dwordx4 v1, s[60:63], s90 offen offset:1024 sc1 lds
    v_mfma_f32_16x16x32_bf16 v[88:91], a[116:119], a[92:95], v[88:91]
    ds_read_b128 a[20:23], v50 offset:50176
    v_mfma_f32_16x16x32_bf16 v[88:91], a[112:115], a[88:91], v[88:91]
    ds_read_b128 a[24:27], v51 offset:49152
    v_mfma_f32_16x16x32_bf16 v[84:87], a[112:115], a[80:83], v[84:87]
    ds_read_b128 a[28:31], v51 offset:50176
    v_mfma_f32_16x16x32_bf16 v[84:87], a[116:119], a[84:87], v[84:87]
    buffer_load_dwordx4 v1, s[60:63], s90 offen offset:2048 sc1 lds
    v_mfma_f32_16x16x32_bf16 v[80:83], a[116:119], a[76:79], v[80:83]
    ds_read_b128 a[40:43], v52 offset:43008
    v_mfma_f32_16x16x32_bf16 v[80:83], a[112:115], a[72:75], v[80:83]
    ds_read_b128 a[44:47], v52 offset:44032
    v_mfma_f32_16x16x32_bf16 v[96:99], a[120:123], a[72:75], v[96:99]
    ds_read_b128 a[48:51], v52 offset:45056
    v_mfma_f32_16x16x32_bf16 v[96:99], a[124:127], a[76:79], v[96:99]
    buffer_load_dwordx4 v1, s[60:63], s90 offen offset:3072 sc1 lds
    v_mfma_f32_16x16x32_bf16 v[100:103], a[124:127], a[84:87], v[100:103]
    s_add_u32 m0, s15, 24576
    ds_read_b128 a[52:55], v52 offset:46080
    v_mfma_f32_16x16x32_bf16 v[100:103], a[120:123], a[80:83], v[100:103]
    ds_read_b128 a[56:59], v52 offset:47104
    v_mfma_f32_16x16x32_bf16 v[104:107], a[120:123], a[88:91], v[104:107]
    ds_read_b128 a[60:63], v52 offset:48128
    v_mfma_f32_16x16x32_bf16 v[104:107], a[124:127], a[92:95], v[104:107]
    buffer_load_dwordx4 v22, s[60:63], s90 offen sc1 lds
    v_mfma_f32_16x16x32_bf16 v[108:111], a[124:127], a[100:103], v[108:111]
    s_add_u32 s90, s90, 163840
    ds_read_b128 a[64:67], v52 offset:49152
    s_mov_b32 m0, s74
    v_mfma_f32_16x16x32_bf16 v[108:111], a[120:123], a[96:99], v[108:111]
    ds_read_b128 a[68:71], v52 offset:50176
    v_mfma_f32_16x16x32_bf16 v[124:127], a[128:131], a[96:99], v[124:127]
    v_mfma_f32_16x16x32_bf16 v[124:127], a[132:135], a[100:103], v[124:127]
    buffer_load_dwordx4 v1, s[56:59], s89 offen offset:0 sc1 lds
    v_mfma_f32_16x16x32_bf16 v[120:123], a[132:135], a[92:95], v[120:123]
    v_mfma_f32_16x16x32_bf16 v[120:123], a[128:131], a[88:91], v[120:123]
    v_mfma_f32_16x16x32_bf16 v[116:119], a[128:131], a[80:83], v[116:119]
    v_mfma_f32_16x16x32_bf16 v[116:119], a[132:135], a[84:87], v[116:119]
    buffer_load_dwordx4 v1, s[56:59], s89 offen offset:1024 sc1 lds
    v_mfma_f32_16x16x32_bf16 v[112:115], a[132:135], a[76:79], v[112:115]
    v_mfma_f32_16x16x32_bf16 v[112:115], a[128:131], a[72:75], v[112:115]
    v_mfma_f32_16x16x32_bf16 v[208:211], a[136:139], a[72:75], v[208:211]
    v_mfma_f32_16x16x32_bf16 v[208:211], a[140:143], a[76:79], v[208:211]
    buffer_load_dwordx4 v1, s[56:59], s89 offen offset:2048 sc1 lds
    v_mfma_f32_16x16x32_bf16 v[212:215], a[140:143], a[84:87], v[212:215]
    v_mfma_f32_16x16x32_bf16 v[212:215], a[136:139], a[80:83], v[212:215]
    v_mfma_f32_16x16x32_bf16 v[216:219], a[136:139], a[88:91], v[216:219]
    v_mfma_f32_16x16x32_bf16 v[216:219], a[140:143], a[92:95], v[216:219]
    buffer_load_dwordx4 v1, s[56:59], s89 offen offset:3072 sc1 lds
    v_mfma_f32_16x16x32_bf16 v[220:223], a[140:143], a[100:103], v[220:223]
    s_add_u32 s89, s89, 16384
    v_mfma_f32_16x16x32_bf16 v[220:223], a[136:139], a[96:99], v[220:223]
    s_waitcnt lgkmcnt(0)
    s_waitcnt vmcnt(19)
    s_barrier
    v_mfma_f32_16x16x32_bf16 v[64:67], a[32:35], a[0:3], v[64:67]
    s_add_u32 m0, s15, 40960
    ds_read_b128 a[104:107], v53 offset:0
    v_mfma_f32_16x16x32_bf16 v[64:67], a[36:39], a[4:7], v[64:67]
    buffer_load_dwordx4 v1, s[60:63], s90 offen offset:0 sc1 lds
    v_mfma_f32_16x16x32_bf16 v[68:71], a[36:39], a[12:15], v[68:71]
    ds_read_b128 a[108:111], v53 offset:1024
    v_mfma_f32_16x16x32_bf16 v[68:71], a[32:35], a[8:11], v[68:71]
    ds_read_b128 a[72:75], v48 offset:0
    v_mfma_f32_16x16x32_bf16 v[72:75], a[32:35], a[16:19], v[72:75]
    ds_read_b128 a[76:79], v48 offset:1024
    v_mfma_f32_16x16x32_bf16 v[72:75], a[36:39], a[20:23], v[72:75]
    buffer_load_dwordx4 v1, s[60:63], s90 offen offset:1024 sc1 lds
    v_mfma_f32_16x16x32_bf16 v[76:79], a[36:39], a[28:31], v[76:79]
    ds_read_b128 a[80:83], v49 offset:0
    v_mfma_f32_16x16x32_bf16 v[76:79], a[32:35], a[24:27], v[76:79]
    ds_read_b128 a[84:87], v49 offset:1024
    v_mfma_f32_16x16x32_bf16 v[92:95], a[40:43], a[24:27], v[92:95]
    ds_read_b128 a[88:91], v50 offset:0
    v_mfma_f32_16x16x32_bf16 v[92:95], a[44:47], a[28:31], v[92:95]
    buffer_load_dwordx4 v1, s[60:63], s90 offen offset:2048 sc1 lds
    v_mfma_f32_16x16x32_bf16 v[88:91], a[44:47], a[20:23], v[88:91]
    ds_read_b128 a[92:95], v50 offset:1024
    v_mfma_f32_16x16x32_bf16 v[88:91], a[40:43], a[16:19], v[88:91]
    ds_read_b128 a[96:99], v51 offset:0
    v_mfma_f32_16x16x32_bf16 v[84:87], a[40:43], a[8:11], v[84:87]
    ds_read_b128 a[100:103], v51 offset:1024
    v_mfma_f32_16x16x32_bf16 v[84:87], a[44:47], a[12:15], v[84:87]
    buffer_load_dwordx4 v1, s[60:63], s90 offen offset:3072 sc1 lds
    v_mfma_f32_16x16x32_bf16 v[80:83], a[44:47], a[4:7], v[80:83]
    s_add_u32 m0, s15, 45056
    ds_read_b128 a[112:115], v53 offset:2048
    v_mfma_f32_16x16x32_bf16 v[80:83], a[40:43], a[0:3], v[80:83]
    ds_read_b128 a[116:119], v53 offset:3072
    v_mfma_f32_16x16x32_bf16 v[96:99], a[48:51], a[0:3], v[96:99]
    ds_read_b128 a[120:123], v53 offset:4096
    v_mfma_f32_16x16x32_bf16 v[96:99], a[52:55], a[4:7], v[96:99]
    buffer_load_dwordx4 v22, s[60:63], s90 offen sc1 lds
    v_mfma_f32_16x16x32_bf16 v[100:103], a[52:55], a[12:15], v[100:103]
    s_add_u32 s90, s90, 163840
    ds_read_b128 a[124:127], v53 offset:5120
    s_mov_b32 m0, s75
    v_mfma_f32_16x16x32_bf16 v[100:103], a[48:51], a[8:11], v[100:103]
    ds_read_b128 a[128:131], v53 offset:6144
    v_mfma_f32_16x16x32_bf16 v[104:107], a[48:51], a[16:19], v[104:107]
    ds_read_b128 a[132:135], v53 offset:7168
    v_mfma_f32_16x16x32_bf16 v[104:107], a[52:55], a[20:23], v[104:107]
    buffer_load_dwordx4 v1, s[56:59], s89 offen offset:0 sc1 lds
    v_mfma_f32_16x16x32_bf16 v[108:111], a[52:55], a[28:31], v[108:111]
    ds_read_b128 a[136:139], v53 offset:8192
    v_mfma_f32_16x16x32_bf16 v[108:111], a[48:51], a[24:27], v[108:111]
    ds_read_b128 a[140:143], v53 offset:9216
    v_mfma_f32_16x16x32_bf16 v[124:127], a[56:59], a[24:27], v[124:127]
    v_mfma_f32_16x16x32_bf16 v[124:127], a[60:63], a[28:31], v[124:127]
    buffer_load_dwordx4 v1, s[56:59], s89 offen offset:1024 sc1 lds
    v_mfma_f32_16x16x32_bf16 v[120:123], a[60:63], a[20:23], v[120:123]
    v_mfma_f32_16x16x32_bf16 v[120:123], a[56:59], a[16:19], v[120:123]
    v_mfma_f32_16x16x32_bf16 v[116:119], a[56:59], a[8:11], v[116:119]
    v_mfma_f32_16x16x32_bf16 v[116:119], a[60:63], a[12:15], v[116:119]
    buffer_load_dwordx4 v1, s[56:59], s89 offen offset:2048 sc1 lds
    v_mfma_f32_16x16x32_bf16 v[112:115], a[60:63], a[4:7], v[112:115]
    v_mfma_f32_16x16x32_bf16 v[112:115], a[56:59], a[0:3], v[112:115]
    v_mfma_f32_16x16x32_bf16 v[208:211], a[64:67], a[0:3], v[208:211]
    v_mfma_f32_16x16x32_bf16 v[208:211], a[68:71], a[4:7], v[208:211]
    buffer_load_dwordx4 v1, s[56:59], s89 offen offset:3072 sc1 lds
    v_mfma_f32_16x16x32_bf16 v[212:215], a[68:71], a[12:15], v[212:215]
    s_add_u32 s89, s89, 16384
    v_mfma_f32_16x16x32_bf16 v[212:215], a[64:67], a[8:11], v[212:215]
    v_mfma_f32_16x16x32_bf16 v[216:219], a[64:67], a[16:19], v[216:219]
    v_mfma_f32_16x16x32_bf16 v[216:219], a[68:71], a[20:23], v[216:219]
    v_mfma_f32_16x16x32_bf16 v[220:223], a[68:71], a[28:31], v[220:223]
    v_mfma_f32_16x16x32_bf16 v[220:223], a[64:67], a[24:27], v[220:223]
    s_waitcnt lgkmcnt(0)
    s_waitcnt vmcnt(19)
    s_barrier
    v_mfma_f32_16x16x32_bf16 v[64:67], a[104:107], a[72:75], v[64:67]
    s_add_u32 m0, s15, 139264
    ds_read_b128 a[32:35], v52 offset:0
    v_mfma_f32_16x16x32_bf16 v[64:67], a[108:111], a[76:79], v[64:67]
    buffer_load_dwordx4 v1, s[60:63], s90 offen offset:0 sc1 lds
    v_mfma_f32_16x16x32_bf16 v[68:71], a[108:111], a[84:87], v[68:71]
    ds_read_b128 a[36:39], v52 offset:1024
    v_mfma_f32_16x16x32_bf16 v[68:71], a[104:107], a[80:83], v[68:71]
    ds_read_b128 a[0:3], v48 offset:16384
    v_mfma_f32_16x16x32_bf16 v[72:75], a[104:107], a[88:91], v[72:75]
    ds_read_b128 a[4:7], v48 offset:17408
    v_mfma_f32_16x16x32_bf16 v[72:75], a[108:111], a[92:95], v[72:75]
    buffer_load_dwordx4 v1, s[60:63], s90 offen offset:1024 sc1 lds
    v_mfma_f32_16x16x32_bf16 v[76:79], a[108:111], a[100:103], v[76:79]
    ds_read_b128 a[8:11], v49 offset:16384
    v_mfma_f32_16x16x32_bf16 v[76:79], a[104:107], a[96:99], v[76:79]
    ds_read_b128 a[12:15], v49 offset:17408
    v_mfma_f32_16x16x32_bf16 v[92:95], a[112:115], a[96:99], v[92:95]
    ds_read_b128 a[16:19], v50 offset:16384
    v_mfma_f32_16x16x32_bf16 v[92:95], a[116:119], a[100:103], v[92:95]
    buffer_load_dwordx4 v1, s[60:63], s90 offen offset:2048 sc1 lds
    v_mfma_f32_16x16x32_bf16 v[88:91], a[116:119], a[92:95], v[88:91]
    ds_read_b128 a[20:23], v50 offset:17408
    v_mfma_f32_16x16x32_bf16 v[88:91], a[112:115], a[88:91], v[88:91]
    ds_read_b128 a[24:27], v51 offset:16384
    v_mfma_f32_16x16x32_bf16 v[84:87], a[112:115], a[80:83], v[84:87]
    ds_read_b128 a[28:31], v51 offset:17408
    v_mfma_f32_16x16x32_bf16 v[84:87], a[116:119], a[84:87], v[84:87]
    buffer_load_dwordx4 v1, s[60:63], s90 offen offset:3072 sc1 lds
    v_mfma_f32_16x16x32_bf16 v[80:83], a[116:119], a[76:79], v[80:83]
    s_add_u32 m0, s15, 143360
    ds_read_b128 a[40:43], v52 offset:2048
    v_mfma_f32_16x16x32_bf16 v[80:83], a[112:115], a[72:75], v[80:83]
    ds_read_b128 a[44:47], v52 offset:3072
    v_mfma_f32_16x16x32_bf16 v[96:99], a[120:123], a[72:75], v[96:99]
    ds_read_b128 a[48:51], v52 offset:4096
    v_mfma_f32_16x16x32_bf16 v[96:99], a[124:127], a[76:79], v[96:99]
    buffer_load_dwordx4 v22, s[60:63], s90 offen sc1 lds
    v_mfma_f32_16x16x32_bf16 v[100:103], a[124:127], a[84:87], v[100:103]
    s_add_u32 s90, s90, 163840
    ds_read_b128 a[52:55], v52 offset:5120
    s_mov_b32 m0, s72
    v_mfma_f32_16x16x32_bf16 v[100:103], a[120:123], a[80:83], v[100:103]
    ds_read_b128 a[56:59], v52 offset:6144
    v_mfma_f32_16x16x32_bf16 v[104:107], a[120:123], a[88:91], v[104:107]
    ds_read_b128 a[60:63], v52 offset:7168
    v_mfma_f32_16x16x32_bf16 v[104:107], a[124:127], a[92:95], v[104:107]
    buffer_load_dwordx4 v1, s[56:59], s89 offen offset:0 sc1 lds
    v_mfma_f32_16x16x32_bf16 v[108:111], a[124:127], a[100:103], v[108:111]
    ds_read_b128 a[64:67], v52 offset:8192
    v_mfma_f32_16x16x32_bf16 v[108:111], a[120:123], a[96:99], v[108:111]
    ds_read_b128 a[68:71], v52 offset:9216
    v_mfma_f32_16x16x32_bf16 v[124:127], a[128:131], a[96:99], v[124:127]
    v_mfma_f32_16x16x32_bf16 v[124:127], a[132:135], a[100:103], v[124:127]
    buffer_load_dwordx4 v1, s[56:59], s89 offen offset:1024 sc1 lds
    v_mfma_f32_16x16x32_bf16 v[120:123], a[132:135], a[92:95], v[120:123]
    v_mfma_f32_16x16x32_bf16 v[120:123], a[128:131], a[88:91], v[120:123]
    v_mfma_f32_16x16x32_bf16 v[116:119], a[128:131], a[80:83], v[116:119]
    v_mfma_f32_16x16x32_bf16 v[116:119], a[132:135], a[84:87], v[116:119]
    buffer_load_dwordx4 v1, s[56:59], s89 offen offset:2048 sc1 lds
    v_mfma_f32_16x16x32_bf16 v[112:115], a[132:135], a[76:79], v[112:115]
    v_mfma_f32_16x16x32_bf16 v[112:115], a[128:131], a[72:75], v[112:115]
    v_mfma_f32_16x16x32_bf16 v[208:211], a[136:139], a[72:75], v[208:211]
    v_mfma_f32_16x16x32_bf16 v[208:211], a[140:143], a[76:79], v[208:211]
    buffer_load_dwordx4 v1, s[56:59], s89 offen offset:3072 sc1 lds
    v_mfma_f32_16x16x32_bf16 v[212:215], a[140:143], a[84:87], v[212:215]
    s_add_u32 s89, s89, 16384
    v_mfma_f32_16x16x32_bf16 v[212:215], a[136:139], a[80:83], v[212:215]
    v_mfma_f32_16x16x32_bf16 v[216:219], a[136:139], a[88:91], v[216:219]
    v_mfma_f32_16x16x32_bf16 v[216:219], a[140:143], a[92:95], v[216:219]
    v_mfma_f32_16x16x32_bf16 v[220:223], a[140:143], a[100:103], v[220:223]
    v_mfma_f32_16x16x32_bf16 v[220:223], a[136:139], a[96:99], v[220:223]
    s_waitcnt lgkmcnt(0)
    s_waitcnt vmcnt(18)
    s_barrier
    v_mfma_f32_16x16x32_bf16 v[64:67], a[32:35], a[0:3], v[64:67]
    ds_read_b128 a[104:107], v52 offset:20480
    v_mfma_f32_16x16x32_bf16 v[64:67], a[36:39], a[4:7], v[64:67]
    buffer_load_dword v21, off, s[40:43], s13 sc1
    v_mfma_f32_16x16x32_bf16 v[68:71], a[36:39], a[12:15], v[68:71]
    s_add_u32 m0, s15, 0
    ds_read_b128 a[108:111], v52 offset:21504
    v_mfma_f32_16x16x32_bf16 v[68:71], a[32:35], a[8:11], v[68:71]
    ds_read_b128 a[72:75], v48 offset:32768
    v_mfma_f32_16x16x32_bf16 v[72:75], a[32:35], a[16:19], v[72:75]
    ds_read_b128 a[76:79], v48 offset:33792
    v_mfma_f32_16x16x32_bf16 v[72:75], a[36:39], a[20:23], v[72:75]
    buffer_load_dwordx4 v1, s[60:63], s90 offen offset:0 sc1 lds
    v_mfma_f32_16x16x32_bf16 v[76:79], a[36:39], a[28:31], v[76:79]
    ds_read_b128 a[80:83], v49 offset:32768
    v_mfma_f32_16x16x32_bf16 v[76:79], a[32:35], a[24:27], v[76:79]
    ds_read_b128 a[84:87], v49 offset:33792
    v_mfma_f32_16x16x32_bf16 v[92:95], a[40:43], a[24:27], v[92:95]
    ds_read_b128 a[88:91], v50 offset:32768
    v_mfma_f32_16x16x32_bf16 v[92:95], a[44:47], a[28:31], v[92:95]
    buffer_load_dwordx4 v1, s[60:63], s90 offen offset:1024 sc1 lds
    v_mfma_f32_16x16x32_bf16 v[88:91], a[44:47], a[20:23], v[88:91]
    ds_read_b128 a[92:95], v50 offset:33792
    v_mfma_f32_16x16x32_bf16 v[88:91], a[40:43], a[16:19], v[88:91]
    ds_read_b128 a[96:99], v51 offset:32768
    v_mfma_f32_16x16x32_bf16 v[84:87], a[40:43], a[8:11], v[84:87]
    ds_read_b128 a[100:103], v51 offset:33792
    v_mfma_f32_16x16x32_bf16 v[84:87], a[44:47], a[12:15], v[84:87]
    buffer_load_dwordx4 v1, s[60:63], s90 offen offset:2048 sc1 lds
    v_mfma_f32_16x16x32_bf16 v[80:83], a[44:47], a[4:7], v[80:83]
    ds_read_b128 a[112:115], v52 offset:22528
    v_mfma_f32_16x16x32_bf16 v[80:83], a[40:43], a[0:3], v[80:83]
    ds_read_b128 a[116:119], v52 offset:23552
    v_mfma_f32_16x16x32_bf16 v[96:99], a[48:51], a[0:3], v[96:99]
    ds_read_b128 a[120:123], v52 offset:24576
    v_mfma_f32_16x16x32_bf16 v[96:99], a[52:55], a[4:7], v[96:99]
    buffer_load_dwordx4 v1, s[60:63], s90 offen offset:3072 sc1 lds
    v_mfma_f32_16x16x32_bf16 v[100:103], a[52:55], a[12:15], v[100:103]
    s_add_u32 m0, s15, 4096
    ds_read_b128 a[124:127], v52 offset:25600
    v_mfma_f32_16x16x32_bf16 v[100:103], a[48:51], a[8:11], v[100:103]
    ds_read_b128 a[128:131], v52 offset:26624
    v_mfma_f32_16x16x32_bf16 v[104:107], a[48:51], a[16:19], v[104:107]
    ds_read_b128 a[132:135], v52 offset:27648
    v_mfma_f32_16x16x32_bf16 v[104:107], a[52:55], a[20:23], v[104:107]
    buffer_load_dwordx4 v22, s[60:63], s90 offen sc1 lds
    v_mfma_f32_16x16x32_bf16 v[108:111], a[52:55], a[28:31], v[108:111]
    s_add_u32 s90, s90, 163840
    ds_read_b128 a[136:139], v52 offset:28672
    s_mov_b32 m0, s73
    v_mfma_f32_16x16x32_bf16 v[108:111], a[48:51], a[24:27], v[108:111]
    ds_read_b128 a[140:143], v52 offset:29696
    v_mfma_f32_16x16x32_bf16 v[124:127], a[56:59], a[24:27], v[124:127]
    v_mfma_f32_16x16x32_bf16 v[124:127], a[60:63], a[28:31], v[124:127]
    buffer_load_dwordx4 v1, s[56:59], s89 offen offset:0 sc1 lds
    v_mfma_f32_16x16x32_bf16 v[120:123], a[60:63], a[20:23], v[120:123]
    v_mfma_f32_16x16x32_bf16 v[120:123], a[56:59], a[16:19], v[120:123]
    v_mfma_f32_16x16x32_bf16 v[116:119], a[56:59], a[8:11], v[116:119]
    v_mfma_f32_16x16x32_bf16 v[116:119], a[60:63], a[12:15], v[116:119]
    buffer_load_dwordx4 v1, s[56:59], s89 offen offset:1024 sc1 lds
    v_mfma_f32_16x16x32_bf16 v[112:115], a[60:63], a[4:7], v[112:115]
    v_mfma_f32_16x16x32_bf16 v[112:115], a[56:59], a[0:3], v[112:115]
    v_mfma_f32_16x16x32_bf16 v[208:211], a[64:67], a[0:3], v[208:211]
    v_mfma_f32_16x16x32_bf16 v[208:211], a[68:71], a[4:7], v[208:211]
    buffer_load_dwordx4 v1, s[56:59], s89 offen offset:2048 sc1 lds
    v_mfma_f32_16x16x32_bf16 v[212:215], a[68:71], a[12:15], v[212:215]
    v_mfma_f32_16x16x32_bf16 v[212:215], a[64:67], a[8:11], v[212:215]
    v_mfma_f32_16x16x32_bf16 v[216:219], a[64:67], a[16:19], v[216:219]
    v_mfma_f32_16x16x32_bf16 v[216:219], a[68:71], a[20:23], v[216:219]
    buffer_load_dwordx4 v1, s[56:59], s89 offen offset:3072 sc1 lds
    v_mfma_f32_16x16x32_bf16 v[220:223], a[68:71], a[28:31], v[220:223]
    s_add_u32 s89, s89, 16384
    v_mfma_f32_16x16x32_bf16 v[220:223], a[64:67], a[24:27], v[220:223]
    s_waitcnt lgkmcnt(0)
    s_waitcnt vmcnt(19)
    s_barrier
    v_mfma_f32_16x16x32_bf16 v[64:67], a[104:107], a[72:75], v[64:67]
    s_add_u32 m0, s15, 20480
    ds_read_b128 a[32:35], v52 offset:40960
    v_mfma_f32_16x16x32_bf16 v[64:67], a[108:111], a[76:79], v[64:67]
    buffer_load_dwordx4 v1, s[60:63], s90 offen offset:0 sc1 lds
    v_mfma_f32_16x16x32_bf16 v[68:71], a[108:111], a[84:87], v[68:71]
    ds_read_b128 a[36:39], v52 offset:41984
    v_mfma_f32_16x16x32_bf16 v[68:71], a[104:107], a[80:83], v[68:71]
    ds_read_b128 a[0:3], v48 offset:49152
    v_mfma_f32_16x16x32_bf16 v[72:75], a[104:107], a[88:91], v[72:75]
    ds_read_b128 a[4:7], v48 offset:50176
    v_mfma_f32_16x16x32_bf16 v[72:75], a[108:111], a[92:95], v[72:75]
    buffer_load_dwordx4 v1, s[60:63], s90 offen offset:1024 sc1 lds
    v_mfma_f32_16x16x32_bf16 v[76:79], a[108:111], a[100:103], v[76:79]
    ds_read_b128 a[8:11], v49 offset:49152
    v_mfma_f32_16x16x32_bf16 v[76:79], a[104:107], a[96:99], v[76:79]
    ds_read_b128 a[12:15], v49 offset:50176
    v_mfma_f32_16x16x32_bf16 v[92:95], a[112:115], a[96:99], v[92:95]
    ds_read_b128 a[16:19], v50 offset:49152
    v_mfma_f32_16x16x32_bf16 v[92:95], a[116:119], a[100:103], v[92:95]
    buffer_load_dwordx4 v1, s[60:63], s90 offen offset:2048 sc1 lds
    v_mfma_f32_16x16x32_bf16 v[88:91], a[116:119], a[92:95], v[88:91]
    ds_read_b128 a[20:23], v50 offset:50176
    v_mfma_f32_16x16x32_bf16 v[88:91], a[112:115], a[88:91], v[88:91]
    ds_read_b128 a[24:27], v51 offset:49152
    v_mfma_f32_16x16x32_bf16 v[84:87], a[112:115], a[80:83], v[84:87]
    ds_read_b128 a[28:31], v51 offset:50176
    v_mfma_f32_16x16x32_bf16 v[84:87], a[116:119], a[84:87], v[84:87]
    buffer_load_dwordx4 v1, s[60:63], s90 offen offset:3072 sc1 lds
    v_mfma_f32_16x16x32_bf16 v[80:83], a[116:119], a[76:79], v[80:83]
    s_add_u32 m0, s15, 24576
    ds_read_b128 a[40:43], v52 offset:43008
    v_mfma_f32_16x16x32_bf16 v[80:83], a[112:115], a[72:75], v[80:83]
    ds_read_b128 a[44:47], v52 offset:44032
    v_mfma_f32_16x16x32_bf16 v[96:99], a[120:123], a[72:75], v[96:99]
    ds_read_b128 a[48:51], v52 offset:45056
    v_mfma_f32_16x16x32_bf16 v[96:99], a[124:127], a[76:79], v[96:99]
    buffer_load_dwordx4 v22, s[60:63], s90 offen sc1 lds
    v_mfma_f32_16x16x32_bf16 v[100:103], a[124:127], a[84:87], v[100:103]
    s_add_u32 s90, s90, 163840
    ds_read_b128 a[52:55], v52 offset:46080
    s_mov_b32 m0, s74
    v_mfma_f32_16x16x32_bf16 v[100:103], a[120:123], a[80:83], v[100:103]
    ds_read_b128 a[56:59], v52 offset:47104
    v_mfma_f32_16x16x32_bf16 v[104:107], a[120:123], a[88:91], v[104:107]
    ds_read_b128 a[60:63], v52 offset:48128
    v_mfma_f32_16x16x32_bf16 v[104:107], a[124:127], a[92:95], v[104:107]
    buffer_load_dwordx4 v1, s[56:59], s89 offen offset:0 sc1 lds
    v_mfma_f32_16x16x32_bf16 v[108:111], a[124:127], a[100:103], v[108:111]
    ds_read_b128 a[64:67], v52 offset:49152
    v_mfma_f32_16x16x32_bf16 v[108:111], a[120:123], a[96:99], v[108:111]
    ds_read_b128 a[68:71], v52 offset:50176
    v_mfma_f32_16x16x32_bf16 v[124:127], a[128:131], a[96:99], v[124:127]
    v_mfma_f32_16x16x32_bf16 v[124:127], a[132:135], a[100:103], v[124:127]
    buffer_load_dwordx4 v1, s[56:59], s89 offen offset:1024 sc1 lds
    v_mfma_f32_16x16x32_bf16 v[120:123], a[132:135], a[92:95], v[120:123]
    v_mfma_f32_16x16x32_bf16 v[120:123], a[128:131], a[88:91], v[120:123]
    v_mfma_f32_16x16x32_bf16 v[116:119], a[128:131], a[80:83], v[116:119]
    v_mfma_f32_16x16x32_bf16 v[116:119], a[132:135], a[84:87], v[116:119]
    buffer_load_dwordx4 v1, s[56:59], s89 offen offset:2048 sc1 lds
    v_mfma_f32_16x16x32_bf16 v[112:115], a[132:135], a[76:79], v[112:115]
    v_mfma_f32_16x16x32_bf16 v[112:115], a[128:131], a[72:75], v[112:115]
    v_mfma_f32_16x16x32_bf16 v[208:211], a[136:139], a[72:75], v[208:211]
    v_mfma_f32_16x16x32_bf16 v[208:211], a[140:143], a[76:79], v[208:211]
    buffer_load_dwordx4 v1, s[56:59], s89 offen offset:3072 sc1 lds
    v_mfma_f32_16x16x32_bf16 v[212:215], a[140:143], a[84:87], v[212:215]
    s_add_u32 s89, s89, 16384
    v_mfma_f32_16x16x32_bf16 v[212:215], a[136:139], a[80:83], v[212:215]
    v_mfma_f32_16x16x32_bf16 v[216:219], a[136:139], a[88:91], v[216:219]
    v_mfma_f32_16x16x32_bf16 v[216:219], a[140:143], a[92:95], v[216:219]
    v_mfma_f32_16x16x32_bf16 v[220:223], a[140:143], a[100:103], v[220:223]
    v_mfma_f32_16x16x32_bf16 v[220:223], a[136:139], a[96:99], v[220:223]
    s_waitcnt lgkmcnt(0)
    s_waitcnt vmcnt(18)
    s_barrier
    v_cmp_gt_u32 vcc, 4, v21
    s_cbranch_vccnz M_pg_spin
M_pg_back:
    v_mfma_f32_16x16x32_bf16 v[64:67], a[32:35], a[0:3], v[64:67]
    s_add_u32 m0, s75, 0
    ds_read_b128 a[104:107], v53 offset:0
    v_mfma_f32_16x16x32_bf16 v[64:67], a[36:39], a[4:7], v[64:67]
    buffer_load_dwordx4 v28, s[8:11], s91 offen lds
    v_mfma_f32_16x16x32_bf16 v[68:71], a[36:39], a[12:15], v[68:71]
    s_add_u32 m0, s75, 1024
    ds_read_b128 a[108:111], v53 offset:1024
    v_mfma_f32_16x16x32_bf16 v[68:71], a[32:35], a[8:11], v[68:71]
    ds_read_b128 a[72:75], v48 offset:0
    v_mfma_f32_16x16x32_bf16 v[72:75], a[32:35], a[16:19], v[72:75]
    ds_read_b128 a[76:79], v48 offset:1024
    v_mfma_f32_16x16x32_bf16 v[72:75], a[36:39], a[20:23], v[72:75]
    buffer_load_dwordx4 v29, s[8:11], s91 offen lds
    v_mfma_f32_16x16x32_bf16 v[76:79], a[36:39], a[28:31], v[76:79]
    s_add_u32 m0, s75, 2048
    ds_read_b128 a[80:83], v49 offset:0
    v_mfma_f32_16x16x32_bf16 v[76:79], a[32:35], a[24:27], v[76:79]
    ds_read_b128 a[84:87], v49 offset:1024
    v_mfma_f32_16x16x32_bf16 v[92:95], a[40:43], a[24:27], v[92:95]
    ds_read_b128 a[88:91], v50 offset:0
    v_mfma_f32_16x16x32_bf16 v[92:95], a[44:47], a[28:31], v[92:95]
    buffer_load_dwordx4 v30, s[8:11], s91 offen lds
    v_mfma_f32_16x16x32_bf16 v[88:91], a[44:47], a[20:23], v[88:91]
    ds_read_b128 a[92:95], v50 offset:1024
    v_mfma_f32_16x16x32_bf16 v[88:91], a[40:43], a[16:19], v[88:91]
    ds_read_b128 a[96:99], v51 offset:0
    v_mfma_f32_16x16x32_bf16 v[84:87], a[40:43], a[8:11], v[84:87]
    ds_read_b128 a[100:103], v51 offset:1024
    v_mfma_f32_16x16x32_bf16 v[84:87], a[44:47], a[12:15], v[84:87]
    buffer_load_dwordx4 v[132:135], v14, s[48:51], s16 offen sc1
    v_mfma_f32_16x16x32_bf16 v[80:83], a[44:47], a[4:7], v[80:83]
    ds_read_b128 a[112:115], v53 offset:2048
    v_mfma_f32_16x16x32_bf16 v[80:83], a[40:43], a[0:3], v[80:83]
    ds_read_b128 a[116:119], v53 offset:3072
    v_mfma_f32_16x16x32_bf16 v[96:99], a[48:51], a[0:3], v[96:99]
    ds_read_b128 a[120:123], v53 offset:4096
    v_mfma_f32_16x16x32_bf16 v[96:99], a[52:55], a[4:7], v[96:99]
    buffer_load_dwordx4 v[136:139], v14, s[48:51], s16 offen offset:1024 sc1
    v_mfma_f32_16x16x32_bf16 v[100:103], a[52:55], a[12:15], v[100:103]
    ds_read_b128 a[124:127], v53 offset:5120
    v_mfma_f32_16x16x32_bf16 v[100:103], a[48:51], a[8:11], v[100:103]
    ds_read_b128 a[128:131], v53 offset:6144
    v_mfma_f32_16x16x32_bf16 v[104:107], a[48:51], a[16:19], v[104:107]
    ds_read_b128 a[132:135], v53 offset:7168
    v_mfma_f32_16x16x32_bf16 v[104:107], a[52:55], a[20:23], v[104:107]
    buffer_load_dwordx2 v[140:141], v15, s[48:51], s16 offen offset:2048 sc1
    v_mfma_f32_16x16x32_bf16 v[108:111], a[52:55], a[28:31], v[108:111]
    ds_read_b128 a[136:139], v53 offset:8192
    v_mfma_f32_16x16x32_bf16 v[108:111], a[48:51], a[24:27], v[108:111]
    ds_read_b128 a[140:143], v53 offset:9216
    v_mfma_f32_16x16x32_bf16 v[124:127], a[56:59], a[24:27], v[124:127]
    v_mfma_f32_16x16x32_bf16 v[124:127], a[60:63], a[28:31], v[124:127]
    buffer_load_dwordx4 v[148:151], v14, s[48:51], s14 offen sc1
    v_mfma_f32_16x16x32_bf16 v[120:123], a[60:63], a[20:23], v[120:123]
    v_mfma_f32_16x16x32_bf16 v[120:123], a[56:59], a[16:19], v[120:123]
    v_mfma_f32_16x16x32_bf16 v[116:119], a[56:59], a[8:11], v[116:119]
    v_mfma_f32_16x16x32_bf16 v[116:119], a[60:63], a[12:15], v[116:119]
    buffer_load_dwordx4 v[152:155], v14, s[48:51], s14 offen offset:1024 sc1
    v_mfma_f32_16x16x32_bf16 v[112:115], a[60:63], a[4:7], v[112:115]
    v_mfma_f32_16x16x32_bf16 v[112:115], a[56:59], a[0:3], v[112:115]
    v_mfma_f32_16x16x32_bf16 v[208:211], a[64:67], a[0:3], v[208:211]
    v_mfma_f32_16x16x32_bf16 v[208:211], a[68:71], a[4:7], v[208:211]
    v_mfma_f32_16x16x32_bf16 v[212:215], a[68:71], a[12:15], v[212:215]
    v_mfma_f32_16x16x32_bf16 v[212:215], a[64:67], a[8:11], v[212:215]
    v_mfma_f32_16x16x32_bf16 v[216:219], a[64:67], a[16:19], v[216:219]
    v_mfma_f32_16x16x32_bf16 v[216:219], a[68:71], a[20:23], v[216:219]
    v_mfma_f32_16x16x32_bf16 v[220:223], a[68:71], a[28:31], v[220:223]
    v_mfma_f32_16x16x32_bf16 v[220:223], a[64:67], a[24:27], v[220:223]
    s_waitcnt lgkmcnt(0)
    s_waitcnt vmcnt(8)
    s_barrier
    v_mfma_f32_16x16x32_bf16 v[64:67], a[104:107], a[72:75], v[64:67]
    ds_read_b128 a[32:35], v52 offset:0
    ds_read_b128 a[36:39], v52 offset:1024
    v_mfma_f32_16x16x32_bf16 v[64:67], a[108:111], a[76:79], v[64:67]
    buffer_load_dwordx2 v[156:157], v15, s[48:51], s14 offen offset:2048 sc1
    v_mfma_f32_16x16x32_bf16 v[68:71], a[108:111], a[84:87], v[68:71]
    ds_read_b128 a[0:3], v48 offset:16384
    ds_read_b128 a[4:7], v48 offset:17408
    v_mfma_f32_16x16x32_bf16 v[68:71], a[104:107], a[80:83], v[68:71]
    v_mfma_f32_16x16x32_bf16 v[72:75], a[104:107], a[88:91], v[72:75]
    ds_read_b128 a[8:11], v49 offset:16384
    ds_read_b128 a[12:15], v49 offset:17408
    v_mfma_f32_16x16x32_bf16 v[72:75], a[108:111], a[92:95], v[72:75]
    buffer_load_dwordx4 v[164:167], v14, s[48:51], s12 offen sc1
    v_mfma_f32_16x16x32_bf16 v[76:79], a[108:111], a[100:103], v[76:79]
    ds_read_b128 a[16:19], v50 offset:16384
    ds_read_b128 a[20:23], v50 offset:17408
    v_mfma_f32_16x16x32_bf16 v[76:79], a[104:107], a[96:99], v[76:79]
    v_mfma_f32_16x16x32_bf16 v[92:95], a[112:115], a[96:99], v[92:95]
    ds_read_b128 a[24:27], v51 offset:16384
    ds_read_b128 a[28:31], v51 offset:17408
    v_mfma_f32_16x16x32_bf16 v[92:95], a[116:119], a[100:103], v[92:95]
    buffer_load_dwordx4 v[168:171], v14, s[48:51], s12 offen offset:1024 sc1
    v_mfma_f32_16x16x32_bf16 v[88:91], a[116:119], a[92:95], v[88:91]
    ds_read_b128 a[40:43], v52 offset:2048
    ds_read_b128 a[44:47], v52 offset:3072
    v_mfma_f32_16x16x32_bf16 v[88:91], a[112:115], a[88:91], v[88:91]
    v_mfma_f32_16x16x32_bf16 v[84:87], a[112:115], a[80:83], v[84:87]
    ds_read_b128 a[48:51], v52 offset:4096
    ds_read_b128 a[52:55], v52 offset:5120
    v_mfma_f32_16x16x32_bf16 v[84:87], a[116:119], a[84:87], v[84:87]
    buffer_load_dwordx2 v[172:173], v15, s[48:51], s12 offen offset:2048 sc1
    v_mfma_f32_16x16x32_bf16 v[80:83], a[116:119], a[76:79], v[80:83]
    ds_read_b128 a[56:59], v52 offset:6144
    ds_read_b128 a[60:63], v52 offset:7168
    v_mfma_f32_16x16x32_bf16 v[80:83], a[112:115], a[72:75], v[80:83]
    v_mfma_f32_16x16x32_bf16 v[96:99], a[120:123], a[72:75], v[96:99]
    ds_read_b128 a[64:67], v52 offset:8192
    ds_read_b128 a[68:71], v52 offset:9216
    v_mfma_f32_16x16x32_bf16 v[96:99], a[124:127], a[76:79], v[96:99]
    v_mfma_f32_16x16x32_bf16 v[100:103], a[124:127], a[84:87], v[100:103]
    ds_read_b128 a[176:179], v52 offset:20480
    ds_read_b128 a[180:183], v52 offset:21504
    v_mfma_f32_16x16x32_bf16 v[100:103], a[120:123], a[80:83], v[100:103]
    v_mfma_f32_16x16x32_bf16 v[104:107], a[120:123], a[88:91], v[104:107]
    ds_read_b128 a[144:147], v48 offset:32768
    ds_read_b128 a[148:151], v48 offset:33792
    v_mfma_f32_16x16x32_bf16 v[104:107], a[124:127], a[92:95], v[104:107]
    v_mfma_f32_16x16x32_bf16 v[108:111], a[124:127], a[100:103], v[108:111]
    ds_read_b128 a[152:155], v49 offset:32768
    ds_read_b128 a[156:159], v49 offset:33792
    v_mfma_f32_16x16x32_bf16 v[108:111], a[120:123], a[96:99], v[108:111]
    v_mfma_f32_16x16x32_bf16 v[124:127], a[128:131], a[96:99], v[124:127]
    ds_read_b128 a[160:163], v50 offset:32768
    ds_read_b128 a[164:167], v50 offset:33792
    v_mfma_f32_16x16x32_bf16 v[124:127], a[132:135], a[100:103], v[124:127]
    v_mfma_f32_16x16x32_bf16 v[120:123], a[132:135], a[92:95], v[120:123]
    ds_read_b128 a[168:171], v51 offset:32768
    ds_read_b128 a[172:175], v51 offset:33792
    v_mfma_f32_16x16x32_bf16 v[120:123], a[128:131], a[88:91], v[120:123]
    v_mfma_f32_16x16x32_bf16 v[116:119], a[128:131], a[80:83], v[116:119]
    ds_read_b128 a[184:187], v52 offset:22528
    ds_read_b128 a[188:191], v52 offset:23552
    v_mfma_f32_16x16x32_bf16 v[116:119], a[132:135], a[84:87], v[116:119]
    v_mfma_f32_16x16x32_bf16 v[112:115], a[132:135], a[76:79], v[112:115]
    ds_read_b128 a[192:195], v52 offset:24576
    ds_read_b128 a[196:199], v52 offset:25600
    v_mfma_f32_16x16x32_bf16 v[112:115], a[128:131], a[72:75], v[112:115]
    v_mfma_f32_16x16x32_bf16 v[208:211], a[136:139], a[72:75], v[208:211]
    ds_read_b128 a[200:203], v52 offset:26624
    ds_read_b128 a[204:207], v52 offset:27648
    v_mfma_f32_16x16x32_bf16 v[208:211], a[140:143], a[76:79], v[208:211]
    v_mfma_f32_16x16x32_bf16 v[212:215], a[140:143], a[84:87], v[212:215]
    ds_read_b128 a[208:211], v52 offset:28672
    ds_read_b128 a[212:215], v52 offset:29696
    v_mfma_f32_16x16x32_bf16 v[212:215], a[136:139], a[80:83], v[212:215]
    v_mfma_f32_16x16x32_bf16 v[216:219], a[136:139], a[88:91], v[216:219]
    v_mfma_f32_16x16x32_bf16 v[216:219], a[140:143], a[92:95], v[216:219]
    v_mfma_f32_16x16x32_bf16 v[220:223], a[140:143], a[100:103], v[220:223]
    v_mfma_f32_16x16x32_bf16 v[220:223], a[136:139], a[96:99], v[220:223]
    s_waitcnt lgkmcnt(0)
    v_mfma_f32_16x16x32_bf16 v[68:71], a[32:35], a[8:11], v[68:71]
    s_waitcnt vmcnt(9)
    ds_read_b64 v[2:3], v46 offset:0
    ds_read_b64 v[4:5], v46 offset:32
    v_mfma_f32_16x16x32_bf16 v[68:71], a[36:39], a[12:15], v[68:71]
    ds_read_b64 v[6:7], v46 offset:64
    ds_read_b64 v[8:9], v46 offset:96
    v_mfma_f32_16x16x32_bf16 v[68:71], a[176:179], a[152:155], v[68:71]
    ds_read_b64 v[10:11], v46 offset:128
    v_mfma_f32_16x16x32_bf16 v[68:71], a[180:183], a[156:159], v[68:71]
    v_mfma_f32_16x16x32_bf16 v[84:87], a[188:191], a[156:159], v[84:87]
    v_mfma_f32_16x16x32_bf16 v[84:87], a[184:187], a[152:155], v[84:87]
    v_mfma_f32_16x16x32_bf16 v[84:87], a[44:47], a[12:15], v[84:87]
    v_mfma_f32_16x16x32_bf16 v[84:87], a[40:43], a[8:11], v[84:87]
    v_mfma_f32_16x16x32_bf16 v[100:103], a[48:51], a[8:11], v[100:103]
    v_mfma_f32_16x16x32_bf16 v[100:103], a[52:55], a[12:15], v[100:103]
    v_mfma_f32_16x16x32_bf16 v[100:103], a[192:195], a[152:155], v[100:103]
    v_mfma_f32_16x16x32_bf16 v[100:103], a[196:199], a[156:159], v[100:103]
    v_mfma_f32_16x16x32_bf16 v[116:119], a[204:207], a[156:159], v[116:119]
    v_mfma_f32_16x16x32_bf16 v[116:119], a[200:203], a[152:155], v[116:119]
    v_mfma_f32_16x16x32_bf16 v[116:119], a[60:63], a[12:15], v[116:119]
    v_mfma_f32_16x16x32_bf16 v[116:119], a[56:59], a[8:11], v[116:119]
    v_mfma_f32_16x16x32_bf16 v[212:215], a[64:67], a[8:11], v[212:215]
    v_mfma_f32_16x16x32_bf16 v[212:215], a[68:71], a[12:15], v[212:215]
    v_mfma_f32_16x16x32_bf16 v[212:215], a[208:211], a[152:155], v[212:215]
    v_mfma_f32_16x16x32_bf16 v[212:215], a[212:215], a[156:159], v[212:215]
    v_mfma_f32_16x16x32_bf16 v[72:75], a[32:35], a[16:19], v[72:75]
    v_cvt_pk_bf16_f32 v224, v68, v69
    v_cvt_pk_bf16_f32 v225, v70, v71
    v_mfma_f32_16x16x32_bf16 v[72:75], a[36:39], a[20:23], v[72:75]
    v_cvt_pk_bf16_f32 v226, v84, v85
    v_cvt_pk_bf16_f32 v227, v86, v87
    v_mfma_f32_16x16x32_bf16 v[72:75], a[176:179], a[160:163], v[72:75]
    v_cvt_pk_bf16_f32 v228, v100, v101
    v_cvt_pk_bf16_f32 v229, v102, v103
    v_mfma_f32_16x16x32_bf16 v[72:75], a[180:183], a[164:167], v[72:75]
    v_cvt_pk_bf16_f32 v230, v116, v117
    v_cvt_pk_bf16_f32 v231, v118, v119
    v_mfma_f32_16x16x32_bf16 v[88:91], a[188:191], a[164:167], v[88:91]
    v_cvt_pk_bf16_f32 v232, v212, v213
    v_cvt_pk_bf16_f32 v233, v214, v215
    v_mfma_f32_16x16x32_bf16 v[88:91], a[184:187], a[160:163], v[88:91]
    v_mfma_f32_16x16x32_bf16 v[88:91], a[44:47], a[20:23], v[88:91]
    buffer_store_dwordx4 v[224:227], v1, s[48:51], s17 offen sc1
    v_mfma_f32_16x16x32_bf16 v[88:91], a[40:43], a[16:19], v[88:91]
    buffer_store_dwordx4 v[228:231], v1, s[48:51], s17 offen offset:1024 sc1
    v_mfma_f32_16x16x32_bf16 v[104:107], a[48:51], a[16:19], v[104:107]
    buffer_store_dwordx2 v[232:233], v45, s[48:51], s17 offen offset:2048 sc1
    v_mfma_f32_16x16x32_bf16 v[104:107], a[52:55], a[20:23], v[104:107]
    v_mfma_f32_16x16x32_bf16 v[104:107], a[192:195], a[160:163], v[104:107]
    v_mfma_f32_16x16x32_bf16 v[104:107], a[196:199], a[164:167], v[104:107]
    v_mfma_f32_16x16x32_bf16 v[120:123], a[204:207], a[164:167], v[120:123]
    v_mfma_f32_16x16x32_bf16 v[120:123], a[200:203], a[160:163], v[120:123]
    v_mfma_f32_16x16x32_bf16 v[120:123], a[60:63], a[20:23], v[120:123]
    v_mfma_f32_16x16x32_bf16 v[120:123], a[56:59], a[16:19], v[120:123]
    v_mfma_f32_16x16x32_bf16 v[216:219], a[64:67], a[16:19], v[216:219]
    v_mfma_f32_16x16x32_bf16 v[216:219], a[68:71], a[20:23], v[216:219]
    v_mfma_f32_16x16x32_bf16 v[216:219], a[208:211], a[160:163], v[216:219]
    v_mfma_f32_16x16x32_bf16 v[216:219], a[212:215], a[164:167], v[216:219]
    v_mfma_f32_16x16x32_bf16 v[76:79], a[32:35], a[24:27], v[76:79]
    v_cvt_pk_bf16_f32 v234, v72, v73
    v_cvt_pk_bf16_f32 v235, v74, v75
    v_mfma_f32_16x16x32_bf16 v[76:79], a[36:39], a[28:31], v[76:79]
    v_cvt_pk_bf16_f32 v236, v88, v89
    v_cvt_pk_bf16_f32 v237, v90, v91
    v_mfma_f32_16x16x32_bf16 v[76:79], a[176:179], a[168:171], v[76:79]
    v_cvt_pk_bf16_f32 v238, v104, v105
    v_cvt_pk_bf16_f32 v239, v106, v107
    v_mfma_f32_16x16x32_bf16 v[76:79], a[180:183], a[172:175], v[76:79]
    v_cvt_pk_bf16_f32 v240, v120, v121
    v_cvt_pk_bf16_f32 v241, v122, v123
    v_mfma_f32_16x16x32_bf16 v[92:95], a[188:191], a[172:175], v[92:95]
    v_cvt_pk_bf16_f32 v242, v216, v217
    v_cvt_pk_bf16_f32 v243, v218, v219
    v_mfma_f32_16x16x32_bf16 v[92:95], a[184:187], a[168:171], v[92:95]
    v_mfma_f32_16x16x32_bf16 v[92:95], a[44:47], a[28:31], v[92:95]
    buffer_store_dwordx4 v[234:237], v1, s[48:51], s18 offen sc1
    v_mfma_f32_16x16x32_bf16 v[92:95], a[40:43], a[24:27], v[92:95]
    buffer_store_dwordx4 v[238:241], v1, s[48:51], s18 offen offset:1024 sc1
    v_mfma_f32_16x16x32_bf16 v[108:111], a[48:51], a[24:27], v[108:111]
    buffer_store_dwordx2 v[242:243], v45, s[48:51], s18 offen offset:2048 sc1
    v_mfma_f32_16x16x32_bf16 v[108:111], a[52:55], a[28:31], v[108:111]
    v_mfma_f32_16x16x32_bf16 v[108:111], a[192:195], a[168:171], v[108:111]
    v_mfma_f32_16x16x32_bf16 v[108:111], a[196:199], a[172:175], v[108:111]
    v_mfma_f32_16x16x32_bf16 v[124:127], a[204:207], a[172:175], v[124:127]
    v_mfma_f32_16x16x32_bf16 v[124:127], a[200:203], a[168:171], v[124:127]
    v_mfma_f32_16x16x32_bf16 v[124:127], a[60:63], a[28:31], v[124:127]
    v_mfma_f32_16x16x32_bf16 v[124:127], a[56:59], a[24:27], v[124:127]
    v_mfma_f32_16x16x32_bf16 v[220:223], a[64:67], a[24:27], v[220:223]
    v_mfma_f32_16x16x32_bf16 v[220:223], a[68:71], a[28:31], v[220:223]
    v_mfma_f32_16x16x32_bf16 v[220:223], a[208:211], a[168:171], v[220:223]
    v_mfma_f32_16x16x32_bf16 v[220:223], a[212:215], a[172:175], v[220:223]
    v_mfma_f32_16x16x32_bf16 v[64:67], a[32:35], a[0:3], v[64:67]
    v_cvt_pk_bf16_f32 v244, v76, v77
    v_cvt_pk_bf16_f32 v245, v78, v79
    v_mfma_f32_16x16x32_bf16 v[64:67], a[36:39], a[4:7], v[64:67]
    v_cvt_pk_bf16_f32 v246, v92, v93
    v_cvt_pk_bf16_f32 v247, v94, v95
    v_mfma_f32_16x16x32_bf16 v[64:67], a[176:179], a[144:147], v[64:67]
    v_cvt_pk_bf16_f32 v248, v108, v109
    v_cvt_pk_bf16_f32 v249, v110, v111
    v_mfma_f32_16x16x32_bf16 v[64:67], a[180:183], a[148:151], v[64:67]
    v_cvt_pk_bf16_f32 v250, v124, v125
    v_cvt_pk_bf16_f32 v251, v126, v127
    v_mfma_f32_16x16x32_bf16 v[80:83], a[188:191], a[148:151], v[80:83]
    v_cvt_pk_bf16_f32 v252, v220, v221
    v_cvt_pk_bf16_f32 v253, v222, v223
    v_mfma_f32_16x16x32_bf16 v[80:83], a[184:187], a[144:147], v[80:83]
    v_mfma_f32_16x16x32_bf16 v[80:83], a[44:47], a[4:7], v[80:83]
    buffer_store_dwordx4 v[244:247], v1, s[48:51], s19 offen sc1
    v_mfma_f32_16x16x32_bf16 v[80:83], a[40:43], a[0:3], v[80:83]
    buffer_store_dwordx4 v[248:251], v1, s[48:51], s19 offen offset:1024 sc1
    v_mfma_f32_16x16x32_bf16 v[96:99], a[48:51], a[0:3], v[96:99]
    buffer_store_dwordx2 v[252:253], v45, s[48:51], s19 offen offset:2048 sc1
    v_mfma_f32_16x16x32_bf16 v[96:99], a[52:55], a[4:7], v[96:99]
    v_mfma_f32_16x16x32_bf16 v[96:99], a[192:195], a[144:147], v[96:99]
    v_mfma_f32_16x16x32_bf16 v[96:99], a[196:199], a[148:151], v[96:99]
    v_mfma_f32_16x16x32_bf16 v[112:115], a[204:207], a[148:151], v[112:115]
    v_mfma_f32_16x16x32_bf16 v[112:115], a[200:203], a[144:147], v[112:115]
    v_mfma_f32_16x16x32_bf16 v[112:115], a[60:63], a[4:7], v[112:115]
    v_mfma_f32_16x16x32_bf16 v[112:115], a[56:59], a[0:3], v[112:115]
    v_mfma_f32_16x16x32_bf16 v[208:211], a[64:67], a[0:3], v[208:211]
    v_mfma_f32_16x16x32_bf16 v[208:211], a[68:71], a[4:7], v[208:211]
    v_mfma_f32_16x16x32_bf16 v[208:211], a[208:211], a[144:147], v[208:211]
    v_mfma_f32_16x16x32_bf16 v[208:211], a[212:215], a[148:151], v[208:211]
    buffer_load_dword v21, off, s[40:43], s92 sc1
    s_mov_b32 s6, 0xbfb8aa3b
    s_mov_b32 s7, s6
    s_waitcnt lgkmcnt(0)
    s_waitcnt vmcnt(16)
    v_dot2_f32_bf16 v128, v132, v12, v128
    v_dot2_f32_bf16 v129, v132, v13, v129
    v_dot2_f32_bf16 v130, v133, v12, v130
    v_dot2_f32_bf16 v131, v133, v13, v131
    v_dot2_f32_bf16 v144, v134, v12, v144
    v_dot2_f32_bf16 v145, v134, v13, v145
    v_dot2_f32_bf16 v146, v135, v12, v146
    v_dot2_f32_bf16 v147, v135, v13, v147
    v_dot2_f32_bf16 v160, v136, v12, v160
    v_dot2_f32_bf16 v161, v136, v13, v161
    v_dot2_f32_bf16 v162, v137, v12, v162
    v_dot2_f32_bf16 v163, v137, v13, v163
    v_dot2_f32_bf16 v176, v138, v12, v176
    v_dot2_f32_bf16 v177, v138, v13, v177
    v_dot2_f32_bf16 v178, v139, v12, v178
    v_dot2_f32_bf16 v179, v139, v13, v179
    v_dot2_f32_bf16 v192, v140, v12, v192
    v_dot2_f32_bf16 v193, v140, v13, v193
    v_dot2_f32_bf16 v194, v141, v12, v194
    v_dot2_f32_bf16 v195, v141, v13, v195
    s_waitcnt vmcnt(13)
    v_dot2_f32_bf16 v128, v148, v12, v128
    v_dot2_f32_bf16 v129, v148, v13, v129
    v_dot2_f32_bf16 v130, v149, v12, v130
    v_dot2_f32_bf16 v131, v149, v13, v131
    v_dot2_f32_bf16 v144, v150, v12, v144
    v_dot2_f32_bf16 v145, v150, v13, v145
    v_dot2_f32_bf16 v146, v151, v12, v146
    v_dot2_f32_bf16 v147, v151, v13, v147
    v_dot2_f32_bf16 v160, v152, v12, v160
    v_dot2_f32_bf16 v161, v152, v13, v161
    v_dot2_f32_bf16 v162, v153, v12, v162
    v_dot2_f32_bf16 v163, v153, v13, v163
    v_dot2_f32_bf16 v176, v154, v12, v176
    v_dot2_f32_bf16 v177, v154, v13, v177
    v_dot2_f32_bf16 v178, v155, v12, v178
    v_dot2_f32_bf16 v179, v155, v13, v179
    v_dot2_f32_bf16 v192, v156, v12, v192
    v_dot2_f32_bf16 v193, v156, v13, v193
    v_dot2_f32_bf16 v194, v157, v12, v194
    v_dot2_f32_bf16 v195, v157, v13, v195
    s_waitcnt vmcnt(10)
    v_dot2_f32_bf16 v128, v164, v12, v128
    v_dot2_f32_bf16 v129, v164, v13, v129
    v_dot2_f32_bf16 v130, v165, v12, v130
    v_dot2_f32_bf16 v131, v165, v13, v131
    v_dot2_f32_bf16 v144, v166, v12, v144
    v_dot2_f32_bf16 v145, v166, v13, v145
    v_dot2_f32_bf16 v146, v167, v12, v146
    v_dot2_f32_bf16 v147, v167, v13, v147
    v_dot2_f32_bf16 v160, v168, v12, v160
    v_dot2_f32_bf16 v161, v168, v13, v161
    v_dot2_f32_bf16 v162, v169, v12, v162
    v_dot2_f32_bf16 v163, v169, v13, v163
    v_dot2_f32_bf16 v176, v170, v12, v176
    v_dot2_f32_bf16 v177, v170, v13, v177
    v_dot2_f32_bf16 v178, v171, v12, v178
    v_dot2_f32_bf16 v179, v171, v13, v179
    v_dot2_f32_bf16 v192, v172, v12, v192
    v_dot2_f32_bf16 v193, v172, v13, v193
    v_dot2_f32_bf16 v194, v173, v12, v194
    v_dot2_f32_bf16 v195, v173, v13, v195
    v_pk_mul_f32 v[132:133], v[128:129], s[6:7]
    v_pk_mul_f32 v[134:135], v[130:131], s[6:7]
    v_exp_f32 v132, v132
    v_exp_f32 v133, v133
    v_exp_f32 v134, v134
    v_exp_f32 v135, v135
    v_lshlrev_b32 v136, 16, v2
    v_and_b32 v137, 0xffff0000, v2
    v_lshlrev_b32 v138, 16, v3
    v_and_b32 v139, 0xffff0000, v3
    v_pk_add_f32 v[132:133], v[132:133], 1.0 op_sel_hi:[1,0]
    v_pk_add_f32 v[134:135], v[134:135], 1.0 op_sel_hi:[1,0]
    v_rcp_f32 v132, v132
    v_rcp_f32 v133, v133
    v_rcp_f32 v134, v134
    v_rcp_f32 v135, v135
    v_pk_mul_f32 v[132:133], v[132:133], v[128:129]
    v_pk_mul_f32 v[134:135], v[134:135], v[130:131]
    v_pk_mul_f32 v[148:149], v[144:145], s[6:7]
    v_pk_mul_f32 v[150:151], v[146:147], s[6:7]
    v_exp_f32 v148, v148
    v_exp_f32 v149, v149
    v_exp_f32 v150, v150
    v_exp_f32 v151, v151
    v_lshlrev_b32 v152, 16, v4
    v_and_b32 v153, 0xffff0000, v4
    v_lshlrev_b32 v154, 16, v5
    v_and_b32 v155, 0xffff0000, v5
    v_pk_add_f32 v[148:149], v[148:149], 1.0 op_sel_hi:[1,0]
    v_pk_add_f32 v[150:151], v[150:151], 1.0 op_sel_hi:[1,0]
    v_rcp_f32 v148, v148
    v_rcp_f32 v149, v149
    v_rcp_f32 v150, v150
    v_rcp_f32 v151, v151
    v_pk_mul_f32 v[148:149], v[148:149], v[144:145]
    v_pk_mul_f32 v[150:151], v[150:151], v[146:147]
    v_pk_mul_f32 v[164:165], v[160:161], s[6:7]
    v_pk_mul_f32 v[166:167], v[162:163], s[6:7]
    v_exp_f32 v164, v164
    v_exp_f32 v165, v165
    v_exp_f32 v166, v166
    v_exp_f32 v167, v167
    v_lshlrev_b32 v168, 16, v6
    v_and_b32 v169, 0xffff0000, v6
    v_lshlrev_b32 v170, 16, v7
    v_and_b32 v171, 0xffff0000, v7
    v_pk_add_f32 v[164:165], v[164:165], 1.0 op_sel_hi:[1,0]
    v_pk_add_f32 v[166:167], v[166:167], 1.0 op_sel_hi:[1,0]
    v_rcp_f32 v164, v164
    v_rcp_f32 v165, v165
    v_rcp_f32 v166, v166
    v_rcp_f32 v167, v167
    v_pk_mul_f32 v[164:165], v[164:165], v[160:161]
    v_pk_mul_f32 v[166:167], v[166:167], v[162:163]
    v_pk_mul_f32 v[180:181], v[176:177], s[6:7]
    v_pk_mul_f32 v[182:183], v[178:179], s[6:7]
    v_exp_f32 v180, v180
    v_exp_f32 v181, v181
    v_exp_f32 v182, v182
    v_exp_f32 v183, v183
    v_lshlrev_b32 v184, 16, v8
    v_and_b32 v185, 0xffff0000, v8
    v_lshlrev_b32 v186, 16, v9
    v_and_b32 v187, 0xffff0000, v9
    v_pk_add_f32 v[180:181], v[180:181], 1.0 op_sel_hi:[1,0]
    v_pk_add_f32 v[182:183], v[182:183], 1.0 op_sel_hi:[1,0]
    v_rcp_f32 v180, v180
    v_rcp_f32 v181, v181
    v_rcp_f32 v182, v182
    v_rcp_f32 v183, v183
    v_pk_mul_f32 v[180:181], v[180:181], v[176:177]
    v_pk_mul_f32 v[182:183], v[182:183], v[178:179]
    v_pk_mul_f32 v[196:197], v[192:193], s[6:7]
    v_pk_mul_f32 v[198:199], v[194:195], s[6:7]
    v_exp_f32 v196, v196
    v_exp_f32 v197, v197
    v_exp_f32 v198, v198
    v_exp_f32 v199, v199
    v_lshlrev_b32 v200, 16, v10
    v_and_b32 v201, 0xffff0000, v10
    v_lshlrev_b32 v202, 16, v11
    v_and_b32 v203, 0xffff0000, v11
    v_pk_add_f32 v[196:197], v[196:197], 1.0 op_sel_hi:[1,0]
    v_pk_add_f32 v[198:199], v[198:199], 1.0 op_sel_hi:[1,0]
    v_rcp_f32 v196, v196
    v_rcp_f32 v197, v197
    v_rcp_f32 v198, v198
    v_rcp_f32 v199, v199
    v_pk_mul_f32 v[196:197], v[196:197], v[192:193]
    v_pk_mul_f32 v[198:199], v[198:199], v[194:195]
    s_waitcnt vmcnt(0)
    s_barrier
    buffer_atomic_add v17, v16, s[40:43], s13 offen
    s_mov_b32 s4, 0
    s_mov_b32 s3, 0x100000
M_gather:
    v_readfirstlane_b32 s5, v21
    s_andn2_b32 s5, s5, s4
    s_bitcmp0_b32 s5, 0
    s_cbranch_scc1 M_skip0
    buffer_load_dwordx4 v[68:71], v1, s[48:51], s16 offen sc1
    buffer_load_dwordx4 v[72:75], v1, s[48:51], s16 offen offset:1024 sc1
    buffer_load_dwordx2 v[76:77], v45, s[48:51], s16 offen offset:2048 sc1
M_skip0:
    s_bitcmp0_b32 s5, 1
    s_cbranch_scc1 M_skip1
    buffer_load_dwordx4 v[84:87], v1, s[48:51], s14 offen sc1
    buffer_load_dwordx4 v[88:91], v1, s[48:51], s14 offen offset:1024 sc1
    buffer_load_dwordx2 v[92:93], v45, s[48:51], s14 offen offset:2048 sc1
M_skip1:
    s_bitcmp0_b32 s5, 2
    s_cbranch_scc1 M_skip2
    buffer_load_dwordx4 v[100:103], v1, s[48:51], s12 offen sc1
    buffer_load_dwordx4 v[104:107], v1, s[48:51], s12 offen offset:1024 sc1
    buffer_load_dwordx2 v[108:109], v45, s[48:51], s12 offen offset:2048 sc1
M_skip2:
    s_or_b32 s4, s4, s5
    s_cmp_eq_u32 s4, 7
    s_cbranch_scc1 M_gathered
    buffer_load_dword v21, off, s[40:43], s92 sc1
    s_sub_u32 s3, s3, 1
    s_cmp_lg_u32 s3, 0
    s_waitcnt vmcnt(0)
    s_cbranch_scc1 M_gather
M_gathered:
    s_waitcnt vmcnt(0)
    v_dot2_f32_bf16 v64, v68, v12, v64
    v_dot2_f32_bf16 v65, v68, v13, v65
    v_dot2_f32_bf16 v66, v69, v12, v66
    v_dot2_f32_bf16 v67, v69, v13, v67
    v_dot2_f32_bf16 v80, v70, v12, v80
    v_dot2_f32_bf16 v81, v70, v13, v81
    v_dot2_f32_bf16 v82, v71, v12, v82
    v_dot2_f32_bf16 v83, v71, v13, v83
    v_dot2_f32_bf16 v96, v72, v12, v96
    v_dot2_f32_bf16 v97, v72, v13, v97
    v_dot2_f32_bf16 v98, v73, v12, v98
    v_dot2_f32_bf16 v99, v73, v13, v99
    v_dot2_f32_bf16 v112, v74, v12, v112
    v_dot2_f32_bf16 v113, v74, v13, v113
    v_dot2_f32_bf16 v114, v75, v12, v114
    v_dot2_f32_bf16 v115, v75, v13, v115
    v_dot2_f32_bf16 v208, v76, v12, v208
    v_dot2_f32_bf16 v209, v76, v13, v209
    v_dot2_f32_bf16 v210, v77, v12, v210
    v_dot2_f32_bf16 v211, v77, v13, v211
    v_dot2_f32_bf16 v64, v84, v12, v64
    v_dot2_f32_bf16 v65, v84, v13, v65
    v_dot2_f32_bf16 v66, v85, v12, v66
    v_dot2_f32_bf16 v67, v85, v13, v67
    v_dot2_f32_bf16 v80, v86, v12, v80
    v_dot2_f32_bf16 v81, v86, v13, v81
    v_dot2_f32_bf16 v82, v87, v12, v82
    v_dot2_f32_bf16 v83, v87, v13, v83
    v_dot2_f32_bf16 v96, v88, v12, v96
    v_dot2_f32_bf16 v97, v88, v13, v97
    v_dot2_f32_bf16 v98, v89, v12, v98
    v_dot2_f32_bf16 v99, v89, v13, v99
    v_dot2_f32_bf16 v112, v90, v12, v112
    v_dot2_f32_bf16 v113, v90, v13, v113
    v_dot2_f32_bf16 v114, v91, v12, v114
    v_dot2_f32_bf16 v115, v91, v13, v115
    v_dot2_f32_bf16 v208, v92, v12, v208
    v_dot2_f32_bf16 v209, v92, v13, v209
    v_dot2_f32_bf16 v210, v93, v12, v210
    v_dot2_f32_bf16 v211, v93, v13, v211
    v_dot2_f32_bf16 v64, v100, v12, v64
    v_dot2_f32_bf16 v65, v100, v13, v65
    v_dot2_f32_bf16 v66, v101, v12, v66
    v_dot2_f32_bf16 v67, v101, v13, v67
    v_dot2_f32_bf16 v80, v102, v12, v80
    v_dot2_f32_bf16 v81, v102, v13, v81
    v_dot2_f32_bf16 v82, v103, v12, v82
    v_dot2_f32_bf16 v83, v103, v13, v83
    v_dot2_f32_bf16 v96, v104, v12, v96
    v_dot2_f32_bf16 v97, v104, v13, v97
    v_dot2_f32_bf16 v98, v105, v12, v98
    v_dot2_f32_bf16 v99, v105, v13, v99
    v_dot2_f32_bf16 v112, v106, v12, v112
    v_dot2_f32_bf16 v113, v106, v13, v113
    v_dot2_f32_bf16 v114, v107, v12, v114
    v_dot2_f32_bf16 v115, v107, v13, v115
    v_dot2_f32_bf16 v208, v108, v12, v208
    v_dot2_f32_bf16 v209, v108, v13, v209
    v_dot2_f32_bf16 v210, v109, v12, v210
    v_dot2_f32_bf16 v211, v109, v13, v211
    v_pk_fma_f32 v[132:133], v[132:133], v[64:65], v[136:137]
    v_pk_fma_f32 v[134:135], v[134:135], v[66:67], v[138:139]
    v_cvt_pk_bf16_f32 v136, v132, v133
    v_cvt_pk_bf16_f32 v137, v134, v135
    ds_write_b64 v24, v[136:137] offset:0
    v_pk_fma_f32 v[148:149], v[148:149], v[80:81], v[152:153]
    v_pk_fma_f32 v[150:151], v[150:151], v[82:83], v[154:155]
    v_cvt_pk_bf16_f32 v152, v148, v149
    v_cvt_pk_bf16_f32 v153, v150, v151
    ds_write_b64 v24, v[152:153] offset:32
    v_pk_fma_f32 v[164:165], v[164:165], v[96:97], v[168:169]
    v_pk_fma_f32 v[166:167], v[166:167], v[98:99], v[170:171]
    v_cvt_pk_bf16_f32 v168, v164, v165
    v_cvt_pk_bf16_f32 v169, v166, v167
    ds_write_b64 v24, v[168:169] offset:64
    v_pk_fma_f32 v[180:181], v[180:181], v[112:113], v[184:185]
    v_pk_fma_f32 v[182:183], v[182:183], v[114:115], v[186:187]
    v_cvt_pk_bf16_f32 v184, v180, v181
    v_cvt_pk_bf16_f32 v185, v182, v183
    ds_write_b64 v24, v[184:185] offset:96
    v_pk_fma_f32 v[196:197], v[196:197], v[208:209], v[200:201]
    v_pk_fma_f32 v[198:199], v[198:199], v[210:211], v[202:203]
    v_cvt_pk_bf16_f32 v200, v196, v197
    v_cvt_pk_bf16_f32 v201, v198, v199
    ds_write_b64 v24, v[200:201] offset:128
    ds_read_b128 v[224:227], v25
    ds_read_b128 v[228:231], v26
    ds_read_b128 v[232:235], v27
    s_waitcnt lgkmcnt(2)
    buffer_store_dwordx4 v[224:227], v28, s[64:67], s91 offen
    s_waitcnt lgkmcnt(1)
    buffer_store_dwordx4 v[228:231], v29, s[64:67], s91 offen
    s_waitcnt lgkmcnt(0)
    buffer_store_dwordx4 v[232:235], v30, s[64:67], s91 offen
M_exit:
    s_endpgm
M_ps_spin:
    s_mov_b32 s3, 0x100000
M_ps_loop:
    buffer_load_dword v63, v62, s[36:39], 0 offen sc1
    s_waitcnt vmcnt(0)
    v_cmp_gt_u32 vcc, 32, v63
    s_cbranch_vccz M_ps_back
    s_sub_u32 s3, s3, 1
    s_cmp_lg_u32 s3, 0
    s_cbranch_scc1 M_ps_loop
    s_branch M_ps_back
M_pa_spin:
    s_mov_b32 s3, 0x100000
M_pa_loop:
    buffer_load_dword v21, v20, s[40:43], 0 offen sc1
    s_waitcnt vmcnt(0)
    v_cmp_gt_u32 vcc, 32, v21
    s_cbranch_vccz M_pa_back
    s_sub_u32 s3, s3, 1
    s_cmp_lg_u32 s3, 0
    s_cbranch_scc1 M_pa_loop
    s_branch M_pa_back
M_poa_spin:
    s_mov_b32 s3, 0x100000
M_poa_loop:
    buffer_load_dword v21, off, s[40:43], s95 sc1
    s_waitcnt vmcnt(0)
    v_and_b32 v21, 0xff, v21
    v_cmp_gt_u32 vcc, 8, v21
    s_cbranch_vccz M_poa_back
    s_sub_u32 s3, s3, 1
    s_cmp_lg_u32 s3, 0
    s_cbranch_scc1 M_poa_loop
    s_branch M_poa_back
M_pob_spin:
    s_mov_b32 s3, 0x100000
M_pob_loop:
    buffer_load_dword v21, off, s[40:43], s95 sc1
    s_waitcnt vmcnt(0)
    v_cmp_gt_u32 vcc, 0x800, v21
    s_cbranch_vccz M_pob_back
    s_sub_u32 s3, s3, 1
    s_cmp_lg_u32 s3, 0
    s_cbranch_scc1 M_pob_loop
    s_branch M_pob_back
M_pg_spin:
    s_mov_b32 s3, 0x100000
M_pg_loop:
    buffer_load_dword v21, off, s[40:43], s13 sc1
    s_waitcnt vmcnt(0)
    v_cmp_gt_u32 vcc, 4, v21
    s_cbranch_vccz M_pg_back
    s_sub_u32 s3, s3, 1
    s_cmp_lg_u32 s3, 0
    s_cbranch_scc1 M_pg_loop
    s_branch M_pg_back
M_hot_end:
M_fallback:
    s_mov_b32 s82, -1
    s_mov_b32 s93, 16777216
    s_mov_b32 s34, 0
    s_sub_u32 s87, s87, 24576
    s_sub_u32 s88, s88, 327680
    v_mov_b32 v24, 0xff800000
    v_mov_b32 v25, 0xff800000
    v_mov_b32 v26, 0xff800000
    v_mov_b32 v27, 0xff800000
    s_mov_b32 s80, 0
M_maxloop:
    s_waitcnt vmcnt(0) lgkmcnt(0)
    s_barrier
    s_mov_b32 m0, s68
    s_nop 0
    buffer_load_dwordx4 v14, s[20:23], s80 offen offset:0 lds
    buffer_load_dwordx4 v15, s[20:23], s80 offen offset:1024 lds
    buffer_load_dwordx4 v16, s[20:23], s80 offen offset:2048 lds
    buffer_load_dwordx4 v17, s[20:23], s80 offen offset:3072 lds
    s_waitcnt vmcnt(0)
    s_barrier
    ds_read_b128 a[64:67], v2 offset:0
    ds_read_b128 a[68:71], v3 offset:0
    ds_read_b128 a[72:75], v4 offset:0
    ds_read_b128 a[76:79], v5 offset:0
    s_waitcnt lgkmcnt(0)
    v_mfma_f32_16x16x32_bf16 v[64:67], a[64:67], a[0:3], 0
    v_mfma_f32_16x16x32_bf16 v[64:67], a[68:71], a[4:7], v[64:67]
    v_mfma_f32_16x16x32_bf16 v[64:67], a[72:75], a[8:11], v[64:67]
    v_mfma_f32_16x16x32_bf16 v[64:67], a[76:79], a[12:15], v[64:67]
    v_mfma_f32_16x16x32_bf16 v[68:71], a[64:67], a[16:19], 0
    v_mfma_f32_16x16x32_bf16 v[68:71], a[68:71], a[20:23], v[68:71]
    v_mfma_f32_16x16x32_bf16 v[68:71], a[72:75], a[24:27], v[68:71]
    v_mfma_f32_16x16x32_bf16 v[68:71], a[76:79], a[28:31], v[68:71]
    v_mfma_f32_16x16x32_bf16 v[72:75], a[64:67], a[32:35], 0
    v_mfma_f32_16x16x32_bf16 v[72:75], a[68:71], a[36:39], v[72:75]
    v_mfma_f32_16x16x32_bf16 v[72:75], a[72:75], a[40:43], v[72:75]
    v_mfma_f32_16x16x32_bf16 v[72:75], a[76:79], a[44:47], v[72:75]
    v_mfma_f32_16x16x32_bf16 v[76:79], a[64:67], a[48:51], 0
    v_mfma_f32_16x16x32_bf16 v[76:79], a[68:71], a[52:55], v[76:79]
    v_mfma_f32_16x16x32_bf16 v[76:79], a[72:75], a[56:59], v[76:79]
    v_mfma_f32_16x16x32_bf16 v[76:79], a[76:79], a[60:63], v[76:79]
    s_nop 7
    v_max3_f32 v24, v24, v64, v65
    v_max3_f32 v24, v24, v66, v67
    v_max3_f32 v25, v25, v68, v69
    v_max3_f32 v25, v25, v70, v71
    v_max3_f32 v26, v26, v72, v73
    v_max3_f32 v26, v26, v74, v75
    v_max3_f32 v27, v27, v76, v77
    v_max3_f32 v27, v27, v78, v79
    ds_read_b128 a[80:83], v2 offset:4096
    ds_read_b128 a[84:87], v3 offset:4096
    ds_read_b128 a[88:91], v4 offset:4096
    ds_read_b128 a[92:95], v5 offset:4096
    s_waitcnt lgkmcnt(0)
    v_mfma_f32_16x16x32_bf16 v[64:67], a[80:83], a[0:3], 0
    v_mfma_f32_16x16x32_bf16 v[64:67], a[84:87], a[4:7], v[64:67]
    v_mfma_f32_16x16x32_bf16 v[64:67], a[88:91], a[8:11], v[64:67]
    v_mfma_f32_16x16x32_bf16 v[64:67], a[92:95], a[12:15], v[64:67]
    v_mfma_f32_16x16x32_bf16 v[68:71], a[80:83], a[16:19], 0
    v_mfma_f32_16x16x32_bf16 v[68:71], a[84:87], a[20:23], v[68:71]
    v_mfma_f32_16x16x32_bf16 v[68:71], a[88:91], a[24:27], v[68:71]
    v_mfma_f32_16x16x32_bf16 v[68:71], a[92:95], a[28:31], v[68:71]
    v_mfma_f32_16x16x32_bf16 v[72:75], a[80:83], a[32:35], 0
    v_mfma_f32_16x16x32_bf16 v[72:75], a[84:87], a[36:39], v[72:75]
    v_mfma_f32_16x16x32_bf16 v[72:75], a[88:91], a[40:43], v[72:75]
    v_mfma_f32_16x16x32_bf16 v[72:75], a[92:95], a[44:47], v[72:75]
    v_mfma_f32_16x16x32_bf16 v[76:79], a[80:83], a[48:51], 0
    v_mfma_f32_16x16x32_bf16 v[76:79], a[84:87], a[52:55], v[76:79]
    v_mfma_f32_16x16x32_bf16 v[76:79], a[88:91], a[56:59], v[76:79]
    v_mfma_f32_16x16x32_bf16 v[76:79], a[92:95], a[60:63], v[76:79]
    s_nop 7
    v_max3_f32 v24, v24, v64, v65
    v_max3_f32 v24, v24, v66, v67
    v_max3_f32 v25, v25, v68, v69
    v_max3_f32 v25, v25, v70, v71
    v_max3_f32 v26, v26, v72, v73
    v_max3_f32 v26, v26, v74, v75
    v_max3_f32 v27, v27, v76, v77
    v_max3_f32 v27, v27, v78, v79
    ds_read_b128 a[96:99], v2 offset:8192
    ds_read_b128 a[100:103], v3 offset:8192
    ds_read_b128 a[104:107], v4 offset:8192
    ds_read_b128 a[108:111], v5 offset:8192
    s_waitcnt lgkmcnt(0)
    v_mfma_f32_16x16x32_bf16 v[64:67], a[96:99], a[0:3], 0
    v_mfma_f32_16x16x32_bf16 v[64:67], a[100:103], a[4:7], v[64:67]
    v_mfma_f32_16x16x32_bf16 v[64:67], a[104:107], a[8:11], v[64:67]
    v_mfma_f32_16x16x32_bf16 v[64:67], a[108:111], a[12:15], v[64:67]
    v_mfma_f32_16x16x32_bf16 v[68:71], a[96:99], a[16:19], 0
    v_mfma_f32_16x16x32_bf16 v[68:71], a[100:103], a[20:23], v[68:71]
    v_mfma_f32_16x16x32_bf16 v[68:71], a[104:107], a[24:27], v[68:71]
    v_mfma_f32_16x16x32_bf16 v[68:71], a[108:111], a[28:31], v[68:71]
    v_mfma_f32_16x16x32_bf16 v[72:75], a[96:99], a[32:35], 0
    v_mfma_f32_16x16x32_bf16 v[72:75], a[100:103], a[36:39], v[72:75]
    v_mfma_f32_16x16x32_bf16 v[72:75], a[104:107], a[40:43], v[72:75]
    v_mfma_f32_16x16x32_bf16 v[72:75], a[108:111], a[44:47], v[72:75]
    v_mfma_f32_16x16x32_bf16 v[76:79], a[96:99], a[48:51], 0
    v_mfma_f32_16x16x32_bf16 v[76:79], a[100:103], a[52:55], v[76:79]
    v_mfma_f32_16x16x32_bf16 v[76:79], a[104:107], a[56:59], v[76:79]
    v_mfma_f32_16x16x32_bf16 v[76:79], a[108:111], a[60:63], v[76:79]
    s_nop 7
    v_max3_f32 v24, v24, v64, v65
    v_max3_f32 v24, v24, v66, v67
    v_max3_f32 v25, v25, v68, v69
    v_max3_f32 v25, v25, v70, v71
    v_max3_f32 v26, v26, v72, v73
    v_max3_f32 v26, v26, v74, v75
    v_max3_f32 v27, v27, v76, v77
    v_max3_f32 v27, v27, v78, v79
    ds_read_b128 a[112:115], v2 offset:12288
    ds_read_b128 a[116:119], v3 offset:12288
    ds_read_b128 a[120:123], v4 offset:12288
    ds_read_b128 a[124:127], v5 offset:12288
    s_waitcnt lgkmcnt(0)
    v_mfma_f32_16x16x32_bf16 v[64:67], a[112:115], a[0:3], 0
    v_mfma_f32_16x16x32_bf16 v[64:67], a[116:119], a[4:7], v[64:67]
    v_mfma_f32_16x16x32_bf16 v[64:67], a[120:123], a[8:11], v[64:67]
    v_mfma_f32_16x16x32_bf16 v[64:67], a[124:127], a[12:15], v[64:67]
    v_mfma_f32_16x16x32_bf16 v[68:71], a[112:115], a[16:19], 0
    v_mfma_f32_16x16x32_bf16 v[68:71], a[116:119], a[20:23], v[68:71]
    v_mfma_f32_16x16x32_bf16 v[68:71], a[120:123], a[24:27], v[68:71]
    v_mfma_f32_16x16x32_bf16 v[68:71], a[124:127], a[28:31], v[68:71]
    v_mfma_f32_16x16x32_bf16 v[72:75], a[112:115], a[32:35], 0
    v_mfma_f32_16x16x32_bf16 v[72:75], a[116:119], a[36:39], v[72:75]
    v_mfma_f32_16x16x32_bf16 v[72:75], a[120:123], a[40:43], v[72:75]
    v_mfma_f32_16x16x32_bf16 v[72:75], a[124:127], a[44:47], v[72:75]
    v_mfma_f32_16x16x32_bf16 v[76:79], a[112:115], a[48:51], 0
    v_mfma_f32_16x16x32_bf16 v[76:79], a[116:119], a[52:55], v[76:79]
    v_mfma_f32_16x16x32_bf16 v[76:79], a[120:123], a[56:59], v[76:79]
    v_mfma_f32_16x16x32_bf16 v[76:79], a[124:127], a[60:63], v[76:79]
    s_nop 7
    v_max3_f32 v24, v24, v64, v65
    v_max3_f32 v24, v24, v66, v67
    v_max3_f32 v25, v25, v68, v69
    v_max3_f32 v25, v25, v70, v71
    v_max3_f32 v26, v26, v72, v73
    v_max3_f32 v26, v26, v74, v75
    v_max3_f32 v27, v27, v76, v77
    v_max3_f32 v27, v27, v78, v79
    s_add_u32 s80, s80, 16384
    s_cmp_lt_u32 s80, 524288
    s_cbranch_scc1 M_maxloop
    s_barrier
    s_mov_b32 m0, s68
    s_mov_b32 s80, 0
    buffer_load_dwordx4 v14, s[20:23], s80 offen offset:0 lds
    buffer_load_dwordx4 v15, s[20:23], s80 offen offset:1024 lds
    buffer_load_dwordx4 v16, s[20:23], s80 offen offset:2048 lds
    buffer_load_dwordx4 v17, s[20:23], s80 offen offset:3072 lds
    s_mov_b32 m0, s69
    s_mov_b32 s80, 16384
    buffer_load_dwordx4 v14, s[20:23], s80 offen offset:0 lds
    buffer_load_dwordx4 v15, s[20:23], s80 offen offset:1024 lds
    buffer_load_dwordx4 v16, s[20:23], s80 offen offset:2048 lds
    buffer_load_dwordx4 v17, s[20:23], s80 offen offset:3072 lds
    s_mov_b32 m0, s70
    s_mov_b32 s80, 32768
    buffer_load_dwordx4 v14, s[20:23], s80 offen offset:0 lds
    buffer_load_dwordx4 v15, s[20:23], s80 offen offset:1024 lds
    buffer_load_dwordx4 v16, s[20:23], s80 offen offset:2048 lds
    buffer_load_dwordx4 v17, s[20:23], s80 offen offset:3072 lds
    s_mov_b32 m0, s72
    s_mov_b32 s80, 0
    buffer_load_dwordx4 v18, s[24:27], s80 offen offset:0 lds
    buffer_load_dwordx4 v19, s[24:27], s80 offen offset:1024 lds
    buffer_load_dwordx4 v18, s[24:27], s80 offen offset:2048 lds
    buffer_load_dwordx4 v19, s[24:27], s80 offen offset:3072 lds
    s_mov_b32 m0, s73
    s_mov_b32 s80, 16384
    buffer_load_dwordx4 v18, s[24:27], s80 offen offset:0 lds
    buffer_load_dwordx4 v19, s[24:27], s80 offen offset:1024 lds
    buffer_load_dwordx4 v18, s[24:27], s80 offen offset:2048 lds
    buffer_load_dwordx4 v19, s[24:27], s80 offen offset:3072 lds
    s_waitcnt vmcnt(0)
    s_barrier
    ds_read_b128 a[64:67], v2 offset:0
    ds_read_b128 a[68:71], v3 offset:0
    ds_read_b128 a[72:75], v4 offset:0
    ds_read_b128 a[76:79], v5 offset:0
    ds_read_b128 a[80:83], v2 offset:4096
    ds_read_b128 a[84:87], v3 offset:4096
    ds_read_b128 a[88:91], v4 offset:4096
    ds_read_b128 a[92:95], v5 offset:4096
    ds_read_b128 a[96:99], v2 offset:8192
    ds_read_b128 a[100:103], v3 offset:8192
    ds_read_b128 a[104:107], v4 offset:8192
    ds_read_b128 a[108:111], v5 offset:8192
    ds_read_b128 a[112:115], v2 offset:12288
    ds_read_b128 a[116:119], v3 offset:12288
    ds_read_b128 a[120:123], v4 offset:12288
    ds_read_b128 a[124:127], v5 offset:12288
    s_waitcnt lgkmcnt(0)
    v_mfma_f32_16x16x32_bf16 v[192:195], a[64:67], a[0:3], 0
    v_mfma_f32_16x16x32_bf16 v[192:195], a[68:71], a[4:7], v[192:195]
    v_mfma_f32_16x16x32_bf16 v[192:195], a[72:75], a[8:11], v[192:195]
    v_mfma_f32_16x16x32_bf16 v[192:195], a[76:79], a[12:15], v[192:195]
    v_mfma_f32_16x16x32_bf16 v[208:211], a[76:79], a[28:31], 0
    v_mfma_f32_16x16x32_bf16 v[208:211], a[72:75], a[24:27], v[208:211]
    v_mfma_f32_16x16x32_bf16 v[208:211], a[68:71], a[20:23], v[208:211]
    v_mfma_f32_16x16x32_bf16 v[208:211], a[64:67], a[16:19], v[208:211]
    v_mfma_f32_16x16x32_bf16 v[224:227], a[64:67], a[32:35], 0
    v_mfma_f32_16x16x32_bf16 v[224:227], a[68:71], a[36:39], v[224:227]
    v_mfma_f32_16x16x32_bf16 v[224:227], a[72:75], a[40:43], v[224:227]
    v_mfma_f32_16x16x32_bf16 v[224:227], a[76:79], a[44:47], v[224:227]
    v_mfma_f32_16x16x32_bf16 v[240:243], a[76:79], a[60:63], 0
    v_mfma_f32_16x16x32_bf16 v[240:243], a[72:75], a[56:59], v[240:243]
    v_mfma_f32_16x16x32_bf16 v[240:243], a[68:71], a[52:55], v[240:243]
    v_mfma_f32_16x16x32_bf16 v[240:243], a[64:67], a[48:51], v[240:243]
    v_mfma_f32_16x16x32_bf16 v[244:247], a[80:83], a[48:51], 0
    v_mfma_f32_16x16x32_bf16 v[244:247], a[84:87], a[52:55], v[244:247]
    v_mfma_f32_16x16x32_bf16 v[244:247], a[88:91], a[56:59], v[244:247]
    v_mfma_f32_16x16x32_bf16 v[244:247], a[92:95], a[60:63], v[244:247]
    v_mfma_f32_16x16x32_bf16 v[228:231], a[92:95], a[44:47], 0
    v_mfma_f32_16x16x32_bf16 v[228:231], a[88:91], a[40:43], v[228:231]
    v_mfma_f32_16x16x32_bf16 v[228:231], a[84:87], a[36:39], v[228:231]
    v_mfma_f32_16x16x32_bf16 v[228:231], a[80:83], a[32:35], v[228:231]
    v_mfma_f32_16x16x32_bf16 v[212:215], a[80:83], a[16:19], 0
    v_mfma_f32_16x16x32_bf16 v[212:215], a[84:87], a[20:23], v[212:215]
    v_mfma_f32_16x16x32_bf16 v[212:215], a[88:91], a[24:27], v[212:215]
    v_mfma_f32_16x16x32_bf16 v[212:215], a[92:95], a[28:31], v[212:215]
    v_mfma_f32_16x16x32_bf16 v[196:199], a[92:95], a[12:15], 0
    v_mfma_f32_16x16x32_bf16 v[196:199], a[88:91], a[8:11], v[196:199]
    v_mfma_f32_16x16x32_bf16 v[196:199], a[84:87], a[4:7], v[196:199]
    v_mfma_f32_16x16x32_bf16 v[196:199], a[80:83], a[0:3], v[196:199]
    v_mfma_f32_16x16x32_bf16 v[200:203], a[96:99], a[0:3], 0
    v_mfma_f32_16x16x32_bf16 v[200:203], a[100:103], a[4:7], v[200:203]
    v_mfma_f32_16x16x32_bf16 v[200:203], a[104:107], a[8:11], v[200:203]
    v_mfma_f32_16x16x32_bf16 v[200:203], a[108:111], a[12:15], v[200:203]
    v_mfma_f32_16x16x32_bf16 v[216:219], a[108:111], a[28:31], 0
    v_mfma_f32_16x16x32_bf16 v[216:219], a[104:107], a[24:27], v[216:219]
    v_mfma_f32_16x16x32_bf16 v[216:219], a[100:103], a[20:23], v[216:219]
    v_mfma_f32_16x16x32_bf16 v[216:219], a[96:99], a[16:19], v[216:219]
    v_mfma_f32_16x16x32_bf16 v[232:235], a[96:99], a[32:35], 0
    v_mfma_f32_16x16x32_bf16 v[232:235], a[100:103], a[36:39], v[232:235]
    v_mfma_f32_16x16x32_bf16 v[232:235], a[104:107], a[40:43], v[232:235]
    v_mfma_f32_16x16x32_bf16 v[232:235], a[108:111], a[44:47], v[232:235]
    v_mfma_f32_16x16x32_bf16 v[248:251], a[108:111], a[60:63], 0
    v_mfma_f32_16x16x32_bf16 v[248:251], a[104:107], a[56:59], v[248:251]
    v_mfma_f32_16x16x32_bf16 v[248:251], a[100:103], a[52:55], v[248:251]
    v_mfma_f32_16x16x32_bf16 v[248:251], a[96:99], a[48:51], v[248:251]
    v_mfma_f32_16x16x32_bf16 v[252:255], a[112:115], a[48:51], 0
    v_mfma_f32_16x16x32_bf16 v[252:255], a[116:119], a[52:55], v[252:255]
    v_mfma_f32_16x16x32_bf16 v[252:255], a[120:123], a[56:59], v[252:255]
    v_mfma_f32_16x16x32_bf16 v[252:255], a[124:127], a[60:63], v[252:255]
    v_mfma_f32_16x16x32_bf16 v[236:239], a[124:127], a[44:47], 0
    v_mfma_f32_16x16x32_bf16 v[236:239], a[120:123], a[40:43], v[236:239]
    v_mfma_f32_16x16x32_bf16 v[236:239], a[116:119], a[36:39], v[236:239]
    v_mfma_f32_16x16x32_bf16 v[236:239], a[112:115], a[32:35], v[236:239]
    v_mfma_f32_16x16x32_bf16 v[220:223], a[112:115], a[16:19], 0
    v_mfma_f32_16x16x32_bf16 v[220:223], a[116:119], a[20:23], v[220:223]
    v_mfma_f32_16x16x32_bf16 v[220:223], a[120:123], a[24:27], v[220:223]
    v_mfma_f32_16x16x32_bf16 v[220:223], a[124:127], a[28:31], v[220:223]
    v_mfma_f32_16x16x32_bf16 v[204:207], a[124:127], a[12:15], 0
    v_mfma_f32_16x16x32_bf16 v[204:207], a[120:123], a[8:11], v[204:207]
    v_mfma_f32_16x16x32_bf16 v[204:207], a[116:119], a[4:7], v[204:207]
    v_mfma_f32_16x16x32_bf16 v[204:207], a[112:115], a[0:3], v[204:207]
    v_accvgpr_write_b32 a160, 0
    v_accvgpr_write_b32 a161, 0
    v_accvgpr_write_b32 a162, 0
    v_accvgpr_write_b32 a163, 0
    v_accvgpr_write_b32 a164, 0
    v_accvgpr_write_b32 a165, 0
    v_accvgpr_write_b32 a166, 0
    v_accvgpr_write_b32 a167, 0
    v_accvgpr_write_b32 a168, 0
    v_accvgpr_write_b32 a169, 0
    v_accvgpr_write_b32 a170, 0
    v_accvgpr_write_b32 a171, 0
    v_accvgpr_write_b32 a172, 0
    v_accvgpr_write_b32 a173, 0
    v_accvgpr_write_b32 a174, 0
    v_accvgpr_write_b32 a175, 0
    s_mov_b32 s6, 0
    s_branch M_restart
.section .rodata,"a"
.p2align 6
.amdhsa_kernel recurrent_scan__gqa_block_cached__dense_activation_silu__prompt_kernel
.amdhsa_next_free_vgpr 512
.amdhsa_next_free_sgpr 102
.amdhsa_accum_offset 256
.amdhsa_group_segment_fixed_size 0
.amdhsa_kernarg_size 88
.amdhsa_user_sgpr_count 2
.amdhsa_user_sgpr_kernarg_segment_ptr 1
.amdhsa_system_sgpr_workgroup_id_x 1
.end_amdhsa_kernel
```
